```python
import torch

def _softmax(x, axis=-1):
    return torch.softmax(x, dim=axis)
def _gelu(x):
    return torch.nn.functional.gelu(x, approximate="tanh")
def _silu(x):
    return torch.nn.functional.silu(x)
def _sigmoid(x):
    return torch.sigmoid(x)
def _layernorm(x, axis=-1, eps=1e-5):
    m = x.mean(dim=axis, keepdim=True)
    v = x.var(dim=axis, keepdim=True, unbiased=False)
    return (x - m) / torch.sqrt(v + eps)
def _scatter_add(tgt, idx, src, axis=0):
    return tgt.clone().index_add_(axis, idx, src)
def _segment_sum(src, seg, n):
    out = torch.zeros((n,) + src.shape[1:], dtype=src.dtype)
    return out.index_add_(0, seg, src)
def _pad(x, pw):
    flat = tuple(v for pair in reversed(pw) for v in pair)
    return torch.nn.functional.pad(x, flat)

kernel_name = 'gated_mix__grouped_kv_mqa__mixer_s_mlp__prompt'

def setup_inputs():

    _w = (lambda a: (lambda t: t.to(torch.bfloat16) if t.is_floating_point() else t)(torch.as_tensor(a)))
    def _A_setup():
        B, S, D, H = 1, 2048, 640, 32
        Dh = D // H
        return {
            "x": _w((lambda *s: torch.randn(*s, dtype=torch.bfloat16) * 0.05)(B, S, D)),
            "wq": _w((lambda *s: torch.randn(*s, dtype=torch.bfloat16) * 0.8)(D, H * Dh)),
            "wk": _w((lambda *s: torch.randn(*s, dtype=torch.bfloat16) * 0.8)(D, Dh)),
            "wv": _w((lambda *s: torch.randn(*s, dtype=torch.bfloat16) * 1.6)(D, Dh)),
            "wo": _w((lambda *s: torch.randn(*s, dtype=torch.bfloat16) * 1.6)(H * Dh, D)),
        }
    _A_in = _A_setup()

    def _B_setup():
        B, S, D, F = 1, 2048, 640, 1728
        return {
            "x":  _w((lambda *s: torch.randn(*s, dtype=torch.bfloat16) * 0.05)(B, S, D)),
            "w1": _w((lambda *s: torch.randn(*s, dtype=torch.bfloat16) * 3.2)(D, D) * (D ** -0.5)),
            "w2": _w((lambda *s: torch.randn(*s, dtype=torch.bfloat16) * 3.2)(D, D) * (D ** -0.5)),
            "w3": _w((lambda *s: torch.randn(*s, dtype=torch.bfloat16) * 3.2)(D, F) * (D ** -0.5)),
            "w4": _w((lambda *s: torch.randn(*s, dtype=torch.bfloat16) * 1.6)(F, D) * (F ** -0.5)),
        }
    _B_in = _B_setup()

    return {
        "A_x": _A_in["x"],
        "A_wq": _A_in["wq"],
        "A_wk": _A_in["wk"],
        "A_wv": _A_in["wv"],
        "A_wo": _A_in["wo"],
        "B_x": _B_in["x"],
        "B_w1": _B_in["w1"],
        "B_w2": _B_in["w2"],
        "B_w3": _B_in["w3"],
        "B_w4": _B_in["w4"],
        "gate_w": _w((lambda *s: torch.randn(*s, dtype=torch.bfloat16) * 0.1)(640) * 16.0),
    }

def reference(A_x, A_wq, A_wk, A_wv, A_wo, B_x, B_w1, B_w2, B_w3, B_w4, gate_w):
    def _A_ref(x, wq, wk, wv, wo):
        B, S, D = x.shape
        H = 32
        Dh = D // H
        q = (lambda x, *d: x.permute(*d))((x @ wq).reshape(B, S, H, Dh), 0, 2, 1, 3)
        k = x @ wk
        v = x @ wv
        scores = torch.einsum("bhqd,bkd->bhqk", q, k) * (Dh ** -0.5)
        p = _softmax(scores, axis=-1)
        o = torch.einsum("bhqk,bkd->bhqd", p, v)
        return (lambda x, *d: x.permute(*d))(o, 0, 2, 1, 3).reshape(B, S, H * Dh) @ wo

    def _B_ref(x, w1, w2, w3, w4):
        B, S, D = x.shape
        h = _gelu(_layernorm(x, axis=-1) @ w1)
        c = D // 4
        g0 = _pad(h[:, :, 0*c:1*c], ((0, 0), (1, 0), (0, 0)))[:, :S, :]
        g1 = _pad(h[:, :, 1*c:2*c], ((0, 0), (0, 1), (0, 0)))[:, 1:, :]
        g2 = _pad(h[:, :, 2*c:3*c], ((0, 0), (2, 0), (0, 0)))[:, :S, :]
        g3 = _pad(h[:, :, 3*c:   ], ((0, 0), (0, 2), (0, 0)))[:, 2:, :]
        hs = torch.concatenate([g0, g1, g2, g3], axis=-1) @ w2
        x1 = x + hs
        h2 = _gelu(_layernorm(x1, axis=-1) @ w3) @ w4
        return x1 + h2

    x = A_x
    g = _sigmoid((x * gate_w).sum(-1, keepdims=True))
    a = _A_ref(x, A_wq, A_wk, A_wv, A_wo)
    b = _B_ref(x, B_w1, B_w2, B_w3, B_w4)
    return g * a + (1 - g) * b
```

```asm
; @launch kernel=k1_kernel grid=(256,1,1) block=(768,1,1) lds=163840
; @launch kernel=k2_kernel grid=(512,1,1) block=(512,1,1) lds=81920
.amdgcn_target "amdgcn-amd-amdhsa--gfx950"
.text
.globl k1_kernel
.p2align 8
.type k1_kernel,@function
k1_kernel:
    s_cmp_ge_u32 s2, 256
    s_cbranch_scc1 k1_kernel_end2
    s_load_dwordx2 s[10:11], s[0:1], 0
    s_load_dwordx2 s[12:13], s[0:1], 8
    s_load_dwordx2 s[18:19], s[0:1], 48
    s_load_dwordx2 s[14:15], s[0:1], 16
    s_load_dwordx2 s[16:17], s[0:1], 24
    s_load_dwordx2 s[20:21], s[0:1], 80
    s_load_dwordx2 s[22:23], s[0:1], 104
    s_load_dwordx2 s[50:51], s[0:1], 56
    s_load_dwordx2 s[52:53], s[0:1], 64
    s_load_dwordx2 s[54:55], s[0:1], 72
    s_load_dwordx2 s[56:57], s[0:1], 32
    v_lshrrev_b32 v4, 6, v0
    v_and_b32 v1, 63, v0
    v_readfirstlane_b32 s3, v4
    s_and_b32 s6, s2, 7
    s_lshl_b32 s4, s6, 2
    s_bfe_u32 s6, s2, 0x20006
    s_add_u32 s4, s4, s6
    s_bfe_u32 s5, s2, 0x30003
    s_lshr_b32 s58, s5, 2
    s_and_b32 s59, s5, 3
    s_bfe_u32 s61, s2, 0x20006
    s_mul_i32 s61, s61, 3
    s_add_u32 s61, s61, s5
    s_sub_u32 s6, s61, 10
    s_cmp_ge_u32 s61, 10
    s_cselect_b32 s61, s6, s61
    s_sub_u32 s6, s61, 10
    s_cmp_ge_u32 s61, 10
    s_cselect_b32 s61, s6, s61
    s_cmp_lg_u32 s2, 255
    s_cbranch_scc1 k1_kernel_zf1
    s_waitcnt lgkmcnt(0)
    s_add_u32 s36, s22, 29770752
    s_addc_u32 s37, s23, 0
    s_mov_b32 s38, 12288
    s_mov_b32 s39, 0x20000
    v_lshlrev_b32 v4, 4, v0
    v_mov_b32 v12, 0
    v_mov_b32 v13, 0
    v_mov_b32 v14, 0
    v_mov_b32 v15, 0
    buffer_store_dwordx4 v[12:15], v4, s[36:39], 0 offen sc1
k1_kernel_zf1:
    s_cmp_lt_u32 s3, 8
    s_cbranch_scc1 k1_kernel_comp2
    v_lshrrev_b32 v4, 3, v1
    v_and_b32 v5, 7, v1
    v_lshrrev_b32 v6, 4, v1
    v_xor_b32 v5, v5, v6
    v_mul_u32_u24 v4, 1280, v4
    v_lshl_add_u32 v12, v5, 4, v4
    v_xor_b32 v13, 64, v12
    v_mul_u32_u24 v4, 6554, v1
    v_lshrrev_b32 v4, 16, v4
    v_mul_u32_u24 v5, 10, v4
    v_sub_u32 v5, v1, v5
    v_mul_u32_u24 v4, 1280, v4
    v_lshl_add_u32 v4, v5, 4, v4
    s_mul_i32 s7, s59, 320
    v_add_u32 v14, s7, v4
    v_add_u32 v15, 6720, v14
    v_add_u32 v16, 13440, v14
    v_add_u32 v17, 20160, v14
    s_mov_b32 s62, -1
    s_mov_b32 s63, 0x0fffffff
    s_mov_b32 s64, -1
    s_mov_b32 s65, 0xff
    s_mov_b32 s66, s61
    s_mul_i32 s45, s4, 81920
    s_lshl_b32 s6, s61, 7
    s_add_u32 s45, s45, s6
    s_mul_i32 s46, s61, 81920
    s_waitcnt lgkmcnt(0)
    s_mov_b32 s24, s10
    s_mov_b32 s25, s11
    s_mov_b32 s26, 2621440
    s_mov_b32 s27, 0x20000
    s_cmp_eq_u32 s58, 0
    s_cselect_b32 s28, s12, s18
    s_cselect_b32 s29, s13, s19
    s_mov_b32 s30, 819200
    s_mov_b32 s31, 0x20000
    s_cmp_eq_u32 s3, 9
    s_cbranch_scc1 k1_kernel_ld4
    s_cmp_eq_u32 s3, 10
    s_cbranch_scc1 k1_kernel_ld5
    s_cmp_eq_u32 s3, 11
    s_cbranch_scc1 k1_kernel_ld6
k1_kernel_ld3:
    s_mov_b32 s42, 0
    s_add_u32 m0, s42, 0
    s_add_u32 s6, s45, 0
    buffer_load_dwordx4 v12, s[24:27], s6 offen offset:0 lds
    s_add_u32 s6, s45, 9216
    buffer_load_dwordx4 v13, s[24:27], s6 offen offset:1024 lds
    s_add_u32 s6, s45, 18432
    buffer_load_dwordx4 v12, s[24:27], s6 offen offset:2048 lds
    s_add_u32 s6, s45, 27648
    buffer_load_dwordx4 v13, s[24:27], s6 offen offset:3072 lds
    s_add_u32 m0, s42, 4096
    s_add_u32 s6, s45, 40960
    buffer_load_dwordx4 v12, s[24:27], s6 offen offset:0 lds
    s_add_u32 s6, s45, 50176
    buffer_load_dwordx4 v13, s[24:27], s6 offen offset:1024 lds
    s_add_u32 s6, s45, 59392
    buffer_load_dwordx4 v12, s[24:27], s6 offen offset:2048 lds
    s_add_u32 s6, s45, 68608
    buffer_load_dwordx4 v13, s[24:27], s6 offen offset:3072 lds
    s_mov_b64 exec, -1
    s_add_u32 s45, s45, 128
    s_add_u32 s46, s46, 81920
    s_add_u32 s66, s66, 1
    s_cmp_eq_u32 s66, 10
    s_cselect_b32 s6, 1280, 0
    s_cselect_b32 s46, 0, s46
    s_cselect_b32 s66, 0, s66
    s_sub_u32 s45, s45, s6
    s_mov_b32 s42, 28672
    s_add_u32 m0, s42, 0
    s_add_u32 s6, s45, 0
    buffer_load_dwordx4 v12, s[24:27], s6 offen offset:0 lds
    s_add_u32 s6, s45, 9216
    buffer_load_dwordx4 v13, s[24:27], s6 offen offset:1024 lds
    s_add_u32 s6, s45, 18432
    buffer_load_dwordx4 v12, s[24:27], s6 offen offset:2048 lds
    s_add_u32 s6, s45, 27648
    buffer_load_dwordx4 v13, s[24:27], s6 offen offset:3072 lds
    s_add_u32 m0, s42, 4096
    s_add_u32 s6, s45, 40960
    buffer_load_dwordx4 v12, s[24:27], s6 offen offset:0 lds
    s_add_u32 s6, s45, 50176
    buffer_load_dwordx4 v13, s[24:27], s6 offen offset:1024 lds
    s_add_u32 s6, s45, 59392
    buffer_load_dwordx4 v12, s[24:27], s6 offen offset:2048 lds
    s_add_u32 s6, s45, 68608
    buffer_load_dwordx4 v13, s[24:27], s6 offen offset:3072 lds
    s_mov_b64 exec, -1
    s_add_u32 s45, s45, 128
    s_add_u32 s46, s46, 81920
    s_add_u32 s66, s66, 1
    s_cmp_eq_u32 s66, 10
    s_cselect_b32 s6, 1280, 0
    s_cselect_b32 s46, 0, s46
    s_cselect_b32 s66, 0, s66
    s_sub_u32 s45, s45, s6
    s_waitcnt vmcnt(8)
    s_barrier
    s_mov_b32 s42, 57344
    s_add_u32 m0, s42, 0
    s_add_u32 s6, s45, 0
    buffer_load_dwordx4 v12, s[24:27], s6 offen offset:0 lds
    s_add_u32 s6, s45, 9216
    buffer_load_dwordx4 v13, s[24:27], s6 offen offset:1024 lds
    s_add_u32 s6, s45, 18432
    buffer_load_dwordx4 v12, s[24:27], s6 offen offset:2048 lds
    s_add_u32 s6, s45, 27648
    buffer_load_dwordx4 v13, s[24:27], s6 offen offset:3072 lds
    s_add_u32 m0, s42, 4096
    s_add_u32 s6, s45, 40960
    buffer_load_dwordx4 v12, s[24:27], s6 offen offset:0 lds
    s_add_u32 s6, s45, 50176
    buffer_load_dwordx4 v13, s[24:27], s6 offen offset:1024 lds
    s_add_u32 s6, s45, 59392
    buffer_load_dwordx4 v12, s[24:27], s6 offen offset:2048 lds
    s_add_u32 s6, s45, 68608
    buffer_load_dwordx4 v13, s[24:27], s6 offen offset:3072 lds
    s_mov_b64 exec, -1
    s_add_u32 s45, s45, 128
    s_add_u32 s46, s46, 81920
    s_add_u32 s66, s66, 1
    s_cmp_eq_u32 s66, 10
    s_cselect_b32 s6, 1280, 0
    s_cselect_b32 s46, 0, s46
    s_cselect_b32 s66, 0, s66
    s_sub_u32 s45, s45, s6
    s_mov_b32 s42, 86016
    s_add_u32 m0, s42, 0
    s_add_u32 s6, s45, 0
    buffer_load_dwordx4 v12, s[24:27], s6 offen offset:0 lds
    s_add_u32 s6, s45, 9216
    buffer_load_dwordx4 v13, s[24:27], s6 offen offset:1024 lds
    s_add_u32 s6, s45, 18432
    buffer_load_dwordx4 v12, s[24:27], s6 offen offset:2048 lds
    s_add_u32 s6, s45, 27648
    buffer_load_dwordx4 v13, s[24:27], s6 offen offset:3072 lds
    s_add_u32 m0, s42, 4096
    s_add_u32 s6, s45, 40960
    buffer_load_dwordx4 v12, s[24:27], s6 offen offset:0 lds
    s_add_u32 s6, s45, 50176
    buffer_load_dwordx4 v13, s[24:27], s6 offen offset:1024 lds
    s_add_u32 s6, s45, 59392
    buffer_load_dwordx4 v12, s[24:27], s6 offen offset:2048 lds
    s_add_u32 s6, s45, 68608
    buffer_load_dwordx4 v13, s[24:27], s6 offen offset:3072 lds
    s_mov_b64 exec, -1
    s_add_u32 s45, s45, 128
    s_add_u32 s46, s46, 81920
    s_add_u32 s66, s66, 1
    s_cmp_eq_u32 s66, 10
    s_cselect_b32 s6, 1280, 0
    s_cselect_b32 s46, 0, s46
    s_cselect_b32 s66, 0, s66
    s_sub_u32 s45, s45, s6
    s_mov_b32 s40, 1
    s_mov_b32 s42, 0
k1_kernel_lloop7:
    s_waitcnt vmcnt(16)
    s_barrier
    s_add_u32 m0, s42, 0
    s_add_u32 s6, s45, 0
    buffer_load_dwordx4 v12, s[24:27], s6 offen offset:0 lds
    s_add_u32 s6, s45, 9216
    buffer_load_dwordx4 v13, s[24:27], s6 offen offset:1024 lds
    s_add_u32 s6, s45, 18432
    buffer_load_dwordx4 v12, s[24:27], s6 offen offset:2048 lds
    s_add_u32 s6, s45, 27648
    buffer_load_dwordx4 v13, s[24:27], s6 offen offset:3072 lds
    s_add_u32 m0, s42, 4096
    s_add_u32 s6, s45, 40960
    buffer_load_dwordx4 v12, s[24:27], s6 offen offset:0 lds
    s_add_u32 s6, s45, 50176
    buffer_load_dwordx4 v13, s[24:27], s6 offen offset:1024 lds
    s_add_u32 s6, s45, 59392
    buffer_load_dwordx4 v12, s[24:27], s6 offen offset:2048 lds
    s_add_u32 s6, s45, 68608
    buffer_load_dwordx4 v13, s[24:27], s6 offen offset:3072 lds
    s_mov_b64 exec, -1
    s_add_u32 s45, s45, 128
    s_add_u32 s46, s46, 81920
    s_add_u32 s66, s66, 1
    s_cmp_eq_u32 s66, 10
    s_cselect_b32 s6, 1280, 0
    s_cselect_b32 s46, 0, s46
    s_cselect_b32 s66, 0, s66
    s_sub_u32 s45, s45, s6
    s_add_u32 s42, s42, 28672
    s_cmp_eq_u32 s42, 114688
    s_cselect_b32 s42, 0, s42
    s_add_u32 s40, s40, 1
    s_cmp_lt_u32 s40, 4
    s_cbranch_scc1 k1_kernel_lloop7
k1_kernel_lloop8:
    s_waitcnt vmcnt(16)
    s_barrier
    s_add_u32 m0, s42, 0
    s_add_u32 s6, s45, 0
    buffer_load_dwordx4 v12, s[24:27], s6 offen offset:0 lds
    s_add_u32 s6, s45, 9216
    buffer_load_dwordx4 v13, s[24:27], s6 offen offset:1024 lds
    s_add_u32 s6, s45, 18432
    buffer_load_dwordx4 v12, s[24:27], s6 offen offset:2048 lds
    s_add_u32 s6, s45, 27648
    buffer_load_dwordx4 v13, s[24:27], s6 offen offset:3072 lds
    s_add_u32 m0, s42, 4096
    s_add_u32 s6, s45, 40960
    buffer_load_dwordx4 v12, s[24:27], s6 offen offset:0 lds
    s_add_u32 s6, s45, 50176
    buffer_load_dwordx4 v13, s[24:27], s6 offen offset:1024 lds
    s_add_u32 s6, s45, 59392
    buffer_load_dwordx4 v12, s[24:27], s6 offen offset:2048 lds
    s_add_u32 s6, s45, 68608
    buffer_load_dwordx4 v13, s[24:27], s6 offen offset:3072 lds
    s_mov_b64 exec, -1
    s_add_u32 s45, s45, 128
    s_add_u32 s46, s46, 81920
    s_add_u32 s66, s66, 1
    s_cmp_eq_u32 s66, 10
    s_cselect_b32 s6, 1280, 0
    s_cselect_b32 s46, 0, s46
    s_cselect_b32 s66, 0, s66
    s_sub_u32 s45, s45, s6
    s_add_u32 s42, s42, 28672
    s_cmp_eq_u32 s42, 114688
    s_cselect_b32 s42, 0, s42
    s_add_u32 s40, s40, 1
    s_cmp_lt_u32 s40, 7
    s_cbranch_scc1 k1_kernel_lloop8
    s_add_u32 s67, s2, 0
    s_mov_b32 s73, 1
k1_kernel_j10:
    s_cmp_lt_u32 s67, 120
    s_cbranch_scc0 k1_kernel_j11
    s_mov_b32 s76, s50
    s_mov_b32 s77, s51
    s_mov_b32 s78, 819200
    s_mov_b32 s79, 0x20000
    s_mov_b32 s71, 20513792
    s_mov_b32 s72, 20
    s_mov_b32 s74, 0
    s_mov_b32 s70, 0
    s_mul_i32 s68, s67, 10923
    s_lshr_b32 s68, s68, 16
    s_mul_i32 s6, s68, 6
    s_sub_u32 s69, s67, s6
    s_mov_b32 s8, 1280
    s_branch k1_kernel_jd9
k1_kernel_j11:
    s_cmp_lt_u32 s67, 240
    s_cbranch_scc0 k1_kernel_j12
    s_mov_b32 s76, s56
    s_mov_b32 s77, s57
    s_mov_b32 s78, 819200
    s_mov_b32 s79, 0x20000
    s_mov_b32 s71, 26944512
    s_mov_b32 s72, 76
    s_mov_b32 s74, 1
    s_sub_u32 s67, s67, 120
    s_mov_b32 s70, 0
    s_mul_i32 s68, s67, 10923
    s_lshr_b32 s68, s68, 16
    s_mul_i32 s6, s68, 6
    s_sub_u32 s69, s67, s6
    s_mov_b32 s8, 1280
    s_branch k1_kernel_jd9
k1_kernel_j12:
    s_cmp_lt_u32 s67, 564
    s_cbranch_scc0 k1_kernel_j13
    s_mov_b32 s76, s54
    s_mov_b32 s77, s55
    s_mov_b32 s78, 2211840
    s_mov_b32 s79, 0x20000
    s_mov_b32 s71, 26657792
    s_mov_b32 s72, 76
    s_mov_b32 s74, 2
    s_sub_u32 s67, s67, 240
    s_mov_b32 s70, 0
    s_mul_i32 s68, s67, 10923
    s_lshr_b32 s68, s68, 16
    s_mul_i32 s6, s68, 6
    s_sub_u32 s69, s67, s6
    s_mov_b32 s8, 1280
    s_branch k1_kernel_jd9
k1_kernel_j13:
    s_mov_b32 s76, s52
    s_mov_b32 s77, s53
    s_mov_b32 s78, 2211840
    s_mov_b32 s79, 0x20000
    s_mov_b32 s71, 24364032
    s_mov_b32 s72, 20
    s_mov_b32 s74, 3
    s_sub_u32 s67, s67, 564
    s_cmp_ge_u32 s67, 320
    s_cselect_b32 s73, 0, 1
    s_cselect_b32 s78, 0, s78
    s_mov_b32 s70, 1
    s_lshr_b32 s68, s67, 4
    s_and_b32 s69, s67, 15
    s_mov_b32 s8, 3456
k1_kernel_jd9:
    s_mul_i32 s6, s68, s8
    s_lshl_b32 s6, s6, 5
    s_mul_i32 s7, s69, 224
    s_add_u32 s6, s6, s7
    v_mul_u32_u24 v4, 4682, v1
    v_lshrrev_b32 v4, 16, v4
    v_mul_u32_u24 v5, 14, v4
    v_sub_u32 v5, v1, v5
    v_mul_lo_u32 v4, v4, s8
    v_lshl_add_u32 v18, v5, 4, v4
    s_lshl_b32 s8, s8, 2
    s_mov_b32 exec_lo, -1
    s_mov_b32 exec_hi, 0x00ffffff
    s_mov_b32 m0, 135168
    s_nop 0
    buffer_load_dwordx4 v18, s[76:79], s6 offen lds
    s_add_u32 s6, s6, s8
    s_mov_b32 m0, 136064
    s_nop 0
    buffer_load_dwordx4 v18, s[76:79], s6 offen lds
    s_add_u32 s6, s6, s8
    s_mov_b32 m0, 136960
    s_nop 0
    buffer_load_dwordx4 v18, s[76:79], s6 offen lds
    s_add_u32 s6, s6, s8
    s_mov_b32 m0, 137856
    s_nop 0
    buffer_load_dwordx4 v18, s[76:79], s6 offen lds
    s_add_u32 s6, s6, s8
    s_mov_b32 m0, 138752
    s_nop 0
    buffer_load_dwordx4 v18, s[76:79], s6 offen lds
    s_add_u32 s6, s6, s8
    s_mov_b32 m0, 139648
    s_nop 0
    buffer_load_dwordx4 v18, s[76:79], s6 offen lds
    s_add_u32 s6, s6, s8
    s_mov_b32 m0, 140544
    s_nop 0
    buffer_load_dwordx4 v18, s[76:79], s6 offen lds
    s_add_u32 s6, s6, s8
    s_mov_b32 m0, 141440
    s_nop 0
    buffer_load_dwordx4 v18, s[76:79], s6 offen lds
    s_mov_b64 exec, -1
    s_waitcnt vmcnt(24)
    s_barrier
    s_waitcnt vmcnt(16)
    s_barrier
    s_waitcnt vmcnt(8)
    s_barrier
    s_barrier
    s_waitcnt vmcnt(0)
    s_cmp_eq_u32 s73, 0
    s_cbranch_scc1 k1_kernel_jx14
    v_lshrrev_b32 v4, 4, v1
    v_bfe_u32 v5, v1, 2, 2
    v_lshl_add_u32 v4, v4, 3, v5
    v_and_b32 v5, 3, v1
    v_lshlrev_b32 v5, 3, v5
    v_mul_u32_u24 v4, 224, v4
    v_add_u32 v4, v4, v5
    v_add_u32 v4, 135168, v4
    v_lshlrev_b32 v6, 4, v1
    s_mov_b32 s76, s22
    s_mov_b32 s77, s23
    s_mov_b32 s78, 29815808
    s_mov_b32 s79, 0x20000
    ds_read_b64_tr_b16 v[20:21], v4 offset:0
    ds_read_b64_tr_b16 v[22:23], v4 offset:896
    ds_read_b64_tr_b16 v[24:25], v4 offset:32
    ds_read_b64_tr_b16 v[26:27], v4 offset:928
    ds_read_b64_tr_b16 v[28:29], v4 offset:64
    ds_read_b64_tr_b16 v[30:31], v4 offset:960
    ds_read_b64_tr_b16 v[32:33], v4 offset:96
    ds_read_b64_tr_b16 v[34:35], v4 offset:992
    ds_read_b64_tr_b16 v[36:37], v4 offset:128
    ds_read_b64_tr_b16 v[38:39], v4 offset:1024
    ds_read_b64_tr_b16 v[40:41], v4 offset:160
    ds_read_b64_tr_b16 v[42:43], v4 offset:1056
    ds_read_b64_tr_b16 v[44:45], v4 offset:192
    ds_read_b64_tr_b16 v[46:47], v4 offset:1088
    s_waitcnt lgkmcnt(0)
    s_cmp_eq_u32 s70, 1
    s_cbranch_scc1 k1_kernel_jw315
    s_mul_i32 s6, s69, 7
    s_add_u32 s6, s6, 0
    s_cmp_ge_u32 s6, 40
    s_cbranch_scc1 k1_kernel_js16
    s_mul_i32 s7, s6, 52
    s_lshr_b32 s7, s7, 8
    s_mul_i32 s8, s7, 5
    s_sub_u32 s6, s6, s8
    s_mul_i32 s7, s7, s72
    s_add_u32 s7, s7, s68
    s_mul_i32 s7, s7, 5
    s_add_u32 s7, s7, s6
    s_lshl_b32 s7, s7, 10
    s_add_u32 s7, s7, s71
    buffer_store_dwordx4 v[20:23], v6, s[76:79], s7 offen sc1
k1_kernel_js16:
    s_mul_i32 s6, s69, 7
    s_add_u32 s6, s6, 1
    s_cmp_ge_u32 s6, 40
    s_cbranch_scc1 k1_kernel_js17
    s_mul_i32 s7, s6, 52
    s_lshr_b32 s7, s7, 8
    s_mul_i32 s8, s7, 5
    s_sub_u32 s6, s6, s8
    s_mul_i32 s7, s7, s72
    s_add_u32 s7, s7, s68
    s_mul_i32 s7, s7, 5
    s_add_u32 s7, s7, s6
    s_lshl_b32 s7, s7, 10
    s_add_u32 s7, s7, s71
    buffer_store_dwordx4 v[24:27], v6, s[76:79], s7 offen sc1
k1_kernel_js17:
    s_mul_i32 s6, s69, 7
    s_add_u32 s6, s6, 2
    s_cmp_ge_u32 s6, 40
    s_cbranch_scc1 k1_kernel_js18
    s_mul_i32 s7, s6, 52
    s_lshr_b32 s7, s7, 8
    s_mul_i32 s8, s7, 5
    s_sub_u32 s6, s6, s8
    s_mul_i32 s7, s7, s72
    s_add_u32 s7, s7, s68
    s_mul_i32 s7, s7, 5
    s_add_u32 s7, s7, s6
    s_lshl_b32 s7, s7, 10
    s_add_u32 s7, s7, s71
    buffer_store_dwordx4 v[28:31], v6, s[76:79], s7 offen sc1
k1_kernel_js18:
    s_mul_i32 s6, s69, 7
    s_add_u32 s6, s6, 3
    s_cmp_ge_u32 s6, 40
    s_cbranch_scc1 k1_kernel_js19
    s_mul_i32 s7, s6, 52
    s_lshr_b32 s7, s7, 8
    s_mul_i32 s8, s7, 5
    s_sub_u32 s6, s6, s8
    s_mul_i32 s7, s7, s72
    s_add_u32 s7, s7, s68
    s_mul_i32 s7, s7, 5
    s_add_u32 s7, s7, s6
    s_lshl_b32 s7, s7, 10
    s_add_u32 s7, s7, s71
    buffer_store_dwordx4 v[32:35], v6, s[76:79], s7 offen sc1
k1_kernel_js19:
    s_mul_i32 s6, s69, 7
    s_add_u32 s6, s6, 4
    s_cmp_ge_u32 s6, 40
    s_cbranch_scc1 k1_kernel_js20
    s_mul_i32 s7, s6, 52
    s_lshr_b32 s7, s7, 8
    s_mul_i32 s8, s7, 5
    s_sub_u32 s6, s6, s8
    s_mul_i32 s7, s7, s72
    s_add_u32 s7, s7, s68
    s_mul_i32 s7, s7, 5
    s_add_u32 s7, s7, s6
    s_lshl_b32 s7, s7, 10
    s_add_u32 s7, s7, s71
    buffer_store_dwordx4 v[36:39], v6, s[76:79], s7 offen sc1
k1_kernel_js20:
    s_mul_i32 s6, s69, 7
    s_add_u32 s6, s6, 5
    s_cmp_ge_u32 s6, 40
    s_cbranch_scc1 k1_kernel_js21
    s_mul_i32 s7, s6, 52
    s_lshr_b32 s7, s7, 8
    s_mul_i32 s8, s7, 5
    s_sub_u32 s6, s6, s8
    s_mul_i32 s7, s7, s72
    s_add_u32 s7, s7, s68
    s_mul_i32 s7, s7, 5
    s_add_u32 s7, s7, s6
    s_lshl_b32 s7, s7, 10
    s_add_u32 s7, s7, s71
    buffer_store_dwordx4 v[40:43], v6, s[76:79], s7 offen sc1
k1_kernel_js21:
    s_mul_i32 s6, s69, 7
    s_add_u32 s6, s6, 6
    s_cmp_ge_u32 s6, 40
    s_cbranch_scc1 k1_kernel_js22
    s_mul_i32 s7, s6, 52
    s_lshr_b32 s7, s7, 8
    s_mul_i32 s8, s7, 5
    s_sub_u32 s6, s6, s8
    s_mul_i32 s7, s7, s72
    s_add_u32 s7, s7, s68
    s_mul_i32 s7, s7, 5
    s_add_u32 s7, s7, s6
    s_lshl_b32 s7, s7, 10
    s_add_u32 s7, s7, s71
    buffer_store_dwordx4 v[44:47], v6, s[76:79], s7 offen sc1
k1_kernel_js22:
    s_branch k1_kernel_jx14
k1_kernel_jw315:
    s_mul_i32 s7, s69, 20
    s_add_u32 s7, s7, s68
    s_mul_i32 s7, s7, 7168
    s_add_u32 s7, s7, s71
    buffer_store_dwordx4 v[20:23], v6, s[76:79], s7 offen offset:0 sc1
    buffer_store_dwordx4 v[24:27], v6, s[76:79], s7 offen offset:1024 sc1
    buffer_store_dwordx4 v[28:31], v6, s[76:79], s7 offen offset:2048 sc1
    buffer_store_dwordx4 v[32:35], v6, s[76:79], s7 offen offset:3072 sc1
    s_add_u32 s7, s7, 4096
    buffer_store_dwordx4 v[36:39], v6, s[76:79], s7 offen offset:0 sc1
    buffer_store_dwordx4 v[40:43], v6, s[76:79], s7 offen offset:1024 sc1
    buffer_store_dwordx4 v[44:47], v6, s[76:79], s7 offen offset:2048 sc1
k1_kernel_jx14:
    s_branch k1_kernel_end
k1_kernel_ld4:
    s_mov_b32 s42, 0
    s_mov_b64 exec, s[62:63]
    s_add_u32 m0, s42, 8192
    s_add_u32 s6, s46, 0
    buffer_load_dwordx4 v14, s[28:31], s6 offen offset:0 lds
    buffer_load_dwordx4 v15, s[28:31], s6 offen offset:960 lds
    buffer_load_dwordx4 v16, s[28:31], s6 offen offset:1920 lds
    buffer_load_dwordx4 v17, s[28:31], s6 offen offset:2880 lds
    s_mov_b64 exec, s[62:63]
    s_add_u32 m0, s42, 18432
    s_add_u32 s6, s46, 160
    buffer_load_dwordx4 v14, s[28:31], s6 offen offset:0 lds
    buffer_load_dwordx4 v15, s[28:31], s6 offen offset:960 lds
    buffer_load_dwordx4 v16, s[28:31], s6 offen offset:1920 lds
    buffer_load_dwordx4 v17, s[28:31], s6 offen offset:2880 lds
    s_mov_b64 exec, -1
    s_add_u32 s45, s45, 128
    s_add_u32 s46, s46, 81920
    s_add_u32 s66, s66, 1
    s_cmp_eq_u32 s66, 10
    s_cselect_b32 s6, 1280, 0
    s_cselect_b32 s46, 0, s46
    s_cselect_b32 s66, 0, s66
    s_sub_u32 s45, s45, s6
    s_mov_b32 s42, 28672
    s_mov_b64 exec, s[62:63]
    s_add_u32 m0, s42, 8192
    s_add_u32 s6, s46, 0
    buffer_load_dwordx4 v14, s[28:31], s6 offen offset:0 lds
    buffer_load_dwordx4 v15, s[28:31], s6 offen offset:960 lds
    buffer_load_dwordx4 v16, s[28:31], s6 offen offset:1920 lds
    buffer_load_dwordx4 v17, s[28:31], s6 offen offset:2880 lds
    s_mov_b64 exec, s[62:63]
    s_add_u32 m0, s42, 18432
    s_add_u32 s6, s46, 160
    buffer_load_dwordx4 v14, s[28:31], s6 offen offset:0 lds
    buffer_load_dwordx4 v15, s[28:31], s6 offen offset:960 lds
    buffer_load_dwordx4 v16, s[28:31], s6 offen offset:1920 lds
    buffer_load_dwordx4 v17, s[28:31], s6 offen offset:2880 lds
    s_mov_b64 exec, -1
    s_add_u32 s45, s45, 128
    s_add_u32 s46, s46, 81920
    s_add_u32 s66, s66, 1
    s_cmp_eq_u32 s66, 10
    s_cselect_b32 s6, 1280, 0
    s_cselect_b32 s46, 0, s46
    s_cselect_b32 s66, 0, s66
    s_sub_u32 s45, s45, s6
    s_waitcnt vmcnt(8)
    s_barrier
    s_mov_b32 s42, 57344
    s_mov_b64 exec, s[62:63]
    s_add_u32 m0, s42, 8192
    s_add_u32 s6, s46, 0
    buffer_load_dwordx4 v14, s[28:31], s6 offen offset:0 lds
    buffer_load_dwordx4 v15, s[28:31], s6 offen offset:960 lds
    buffer_load_dwordx4 v16, s[28:31], s6 offen offset:1920 lds
    buffer_load_dwordx4 v17, s[28:31], s6 offen offset:2880 lds
    s_mov_b64 exec, s[62:63]
    s_add_u32 m0, s42, 18432
    s_add_u32 s6, s46, 160
    buffer_load_dwordx4 v14, s[28:31], s6 offen offset:0 lds
    buffer_load_dwordx4 v15, s[28:31], s6 offen offset:960 lds
    buffer_load_dwordx4 v16, s[28:31], s6 offen offset:1920 lds
    buffer_load_dwordx4 v17, s[28:31], s6 offen offset:2880 lds
    s_mov_b64 exec, -1
    s_add_u32 s45, s45, 128
    s_add_u32 s46, s46, 81920
    s_add_u32 s66, s66, 1
    s_cmp_eq_u32 s66, 10
    s_cselect_b32 s6, 1280, 0
    s_cselect_b32 s46, 0, s46
    s_cselect_b32 s66, 0, s66
    s_sub_u32 s45, s45, s6
    s_mov_b32 s42, 86016
    s_mov_b64 exec, s[62:63]
    s_add_u32 m0, s42, 8192
    s_add_u32 s6, s46, 0
    buffer_load_dwordx4 v14, s[28:31], s6 offen offset:0 lds
    buffer_load_dwordx4 v15, s[28:31], s6 offen offset:960 lds
    buffer_load_dwordx4 v16, s[28:31], s6 offen offset:1920 lds
    buffer_load_dwordx4 v17, s[28:31], s6 offen offset:2880 lds
    s_mov_b64 exec, s[62:63]
    s_add_u32 m0, s42, 18432
    s_add_u32 s6, s46, 160
    buffer_load_dwordx4 v14, s[28:31], s6 offen offset:0 lds
    buffer_load_dwordx4 v15, s[28:31], s6 offen offset:960 lds
    buffer_load_dwordx4 v16, s[28:31], s6 offen offset:1920 lds
    buffer_load_dwordx4 v17, s[28:31], s6 offen offset:2880 lds
    s_mov_b64 exec, -1
    s_add_u32 s45, s45, 128
    s_add_u32 s46, s46, 81920
    s_add_u32 s66, s66, 1
    s_cmp_eq_u32 s66, 10
    s_cselect_b32 s6, 1280, 0
    s_cselect_b32 s46, 0, s46
    s_cselect_b32 s66, 0, s66
    s_sub_u32 s45, s45, s6
    s_mov_b32 s40, 1
    s_mov_b32 s42, 0
k1_kernel_lloop23:
    s_waitcnt vmcnt(16)
    s_barrier
    s_mov_b64 exec, s[62:63]
    s_add_u32 m0, s42, 8192
    s_add_u32 s6, s46, 0
    buffer_load_dwordx4 v14, s[28:31], s6 offen offset:0 lds
    buffer_load_dwordx4 v15, s[28:31], s6 offen offset:960 lds
    buffer_load_dwordx4 v16, s[28:31], s6 offen offset:1920 lds
    buffer_load_dwordx4 v17, s[28:31], s6 offen offset:2880 lds
    s_mov_b64 exec, s[62:63]
    s_add_u32 m0, s42, 18432
    s_add_u32 s6, s46, 160
    buffer_load_dwordx4 v14, s[28:31], s6 offen offset:0 lds
    buffer_load_dwordx4 v15, s[28:31], s6 offen offset:960 lds
    buffer_load_dwordx4 v16, s[28:31], s6 offen offset:1920 lds
    buffer_load_dwordx4 v17, s[28:31], s6 offen offset:2880 lds
    s_mov_b64 exec, -1
    s_add_u32 s45, s45, 128
    s_add_u32 s46, s46, 81920
    s_add_u32 s66, s66, 1
    s_cmp_eq_u32 s66, 10
    s_cselect_b32 s6, 1280, 0
    s_cselect_b32 s46, 0, s46
    s_cselect_b32 s66, 0, s66
    s_sub_u32 s45, s45, s6
    s_add_u32 s42, s42, 28672
    s_cmp_eq_u32 s42, 114688
    s_cselect_b32 s42, 0, s42
    s_add_u32 s40, s40, 1
    s_cmp_lt_u32 s40, 4
    s_cbranch_scc1 k1_kernel_lloop23
k1_kernel_lloop24:
    s_waitcnt vmcnt(16)
    s_barrier
    s_mov_b64 exec, s[62:63]
    s_add_u32 m0, s42, 8192
    s_add_u32 s6, s46, 0
    buffer_load_dwordx4 v14, s[28:31], s6 offen offset:0 lds
    buffer_load_dwordx4 v15, s[28:31], s6 offen offset:960 lds
    buffer_load_dwordx4 v16, s[28:31], s6 offen offset:1920 lds
    buffer_load_dwordx4 v17, s[28:31], s6 offen offset:2880 lds
    s_mov_b64 exec, s[62:63]
    s_add_u32 m0, s42, 18432
    s_add_u32 s6, s46, 160
    buffer_load_dwordx4 v14, s[28:31], s6 offen offset:0 lds
    buffer_load_dwordx4 v15, s[28:31], s6 offen offset:960 lds
    buffer_load_dwordx4 v16, s[28:31], s6 offen offset:1920 lds
    buffer_load_dwordx4 v17, s[28:31], s6 offen offset:2880 lds
    s_mov_b64 exec, -1
    s_add_u32 s45, s45, 128
    s_add_u32 s46, s46, 81920
    s_add_u32 s66, s66, 1
    s_cmp_eq_u32 s66, 10
    s_cselect_b32 s6, 1280, 0
    s_cselect_b32 s46, 0, s46
    s_cselect_b32 s66, 0, s66
    s_sub_u32 s45, s45, s6
    s_add_u32 s42, s42, 28672
    s_cmp_eq_u32 s42, 114688
    s_cselect_b32 s42, 0, s42
    s_add_u32 s40, s40, 1
    s_cmp_lt_u32 s40, 7
    s_cbranch_scc1 k1_kernel_lloop24
    s_add_u32 s67, s2, 256
    s_mov_b32 s73, 1
k1_kernel_j26:
    s_cmp_lt_u32 s67, 120
    s_cbranch_scc0 k1_kernel_j27
    s_mov_b32 s76, s50
    s_mov_b32 s77, s51
    s_mov_b32 s78, 819200
    s_mov_b32 s79, 0x20000
    s_mov_b32 s71, 20513792
    s_mov_b32 s72, 20
    s_mov_b32 s74, 0
    s_mov_b32 s70, 0
    s_mul_i32 s68, s67, 10923
    s_lshr_b32 s68, s68, 16
    s_mul_i32 s6, s68, 6
    s_sub_u32 s69, s67, s6
    s_mov_b32 s8, 1280
    s_branch k1_kernel_jd25
k1_kernel_j27:
    s_cmp_lt_u32 s67, 240
    s_cbranch_scc0 k1_kernel_j28
    s_mov_b32 s76, s56
    s_mov_b32 s77, s57
    s_mov_b32 s78, 819200
    s_mov_b32 s79, 0x20000
    s_mov_b32 s71, 26944512
    s_mov_b32 s72, 76
    s_mov_b32 s74, 1
    s_sub_u32 s67, s67, 120
    s_mov_b32 s70, 0
    s_mul_i32 s68, s67, 10923
    s_lshr_b32 s68, s68, 16
    s_mul_i32 s6, s68, 6
    s_sub_u32 s69, s67, s6
    s_mov_b32 s8, 1280
    s_branch k1_kernel_jd25
k1_kernel_j28:
    s_cmp_lt_u32 s67, 564
    s_cbranch_scc0 k1_kernel_j29
    s_mov_b32 s76, s54
    s_mov_b32 s77, s55
    s_mov_b32 s78, 2211840
    s_mov_b32 s79, 0x20000
    s_mov_b32 s71, 26657792
    s_mov_b32 s72, 76
    s_mov_b32 s74, 2
    s_sub_u32 s67, s67, 240
    s_mov_b32 s70, 0
    s_mul_i32 s68, s67, 10923
    s_lshr_b32 s68, s68, 16
    s_mul_i32 s6, s68, 6
    s_sub_u32 s69, s67, s6
    s_mov_b32 s8, 1280
    s_branch k1_kernel_jd25
k1_kernel_j29:
    s_mov_b32 s76, s52
    s_mov_b32 s77, s53
    s_mov_b32 s78, 2211840
    s_mov_b32 s79, 0x20000
    s_mov_b32 s71, 24364032
    s_mov_b32 s72, 20
    s_mov_b32 s74, 3
    s_sub_u32 s67, s67, 564
    s_cmp_ge_u32 s67, 320
    s_cselect_b32 s73, 0, 1
    s_cselect_b32 s78, 0, s78
    s_mov_b32 s70, 1
    s_lshr_b32 s68, s67, 4
    s_and_b32 s69, s67, 15
    s_mov_b32 s8, 3456
k1_kernel_jd25:
    s_mul_i32 s6, s68, s8
    s_lshl_b32 s6, s6, 5
    s_mul_i32 s7, s69, 224
    s_add_u32 s6, s6, s7
    v_mul_u32_u24 v4, 4682, v1
    v_lshrrev_b32 v4, 16, v4
    v_mul_u32_u24 v5, 14, v4
    v_sub_u32 v5, v1, v5
    v_mul_lo_u32 v4, v4, s8
    v_lshl_add_u32 v18, v5, 4, v4
    s_lshl_b32 s8, s8, 2
    s_mov_b32 exec_lo, -1
    s_mov_b32 exec_hi, 0x00ffffff
    s_mov_b32 m0, 142336
    s_nop 0
    buffer_load_dwordx4 v18, s[76:79], s6 offen lds
    s_add_u32 s6, s6, s8
    s_mov_b32 m0, 143232
    s_nop 0
    buffer_load_dwordx4 v18, s[76:79], s6 offen lds
    s_add_u32 s6, s6, s8
    s_mov_b32 m0, 144128
    s_nop 0
    buffer_load_dwordx4 v18, s[76:79], s6 offen lds
    s_add_u32 s6, s6, s8
    s_mov_b32 m0, 145024
    s_nop 0
    buffer_load_dwordx4 v18, s[76:79], s6 offen lds
    s_add_u32 s6, s6, s8
    s_mov_b32 m0, 145920
    s_nop 0
    buffer_load_dwordx4 v18, s[76:79], s6 offen lds
    s_add_u32 s6, s6, s8
    s_mov_b32 m0, 146816
    s_nop 0
    buffer_load_dwordx4 v18, s[76:79], s6 offen lds
    s_add_u32 s6, s6, s8
    s_mov_b32 m0, 147712
    s_nop 0
    buffer_load_dwordx4 v18, s[76:79], s6 offen lds
    s_add_u32 s6, s6, s8
    s_mov_b32 m0, 148608
    s_nop 0
    buffer_load_dwordx4 v18, s[76:79], s6 offen lds
    s_mov_b64 exec, -1
    s_waitcnt vmcnt(24)
    s_barrier
    s_waitcnt vmcnt(16)
    s_barrier
    s_waitcnt vmcnt(8)
    s_barrier
    s_barrier
    s_waitcnt vmcnt(0)
    s_cmp_eq_u32 s73, 0
    s_cbranch_scc1 k1_kernel_jx30
    v_lshrrev_b32 v4, 4, v1
    v_bfe_u32 v5, v1, 2, 2
    v_lshl_add_u32 v4, v4, 3, v5
    v_and_b32 v5, 3, v1
    v_lshlrev_b32 v5, 3, v5
    v_mul_u32_u24 v4, 224, v4
    v_add_u32 v4, v4, v5
    v_add_u32 v4, 142336, v4
    v_lshlrev_b32 v6, 4, v1
    s_mov_b32 s76, s22
    s_mov_b32 s77, s23
    s_mov_b32 s78, 29815808
    s_mov_b32 s79, 0x20000
    ds_read_b64_tr_b16 v[20:21], v4 offset:0
    ds_read_b64_tr_b16 v[22:23], v4 offset:896
    ds_read_b64_tr_b16 v[24:25], v4 offset:32
    ds_read_b64_tr_b16 v[26:27], v4 offset:928
    ds_read_b64_tr_b16 v[28:29], v4 offset:64
    ds_read_b64_tr_b16 v[30:31], v4 offset:960
    ds_read_b64_tr_b16 v[32:33], v4 offset:96
    ds_read_b64_tr_b16 v[34:35], v4 offset:992
    ds_read_b64_tr_b16 v[36:37], v4 offset:128
    ds_read_b64_tr_b16 v[38:39], v4 offset:1024
    ds_read_b64_tr_b16 v[40:41], v4 offset:160
    ds_read_b64_tr_b16 v[42:43], v4 offset:1056
    ds_read_b64_tr_b16 v[44:45], v4 offset:192
    ds_read_b64_tr_b16 v[46:47], v4 offset:1088
    s_waitcnt lgkmcnt(0)
    s_cmp_eq_u32 s70, 1
    s_cbranch_scc1 k1_kernel_jw331
    s_mul_i32 s6, s69, 7
    s_add_u32 s6, s6, 0
    s_cmp_ge_u32 s6, 40
    s_cbranch_scc1 k1_kernel_js32
    s_mul_i32 s7, s6, 52
    s_lshr_b32 s7, s7, 8
    s_mul_i32 s8, s7, 5
    s_sub_u32 s6, s6, s8
    s_mul_i32 s7, s7, s72
    s_add_u32 s7, s7, s68
    s_mul_i32 s7, s7, 5
    s_add_u32 s7, s7, s6
    s_lshl_b32 s7, s7, 10
    s_add_u32 s7, s7, s71
    buffer_store_dwordx4 v[20:23], v6, s[76:79], s7 offen sc1
k1_kernel_js32:
    s_mul_i32 s6, s69, 7
    s_add_u32 s6, s6, 1
    s_cmp_ge_u32 s6, 40
    s_cbranch_scc1 k1_kernel_js33
    s_mul_i32 s7, s6, 52
    s_lshr_b32 s7, s7, 8
    s_mul_i32 s8, s7, 5
    s_sub_u32 s6, s6, s8
    s_mul_i32 s7, s7, s72
    s_add_u32 s7, s7, s68
    s_mul_i32 s7, s7, 5
    s_add_u32 s7, s7, s6
    s_lshl_b32 s7, s7, 10
    s_add_u32 s7, s7, s71
    buffer_store_dwordx4 v[24:27], v6, s[76:79], s7 offen sc1
k1_kernel_js33:
    s_mul_i32 s6, s69, 7
    s_add_u32 s6, s6, 2
    s_cmp_ge_u32 s6, 40
    s_cbranch_scc1 k1_kernel_js34
    s_mul_i32 s7, s6, 52
    s_lshr_b32 s7, s7, 8
    s_mul_i32 s8, s7, 5
    s_sub_u32 s6, s6, s8
    s_mul_i32 s7, s7, s72
    s_add_u32 s7, s7, s68
    s_mul_i32 s7, s7, 5
    s_add_u32 s7, s7, s6
    s_lshl_b32 s7, s7, 10
    s_add_u32 s7, s7, s71
    buffer_store_dwordx4 v[28:31], v6, s[76:79], s7 offen sc1
k1_kernel_js34:
    s_mul_i32 s6, s69, 7
    s_add_u32 s6, s6, 3
    s_cmp_ge_u32 s6, 40
    s_cbranch_scc1 k1_kernel_js35
    s_mul_i32 s7, s6, 52
    s_lshr_b32 s7, s7, 8
    s_mul_i32 s8, s7, 5
    s_sub_u32 s6, s6, s8
    s_mul_i32 s7, s7, s72
    s_add_u32 s7, s7, s68
    s_mul_i32 s7, s7, 5
    s_add_u32 s7, s7, s6
    s_lshl_b32 s7, s7, 10
    s_add_u32 s7, s7, s71
    buffer_store_dwordx4 v[32:35], v6, s[76:79], s7 offen sc1
k1_kernel_js35:
    s_mul_i32 s6, s69, 7
    s_add_u32 s6, s6, 4
    s_cmp_ge_u32 s6, 40
    s_cbranch_scc1 k1_kernel_js36
    s_mul_i32 s7, s6, 52
    s_lshr_b32 s7, s7, 8
    s_mul_i32 s8, s7, 5
    s_sub_u32 s6, s6, s8
    s_mul_i32 s7, s7, s72
    s_add_u32 s7, s7, s68
    s_mul_i32 s7, s7, 5
    s_add_u32 s7, s7, s6
    s_lshl_b32 s7, s7, 10
    s_add_u32 s7, s7, s71
    buffer_store_dwordx4 v[36:39], v6, s[76:79], s7 offen sc1
k1_kernel_js36:
    s_mul_i32 s6, s69, 7
    s_add_u32 s6, s6, 5
    s_cmp_ge_u32 s6, 40
    s_cbranch_scc1 k1_kernel_js37
    s_mul_i32 s7, s6, 52
    s_lshr_b32 s7, s7, 8
    s_mul_i32 s8, s7, 5
    s_sub_u32 s6, s6, s8
    s_mul_i32 s7, s7, s72
    s_add_u32 s7, s7, s68
    s_mul_i32 s7, s7, 5
    s_add_u32 s7, s7, s6
    s_lshl_b32 s7, s7, 10
    s_add_u32 s7, s7, s71
    buffer_store_dwordx4 v[40:43], v6, s[76:79], s7 offen sc1
k1_kernel_js37:
    s_mul_i32 s6, s69, 7
    s_add_u32 s6, s6, 6
    s_cmp_ge_u32 s6, 40
    s_cbranch_scc1 k1_kernel_js38
    s_mul_i32 s7, s6, 52
    s_lshr_b32 s7, s7, 8
    s_mul_i32 s8, s7, 5
    s_sub_u32 s6, s6, s8
    s_mul_i32 s7, s7, s72
    s_add_u32 s7, s7, s68
    s_mul_i32 s7, s7, 5
    s_add_u32 s7, s7, s6
    s_lshl_b32 s7, s7, 10
    s_add_u32 s7, s7, s71
    buffer_store_dwordx4 v[44:47], v6, s[76:79], s7 offen sc1
k1_kernel_js38:
    s_branch k1_kernel_jx30
k1_kernel_jw331:
    s_mul_i32 s7, s69, 20
    s_add_u32 s7, s7, s68
    s_mul_i32 s7, s7, 7168
    s_add_u32 s7, s7, s71
    buffer_store_dwordx4 v[20:23], v6, s[76:79], s7 offen offset:0 sc1
    buffer_store_dwordx4 v[24:27], v6, s[76:79], s7 offen offset:1024 sc1
    buffer_store_dwordx4 v[28:31], v6, s[76:79], s7 offen offset:2048 sc1
    buffer_store_dwordx4 v[32:35], v6, s[76:79], s7 offen offset:3072 sc1
    s_add_u32 s7, s7, 4096
    buffer_store_dwordx4 v[36:39], v6, s[76:79], s7 offen offset:0 sc1
    buffer_store_dwordx4 v[40:43], v6, s[76:79], s7 offen offset:1024 sc1
    buffer_store_dwordx4 v[44:47], v6, s[76:79], s7 offen offset:2048 sc1
k1_kernel_jx30:
    s_branch k1_kernel_end
k1_kernel_ld5:
    s_mov_b32 s42, 0
    s_mov_b64 exec, s[62:63]
    s_add_u32 m0, s42, 12032
    s_add_u32 s6, s46, 30720
    buffer_load_dwordx4 v14, s[28:31], s6 offen offset:0 lds
    buffer_load_dwordx4 v15, s[28:31], s6 offen offset:960 lds
    buffer_load_dwordx4 v16, s[28:31], s6 offen offset:1920 lds
    buffer_load_dwordx4 v17, s[28:31], s6 offen offset:2880 lds
    s_mov_b64 exec, s[62:63]
    s_add_u32 m0, s42, 22272
    s_add_u32 s6, s46, 30880
    buffer_load_dwordx4 v14, s[28:31], s6 offen offset:0 lds
    buffer_load_dwordx4 v15, s[28:31], s6 offen offset:960 lds
    buffer_load_dwordx4 v16, s[28:31], s6 offen offset:1920 lds
    buffer_load_dwordx4 v17, s[28:31], s6 offen offset:2880 lds
    s_mov_b64 exec, -1
    s_add_u32 s45, s45, 128
    s_add_u32 s46, s46, 81920
    s_add_u32 s66, s66, 1
    s_cmp_eq_u32 s66, 10
    s_cselect_b32 s6, 1280, 0
    s_cselect_b32 s46, 0, s46
    s_cselect_b32 s66, 0, s66
    s_sub_u32 s45, s45, s6
    s_mov_b32 s42, 28672
    s_mov_b64 exec, s[62:63]
    s_add_u32 m0, s42, 12032
    s_add_u32 s6, s46, 30720
    buffer_load_dwordx4 v14, s[28:31], s6 offen offset:0 lds
    buffer_load_dwordx4 v15, s[28:31], s6 offen offset:960 lds
    buffer_load_dwordx4 v16, s[28:31], s6 offen offset:1920 lds
    buffer_load_dwordx4 v17, s[28:31], s6 offen offset:2880 lds
    s_mov_b64 exec, s[62:63]
    s_add_u32 m0, s42, 22272
    s_add_u32 s6, s46, 30880
    buffer_load_dwordx4 v14, s[28:31], s6 offen offset:0 lds
    buffer_load_dwordx4 v15, s[28:31], s6 offen offset:960 lds
    buffer_load_dwordx4 v16, s[28:31], s6 offen offset:1920 lds
    buffer_load_dwordx4 v17, s[28:31], s6 offen offset:2880 lds
    s_mov_b64 exec, -1
    s_add_u32 s45, s45, 128
    s_add_u32 s46, s46, 81920
    s_add_u32 s66, s66, 1
    s_cmp_eq_u32 s66, 10
    s_cselect_b32 s6, 1280, 0
    s_cselect_b32 s46, 0, s46
    s_cselect_b32 s66, 0, s66
    s_sub_u32 s45, s45, s6
    s_waitcnt vmcnt(8)
    s_barrier
    s_mov_b32 s42, 57344
    s_mov_b64 exec, s[62:63]
    s_add_u32 m0, s42, 12032
    s_add_u32 s6, s46, 30720
    buffer_load_dwordx4 v14, s[28:31], s6 offen offset:0 lds
    buffer_load_dwordx4 v15, s[28:31], s6 offen offset:960 lds
    buffer_load_dwordx4 v16, s[28:31], s6 offen offset:1920 lds
    buffer_load_dwordx4 v17, s[28:31], s6 offen offset:2880 lds
    s_mov_b64 exec, s[62:63]
    s_add_u32 m0, s42, 22272
    s_add_u32 s6, s46, 30880
    buffer_load_dwordx4 v14, s[28:31], s6 offen offset:0 lds
    buffer_load_dwordx4 v15, s[28:31], s6 offen offset:960 lds
    buffer_load_dwordx4 v16, s[28:31], s6 offen offset:1920 lds
    buffer_load_dwordx4 v17, s[28:31], s6 offen offset:2880 lds
    s_mov_b64 exec, -1
    s_add_u32 s45, s45, 128
    s_add_u32 s46, s46, 81920
    s_add_u32 s66, s66, 1
    s_cmp_eq_u32 s66, 10
    s_cselect_b32 s6, 1280, 0
    s_cselect_b32 s46, 0, s46
    s_cselect_b32 s66, 0, s66
    s_sub_u32 s45, s45, s6
    s_mov_b32 s42, 86016
    s_mov_b64 exec, s[62:63]
    s_add_u32 m0, s42, 12032
    s_add_u32 s6, s46, 30720
    buffer_load_dwordx4 v14, s[28:31], s6 offen offset:0 lds
    buffer_load_dwordx4 v15, s[28:31], s6 offen offset:960 lds
    buffer_load_dwordx4 v16, s[28:31], s6 offen offset:1920 lds
    buffer_load_dwordx4 v17, s[28:31], s6 offen offset:2880 lds
    s_mov_b64 exec, s[62:63]
    s_add_u32 m0, s42, 22272
    s_add_u32 s6, s46, 30880
    buffer_load_dwordx4 v14, s[28:31], s6 offen offset:0 lds
    buffer_load_dwordx4 v15, s[28:31], s6 offen offset:960 lds
    buffer_load_dwordx4 v16, s[28:31], s6 offen offset:1920 lds
    buffer_load_dwordx4 v17, s[28:31], s6 offen offset:2880 lds
    s_mov_b64 exec, -1
    s_add_u32 s45, s45, 128
    s_add_u32 s46, s46, 81920
    s_add_u32 s66, s66, 1
    s_cmp_eq_u32 s66, 10
    s_cselect_b32 s6, 1280, 0
    s_cselect_b32 s46, 0, s46
    s_cselect_b32 s66, 0, s66
    s_sub_u32 s45, s45, s6
    s_mov_b32 s40, 1
    s_mov_b32 s42, 0
k1_kernel_lloop39:
    s_waitcnt vmcnt(16)
    s_barrier
    s_mov_b64 exec, s[62:63]
    s_add_u32 m0, s42, 12032
    s_add_u32 s6, s46, 30720
    buffer_load_dwordx4 v14, s[28:31], s6 offen offset:0 lds
    buffer_load_dwordx4 v15, s[28:31], s6 offen offset:960 lds
    buffer_load_dwordx4 v16, s[28:31], s6 offen offset:1920 lds
    buffer_load_dwordx4 v17, s[28:31], s6 offen offset:2880 lds
    s_mov_b64 exec, s[62:63]
    s_add_u32 m0, s42, 22272
    s_add_u32 s6, s46, 30880
    buffer_load_dwordx4 v14, s[28:31], s6 offen offset:0 lds
    buffer_load_dwordx4 v15, s[28:31], s6 offen offset:960 lds
    buffer_load_dwordx4 v16, s[28:31], s6 offen offset:1920 lds
    buffer_load_dwordx4 v17, s[28:31], s6 offen offset:2880 lds
    s_mov_b64 exec, -1
    s_add_u32 s45, s45, 128
    s_add_u32 s46, s46, 81920
    s_add_u32 s66, s66, 1
    s_cmp_eq_u32 s66, 10
    s_cselect_b32 s6, 1280, 0
    s_cselect_b32 s46, 0, s46
    s_cselect_b32 s66, 0, s66
    s_sub_u32 s45, s45, s6
    s_add_u32 s42, s42, 28672
    s_cmp_eq_u32 s42, 114688
    s_cselect_b32 s42, 0, s42
    s_add_u32 s40, s40, 1
    s_cmp_lt_u32 s40, 4
    s_cbranch_scc1 k1_kernel_lloop39
k1_kernel_lloop40:
    s_waitcnt vmcnt(16)
    s_barrier
    s_mov_b64 exec, s[62:63]
    s_add_u32 m0, s42, 12032
    s_add_u32 s6, s46, 30720
    buffer_load_dwordx4 v14, s[28:31], s6 offen offset:0 lds
    buffer_load_dwordx4 v15, s[28:31], s6 offen offset:960 lds
    buffer_load_dwordx4 v16, s[28:31], s6 offen offset:1920 lds
    buffer_load_dwordx4 v17, s[28:31], s6 offen offset:2880 lds
    s_mov_b64 exec, s[62:63]
    s_add_u32 m0, s42, 22272
    s_add_u32 s6, s46, 30880
    buffer_load_dwordx4 v14, s[28:31], s6 offen offset:0 lds
    buffer_load_dwordx4 v15, s[28:31], s6 offen offset:960 lds
    buffer_load_dwordx4 v16, s[28:31], s6 offen offset:1920 lds
    buffer_load_dwordx4 v17, s[28:31], s6 offen offset:2880 lds
    s_mov_b64 exec, -1
    s_add_u32 s45, s45, 128
    s_add_u32 s46, s46, 81920
    s_add_u32 s66, s66, 1
    s_cmp_eq_u32 s66, 10
    s_cselect_b32 s6, 1280, 0
    s_cselect_b32 s46, 0, s46
    s_cselect_b32 s66, 0, s66
    s_sub_u32 s45, s45, s6
    s_add_u32 s42, s42, 28672
    s_cmp_eq_u32 s42, 114688
    s_cselect_b32 s42, 0, s42
    s_add_u32 s40, s40, 1
    s_cmp_lt_u32 s40, 7
    s_cbranch_scc1 k1_kernel_lloop40
    s_add_u32 s67, s2, 512
    s_mov_b32 s73, 1
k1_kernel_j42:
    s_cmp_lt_u32 s67, 120
    s_cbranch_scc0 k1_kernel_j43
    s_mov_b32 s76, s50
    s_mov_b32 s77, s51
    s_mov_b32 s78, 819200
    s_mov_b32 s79, 0x20000
    s_mov_b32 s71, 20513792
    s_mov_b32 s72, 20
    s_mov_b32 s74, 0
    s_mov_b32 s70, 0
    s_mul_i32 s68, s67, 10923
    s_lshr_b32 s68, s68, 16
    s_mul_i32 s6, s68, 6
    s_sub_u32 s69, s67, s6
    s_mov_b32 s8, 1280
    s_branch k1_kernel_jd41
k1_kernel_j43:
    s_cmp_lt_u32 s67, 240
    s_cbranch_scc0 k1_kernel_j44
    s_mov_b32 s76, s56
    s_mov_b32 s77, s57
    s_mov_b32 s78, 819200
    s_mov_b32 s79, 0x20000
    s_mov_b32 s71, 26944512
    s_mov_b32 s72, 76
    s_mov_b32 s74, 1
    s_sub_u32 s67, s67, 120
    s_mov_b32 s70, 0
    s_mul_i32 s68, s67, 10923
    s_lshr_b32 s68, s68, 16
    s_mul_i32 s6, s68, 6
    s_sub_u32 s69, s67, s6
    s_mov_b32 s8, 1280
    s_branch k1_kernel_jd41
k1_kernel_j44:
    s_cmp_lt_u32 s67, 564
    s_cbranch_scc0 k1_kernel_j45
    s_mov_b32 s76, s54
    s_mov_b32 s77, s55
    s_mov_b32 s78, 2211840
    s_mov_b32 s79, 0x20000
    s_mov_b32 s71, 26657792
    s_mov_b32 s72, 76
    s_mov_b32 s74, 2
    s_sub_u32 s67, s67, 240
    s_mov_b32 s70, 0
    s_mul_i32 s68, s67, 10923
    s_lshr_b32 s68, s68, 16
    s_mul_i32 s6, s68, 6
    s_sub_u32 s69, s67, s6
    s_mov_b32 s8, 1280
    s_branch k1_kernel_jd41
k1_kernel_j45:
    s_mov_b32 s76, s52
    s_mov_b32 s77, s53
    s_mov_b32 s78, 2211840
    s_mov_b32 s79, 0x20000
    s_mov_b32 s71, 24364032
    s_mov_b32 s72, 20
    s_mov_b32 s74, 3
    s_sub_u32 s67, s67, 564
    s_cmp_ge_u32 s67, 320
    s_cselect_b32 s73, 0, 1
    s_cselect_b32 s78, 0, s78
    s_mov_b32 s70, 1
    s_lshr_b32 s68, s67, 4
    s_and_b32 s69, s67, 15
    s_mov_b32 s8, 3456
k1_kernel_jd41:
    s_mul_i32 s6, s68, s8
    s_lshl_b32 s6, s6, 5
    s_mul_i32 s7, s69, 224
    s_add_u32 s6, s6, s7
    v_mul_u32_u24 v4, 4682, v1
    v_lshrrev_b32 v4, 16, v4
    v_mul_u32_u24 v5, 14, v4
    v_sub_u32 v5, v1, v5
    v_mul_lo_u32 v4, v4, s8
    v_lshl_add_u32 v18, v5, 4, v4
    s_lshl_b32 s8, s8, 2
    s_mov_b32 exec_lo, -1
    s_mov_b32 exec_hi, 0x00ffffff
    s_mov_b32 m0, 149504
    s_nop 0
    buffer_load_dwordx4 v18, s[76:79], s6 offen lds
    s_add_u32 s6, s6, s8
    s_mov_b32 m0, 150400
    s_nop 0
    buffer_load_dwordx4 v18, s[76:79], s6 offen lds
    s_add_u32 s6, s6, s8
    s_mov_b32 m0, 151296
    s_nop 0
    buffer_load_dwordx4 v18, s[76:79], s6 offen lds
    s_add_u32 s6, s6, s8
    s_mov_b32 m0, 152192
    s_nop 0
    buffer_load_dwordx4 v18, s[76:79], s6 offen lds
    s_add_u32 s6, s6, s8
    s_mov_b32 m0, 153088
    s_nop 0
    buffer_load_dwordx4 v18, s[76:79], s6 offen lds
    s_add_u32 s6, s6, s8
    s_mov_b32 m0, 153984
    s_nop 0
    buffer_load_dwordx4 v18, s[76:79], s6 offen lds
    s_add_u32 s6, s6, s8
    s_mov_b32 m0, 154880
    s_nop 0
    buffer_load_dwordx4 v18, s[76:79], s6 offen lds
    s_add_u32 s6, s6, s8
    s_mov_b32 m0, 155776
    s_nop 0
    buffer_load_dwordx4 v18, s[76:79], s6 offen lds
    s_mov_b64 exec, -1
    s_waitcnt vmcnt(24)
    s_barrier
    s_waitcnt vmcnt(16)
    s_barrier
    s_waitcnt vmcnt(8)
    s_barrier
    s_barrier
    s_waitcnt vmcnt(0)
    s_cmp_eq_u32 s73, 0
    s_cbranch_scc1 k1_kernel_jx46
    v_lshrrev_b32 v4, 4, v1
    v_bfe_u32 v5, v1, 2, 2
    v_lshl_add_u32 v4, v4, 3, v5
    v_and_b32 v5, 3, v1
    v_lshlrev_b32 v5, 3, v5
    v_mul_u32_u24 v4, 224, v4
    v_add_u32 v4, v4, v5
    v_add_u32 v4, 149504, v4
    v_lshlrev_b32 v6, 4, v1
    s_mov_b32 s76, s22
    s_mov_b32 s77, s23
    s_mov_b32 s78, 29815808
    s_mov_b32 s79, 0x20000
    ds_read_b64_tr_b16 v[20:21], v4 offset:0
    ds_read_b64_tr_b16 v[22:23], v4 offset:896
    ds_read_b64_tr_b16 v[24:25], v4 offset:32
    ds_read_b64_tr_b16 v[26:27], v4 offset:928
    ds_read_b64_tr_b16 v[28:29], v4 offset:64
    ds_read_b64_tr_b16 v[30:31], v4 offset:960
    ds_read_b64_tr_b16 v[32:33], v4 offset:96
    ds_read_b64_tr_b16 v[34:35], v4 offset:992
    ds_read_b64_tr_b16 v[36:37], v4 offset:128
    ds_read_b64_tr_b16 v[38:39], v4 offset:1024
    ds_read_b64_tr_b16 v[40:41], v4 offset:160
    ds_read_b64_tr_b16 v[42:43], v4 offset:1056
    ds_read_b64_tr_b16 v[44:45], v4 offset:192
    ds_read_b64_tr_b16 v[46:47], v4 offset:1088
    s_waitcnt lgkmcnt(0)
    s_cmp_eq_u32 s70, 1
    s_cbranch_scc1 k1_kernel_jw347
    s_mul_i32 s6, s69, 7
    s_add_u32 s6, s6, 0
    s_cmp_ge_u32 s6, 40
    s_cbranch_scc1 k1_kernel_js48
    s_mul_i32 s7, s6, 52
    s_lshr_b32 s7, s7, 8
    s_mul_i32 s8, s7, 5
    s_sub_u32 s6, s6, s8
    s_mul_i32 s7, s7, s72
    s_add_u32 s7, s7, s68
    s_mul_i32 s7, s7, 5
    s_add_u32 s7, s7, s6
    s_lshl_b32 s7, s7, 10
    s_add_u32 s7, s7, s71
    buffer_store_dwordx4 v[20:23], v6, s[76:79], s7 offen sc1
k1_kernel_js48:
    s_mul_i32 s6, s69, 7
    s_add_u32 s6, s6, 1
    s_cmp_ge_u32 s6, 40
    s_cbranch_scc1 k1_kernel_js49
    s_mul_i32 s7, s6, 52
    s_lshr_b32 s7, s7, 8
    s_mul_i32 s8, s7, 5
    s_sub_u32 s6, s6, s8
    s_mul_i32 s7, s7, s72
    s_add_u32 s7, s7, s68
    s_mul_i32 s7, s7, 5
    s_add_u32 s7, s7, s6
    s_lshl_b32 s7, s7, 10
    s_add_u32 s7, s7, s71
    buffer_store_dwordx4 v[24:27], v6, s[76:79], s7 offen sc1
k1_kernel_js49:
    s_mul_i32 s6, s69, 7
    s_add_u32 s6, s6, 2
    s_cmp_ge_u32 s6, 40
    s_cbranch_scc1 k1_kernel_js50
    s_mul_i32 s7, s6, 52
    s_lshr_b32 s7, s7, 8
    s_mul_i32 s8, s7, 5
    s_sub_u32 s6, s6, s8
    s_mul_i32 s7, s7, s72
    s_add_u32 s7, s7, s68
    s_mul_i32 s7, s7, 5
    s_add_u32 s7, s7, s6
    s_lshl_b32 s7, s7, 10
    s_add_u32 s7, s7, s71
    buffer_store_dwordx4 v[28:31], v6, s[76:79], s7 offen sc1
k1_kernel_js50:
    s_mul_i32 s6, s69, 7
    s_add_u32 s6, s6, 3
    s_cmp_ge_u32 s6, 40
    s_cbranch_scc1 k1_kernel_js51
    s_mul_i32 s7, s6, 52
    s_lshr_b32 s7, s7, 8
    s_mul_i32 s8, s7, 5
    s_sub_u32 s6, s6, s8
    s_mul_i32 s7, s7, s72
    s_add_u32 s7, s7, s68
    s_mul_i32 s7, s7, 5
    s_add_u32 s7, s7, s6
    s_lshl_b32 s7, s7, 10
    s_add_u32 s7, s7, s71
    buffer_store_dwordx4 v[32:35], v6, s[76:79], s7 offen sc1
k1_kernel_js51:
    s_mul_i32 s6, s69, 7
    s_add_u32 s6, s6, 4
    s_cmp_ge_u32 s6, 40
    s_cbranch_scc1 k1_kernel_js52
    s_mul_i32 s7, s6, 52
    s_lshr_b32 s7, s7, 8
    s_mul_i32 s8, s7, 5
    s_sub_u32 s6, s6, s8
    s_mul_i32 s7, s7, s72
    s_add_u32 s7, s7, s68
    s_mul_i32 s7, s7, 5
    s_add_u32 s7, s7, s6
    s_lshl_b32 s7, s7, 10
    s_add_u32 s7, s7, s71
    buffer_store_dwordx4 v[36:39], v6, s[76:79], s7 offen sc1
k1_kernel_js52:
    s_mul_i32 s6, s69, 7
    s_add_u32 s6, s6, 5
    s_cmp_ge_u32 s6, 40
    s_cbranch_scc1 k1_kernel_js53
    s_mul_i32 s7, s6, 52
    s_lshr_b32 s7, s7, 8
    s_mul_i32 s8, s7, 5
    s_sub_u32 s6, s6, s8
    s_mul_i32 s7, s7, s72
    s_add_u32 s7, s7, s68
    s_mul_i32 s7, s7, 5
    s_add_u32 s7, s7, s6
    s_lshl_b32 s7, s7, 10
    s_add_u32 s7, s7, s71
    buffer_store_dwordx4 v[40:43], v6, s[76:79], s7 offen sc1
k1_kernel_js53:
    s_mul_i32 s6, s69, 7
    s_add_u32 s6, s6, 6
    s_cmp_ge_u32 s6, 40
    s_cbranch_scc1 k1_kernel_js54
    s_mul_i32 s7, s6, 52
    s_lshr_b32 s7, s7, 8
    s_mul_i32 s8, s7, 5
    s_sub_u32 s6, s6, s8
    s_mul_i32 s7, s7, s72
    s_add_u32 s7, s7, s68
    s_mul_i32 s7, s7, 5
    s_add_u32 s7, s7, s6
    s_lshl_b32 s7, s7, 10
    s_add_u32 s7, s7, s71
    buffer_store_dwordx4 v[44:47], v6, s[76:79], s7 offen sc1
k1_kernel_js54:
    s_branch k1_kernel_jx46
k1_kernel_jw347:
    s_mul_i32 s7, s69, 20
    s_add_u32 s7, s7, s68
    s_mul_i32 s7, s7, 7168
    s_add_u32 s7, s7, s71
    buffer_store_dwordx4 v[20:23], v6, s[76:79], s7 offen offset:0 sc1
    buffer_store_dwordx4 v[24:27], v6, s[76:79], s7 offen offset:1024 sc1
    buffer_store_dwordx4 v[28:31], v6, s[76:79], s7 offen offset:2048 sc1
    buffer_store_dwordx4 v[32:35], v6, s[76:79], s7 offen offset:3072 sc1
    s_add_u32 s7, s7, 4096
    buffer_store_dwordx4 v[36:39], v6, s[76:79], s7 offen offset:0 sc1
    buffer_store_dwordx4 v[40:43], v6, s[76:79], s7 offen offset:1024 sc1
    buffer_store_dwordx4 v[44:47], v6, s[76:79], s7 offen offset:2048 sc1
k1_kernel_jx46:
    s_branch k1_kernel_end
k1_kernel_ld6:
    s_mov_b32 s42, 0
    s_mov_b64 exec, s[62:63]
    s_add_u32 m0, s42, 15872
    s_add_u32 s6, s46, 61440
    buffer_load_dwordx4 v14, s[28:31], s6 offen offset:0 lds
    buffer_load_dwordx4 v15, s[28:31], s6 offen offset:960 lds
    s_mov_b64 exec, s[64:65]
    buffer_load_dwordx4 v16, s[28:31], s6 offen offset:1920 lds
    s_mov_b64 exec, s[62:63]
    s_add_u32 m0, s42, 26112
    s_add_u32 s6, s46, 61600
    buffer_load_dwordx4 v14, s[28:31], s6 offen offset:0 lds
    buffer_load_dwordx4 v15, s[28:31], s6 offen offset:960 lds
    s_mov_b64 exec, s[64:65]
    buffer_load_dwordx4 v16, s[28:31], s6 offen offset:1920 lds
    s_mov_b64 exec, -1
    s_add_u32 s45, s45, 128
    s_add_u32 s46, s46, 81920
    s_add_u32 s66, s66, 1
    s_cmp_eq_u32 s66, 10
    s_cselect_b32 s6, 1280, 0
    s_cselect_b32 s46, 0, s46
    s_cselect_b32 s66, 0, s66
    s_sub_u32 s45, s45, s6
    s_mov_b32 s42, 28672
    s_mov_b64 exec, s[62:63]
    s_add_u32 m0, s42, 15872
    s_add_u32 s6, s46, 61440
    buffer_load_dwordx4 v14, s[28:31], s6 offen offset:0 lds
    buffer_load_dwordx4 v15, s[28:31], s6 offen offset:960 lds
    s_mov_b64 exec, s[64:65]
    buffer_load_dwordx4 v16, s[28:31], s6 offen offset:1920 lds
    s_mov_b64 exec, s[62:63]
    s_add_u32 m0, s42, 26112
    s_add_u32 s6, s46, 61600
    buffer_load_dwordx4 v14, s[28:31], s6 offen offset:0 lds
    buffer_load_dwordx4 v15, s[28:31], s6 offen offset:960 lds
    s_mov_b64 exec, s[64:65]
    buffer_load_dwordx4 v16, s[28:31], s6 offen offset:1920 lds
    s_mov_b64 exec, -1
    s_add_u32 s45, s45, 128
    s_add_u32 s46, s46, 81920
    s_add_u32 s66, s66, 1
    s_cmp_eq_u32 s66, 10
    s_cselect_b32 s6, 1280, 0
    s_cselect_b32 s46, 0, s46
    s_cselect_b32 s66, 0, s66
    s_sub_u32 s45, s45, s6
    s_waitcnt vmcnt(6)
    s_barrier
    s_mov_b32 s42, 57344
    s_mov_b64 exec, s[62:63]
    s_add_u32 m0, s42, 15872
    s_add_u32 s6, s46, 61440
    buffer_load_dwordx4 v14, s[28:31], s6 offen offset:0 lds
    buffer_load_dwordx4 v15, s[28:31], s6 offen offset:960 lds
    s_mov_b64 exec, s[64:65]
    buffer_load_dwordx4 v16, s[28:31], s6 offen offset:1920 lds
    s_mov_b64 exec, s[62:63]
    s_add_u32 m0, s42, 26112
    s_add_u32 s6, s46, 61600
    buffer_load_dwordx4 v14, s[28:31], s6 offen offset:0 lds
    buffer_load_dwordx4 v15, s[28:31], s6 offen offset:960 lds
    s_mov_b64 exec, s[64:65]
    buffer_load_dwordx4 v16, s[28:31], s6 offen offset:1920 lds
    s_mov_b64 exec, -1
    s_add_u32 s45, s45, 128
    s_add_u32 s46, s46, 81920
    s_add_u32 s66, s66, 1
    s_cmp_eq_u32 s66, 10
    s_cselect_b32 s6, 1280, 0
    s_cselect_b32 s46, 0, s46
    s_cselect_b32 s66, 0, s66
    s_sub_u32 s45, s45, s6
    s_mov_b32 s42, 86016
    s_mov_b64 exec, s[62:63]
    s_add_u32 m0, s42, 15872
    s_add_u32 s6, s46, 61440
    buffer_load_dwordx4 v14, s[28:31], s6 offen offset:0 lds
    buffer_load_dwordx4 v15, s[28:31], s6 offen offset:960 lds
    s_mov_b64 exec, s[64:65]
    buffer_load_dwordx4 v16, s[28:31], s6 offen offset:1920 lds
    s_mov_b64 exec, s[62:63]
    s_add_u32 m0, s42, 26112
    s_add_u32 s6, s46, 61600
    buffer_load_dwordx4 v14, s[28:31], s6 offen offset:0 lds
    buffer_load_dwordx4 v15, s[28:31], s6 offen offset:960 lds
    s_mov_b64 exec, s[64:65]
    buffer_load_dwordx4 v16, s[28:31], s6 offen offset:1920 lds
    s_mov_b64 exec, -1
    s_add_u32 s45, s45, 128
    s_add_u32 s46, s46, 81920
    s_add_u32 s66, s66, 1
    s_cmp_eq_u32 s66, 10
    s_cselect_b32 s6, 1280, 0
    s_cselect_b32 s46, 0, s46
    s_cselect_b32 s66, 0, s66
    s_sub_u32 s45, s45, s6
    s_mov_b32 s40, 1
    s_mov_b32 s42, 0
k1_kernel_lloop55:
    s_waitcnt vmcnt(12)
    s_barrier
    s_mov_b64 exec, s[62:63]
    s_add_u32 m0, s42, 15872
    s_add_u32 s6, s46, 61440
    buffer_load_dwordx4 v14, s[28:31], s6 offen offset:0 lds
    buffer_load_dwordx4 v15, s[28:31], s6 offen offset:960 lds
    s_mov_b64 exec, s[64:65]
    buffer_load_dwordx4 v16, s[28:31], s6 offen offset:1920 lds
    s_mov_b64 exec, s[62:63]
    s_add_u32 m0, s42, 26112
    s_add_u32 s6, s46, 61600
    buffer_load_dwordx4 v14, s[28:31], s6 offen offset:0 lds
    buffer_load_dwordx4 v15, s[28:31], s6 offen offset:960 lds
    s_mov_b64 exec, s[64:65]
    buffer_load_dwordx4 v16, s[28:31], s6 offen offset:1920 lds
    s_mov_b64 exec, -1
    s_add_u32 s45, s45, 128
    s_add_u32 s46, s46, 81920
    s_add_u32 s66, s66, 1
    s_cmp_eq_u32 s66, 10
    s_cselect_b32 s6, 1280, 0
    s_cselect_b32 s46, 0, s46
    s_cselect_b32 s66, 0, s66
    s_sub_u32 s45, s45, s6
    s_add_u32 s42, s42, 28672
    s_cmp_eq_u32 s42, 114688
    s_cselect_b32 s42, 0, s42
    s_add_u32 s40, s40, 1
    s_cmp_lt_u32 s40, 4
    s_cbranch_scc1 k1_kernel_lloop55
k1_kernel_lloop56:
    s_waitcnt vmcnt(12)
    s_barrier
    s_mov_b64 exec, s[62:63]
    s_add_u32 m0, s42, 15872
    s_add_u32 s6, s46, 61440
    buffer_load_dwordx4 v14, s[28:31], s6 offen offset:0 lds
    buffer_load_dwordx4 v15, s[28:31], s6 offen offset:960 lds
    s_mov_b64 exec, s[64:65]
    buffer_load_dwordx4 v16, s[28:31], s6 offen offset:1920 lds
    s_mov_b64 exec, s[62:63]
    s_add_u32 m0, s42, 26112
    s_add_u32 s6, s46, 61600
    buffer_load_dwordx4 v14, s[28:31], s6 offen offset:0 lds
    buffer_load_dwordx4 v15, s[28:31], s6 offen offset:960 lds
    s_mov_b64 exec, s[64:65]
    buffer_load_dwordx4 v16, s[28:31], s6 offen offset:1920 lds
    s_mov_b64 exec, -1
    s_add_u32 s45, s45, 128
    s_add_u32 s46, s46, 81920
    s_add_u32 s66, s66, 1
    s_cmp_eq_u32 s66, 10
    s_cselect_b32 s6, 1280, 0
    s_cselect_b32 s46, 0, s46
    s_cselect_b32 s66, 0, s66
    s_sub_u32 s45, s45, s6
    s_add_u32 s42, s42, 28672
    s_cmp_eq_u32 s42, 114688
    s_cselect_b32 s42, 0, s42
    s_add_u32 s40, s40, 1
    s_cmp_lt_u32 s40, 7
    s_cbranch_scc1 k1_kernel_lloop56
    s_add_u32 s67, s2, 768
    s_mov_b32 s73, 1
k1_kernel_j58:
    s_cmp_lt_u32 s67, 120
    s_cbranch_scc0 k1_kernel_j59
    s_mov_b32 s76, s50
    s_mov_b32 s77, s51
    s_mov_b32 s78, 819200
    s_mov_b32 s79, 0x20000
    s_mov_b32 s71, 20513792
    s_mov_b32 s72, 20
    s_mov_b32 s74, 0
    s_mov_b32 s70, 0
    s_mul_i32 s68, s67, 10923
    s_lshr_b32 s68, s68, 16
    s_mul_i32 s6, s68, 6
    s_sub_u32 s69, s67, s6
    s_mov_b32 s8, 1280
    s_branch k1_kernel_jd57
k1_kernel_j59:
    s_cmp_lt_u32 s67, 240
    s_cbranch_scc0 k1_kernel_j60
    s_mov_b32 s76, s56
    s_mov_b32 s77, s57
    s_mov_b32 s78, 819200
    s_mov_b32 s79, 0x20000
    s_mov_b32 s71, 26944512
    s_mov_b32 s72, 76
    s_mov_b32 s74, 1
    s_sub_u32 s67, s67, 120
    s_mov_b32 s70, 0
    s_mul_i32 s68, s67, 10923
    s_lshr_b32 s68, s68, 16
    s_mul_i32 s6, s68, 6
    s_sub_u32 s69, s67, s6
    s_mov_b32 s8, 1280
    s_branch k1_kernel_jd57
k1_kernel_j60:
    s_cmp_lt_u32 s67, 564
    s_cbranch_scc0 k1_kernel_j61
    s_mov_b32 s76, s54
    s_mov_b32 s77, s55
    s_mov_b32 s78, 2211840
    s_mov_b32 s79, 0x20000
    s_mov_b32 s71, 26657792
    s_mov_b32 s72, 76
    s_mov_b32 s74, 2
    s_sub_u32 s67, s67, 240
    s_mov_b32 s70, 0
    s_mul_i32 s68, s67, 10923
    s_lshr_b32 s68, s68, 16
    s_mul_i32 s6, s68, 6
    s_sub_u32 s69, s67, s6
    s_mov_b32 s8, 1280
    s_branch k1_kernel_jd57
k1_kernel_j61:
    s_mov_b32 s76, s52
    s_mov_b32 s77, s53
    s_mov_b32 s78, 2211840
    s_mov_b32 s79, 0x20000
    s_mov_b32 s71, 24364032
    s_mov_b32 s72, 20
    s_mov_b32 s74, 3
    s_sub_u32 s67, s67, 564
    s_cmp_ge_u32 s67, 320
    s_cselect_b32 s73, 0, 1
    s_cselect_b32 s78, 0, s78
    s_mov_b32 s70, 1
    s_lshr_b32 s68, s67, 4
    s_and_b32 s69, s67, 15
    s_mov_b32 s8, 3456
k1_kernel_jd57:
    s_mul_i32 s6, s68, s8
    s_lshl_b32 s6, s6, 5
    s_mul_i32 s7, s69, 224
    s_add_u32 s6, s6, s7
    v_mul_u32_u24 v4, 4682, v1
    v_lshrrev_b32 v4, 16, v4
    v_mul_u32_u24 v5, 14, v4
    v_sub_u32 v5, v1, v5
    v_mul_lo_u32 v4, v4, s8
    v_lshl_add_u32 v18, v5, 4, v4
    s_lshl_b32 s8, s8, 2
    s_mov_b32 exec_lo, -1
    s_mov_b32 exec_hi, 0x00ffffff
    s_mov_b32 m0, 156672
    s_nop 0
    buffer_load_dwordx4 v18, s[76:79], s6 offen lds
    s_add_u32 s6, s6, s8
    s_mov_b32 m0, 157568
    s_nop 0
    buffer_load_dwordx4 v18, s[76:79], s6 offen lds
    s_add_u32 s6, s6, s8
    s_mov_b32 m0, 158464
    s_nop 0
    buffer_load_dwordx4 v18, s[76:79], s6 offen lds
    s_add_u32 s6, s6, s8
    s_mov_b32 m0, 159360
    s_nop 0
    buffer_load_dwordx4 v18, s[76:79], s6 offen lds
    s_add_u32 s6, s6, s8
    s_mov_b32 m0, 160256
    s_nop 0
    buffer_load_dwordx4 v18, s[76:79], s6 offen lds
    s_add_u32 s6, s6, s8
    s_mov_b32 m0, 161152
    s_nop 0
    buffer_load_dwordx4 v18, s[76:79], s6 offen lds
    s_add_u32 s6, s6, s8
    s_mov_b32 m0, 162048
    s_nop 0
    buffer_load_dwordx4 v18, s[76:79], s6 offen lds
    s_add_u32 s6, s6, s8
    s_mov_b32 m0, 162944
    s_nop 0
    buffer_load_dwordx4 v18, s[76:79], s6 offen lds
    s_mov_b64 exec, -1
    s_waitcnt vmcnt(20)
    s_barrier
    s_waitcnt vmcnt(14)
    s_barrier
    s_waitcnt vmcnt(8)
    s_barrier
    s_barrier
    s_waitcnt vmcnt(0)
    s_cmp_eq_u32 s73, 0
    s_cbranch_scc1 k1_kernel_jx62
    v_lshrrev_b32 v4, 4, v1
    v_bfe_u32 v5, v1, 2, 2
    v_lshl_add_u32 v4, v4, 3, v5
    v_and_b32 v5, 3, v1
    v_lshlrev_b32 v5, 3, v5
    v_mul_u32_u24 v4, 224, v4
    v_add_u32 v4, v4, v5
    v_add_u32 v4, 156672, v4
    v_lshlrev_b32 v6, 4, v1
    s_mov_b32 s76, s22
    s_mov_b32 s77, s23
    s_mov_b32 s78, 29815808
    s_mov_b32 s79, 0x20000
    ds_read_b64_tr_b16 v[20:21], v4 offset:0
    ds_read_b64_tr_b16 v[22:23], v4 offset:896
    ds_read_b64_tr_b16 v[24:25], v4 offset:32
    ds_read_b64_tr_b16 v[26:27], v4 offset:928
    ds_read_b64_tr_b16 v[28:29], v4 offset:64
    ds_read_b64_tr_b16 v[30:31], v4 offset:960
    ds_read_b64_tr_b16 v[32:33], v4 offset:96
    ds_read_b64_tr_b16 v[34:35], v4 offset:992
    ds_read_b64_tr_b16 v[36:37], v4 offset:128
    ds_read_b64_tr_b16 v[38:39], v4 offset:1024
    ds_read_b64_tr_b16 v[40:41], v4 offset:160
    ds_read_b64_tr_b16 v[42:43], v4 offset:1056
    ds_read_b64_tr_b16 v[44:45], v4 offset:192
    ds_read_b64_tr_b16 v[46:47], v4 offset:1088
    s_waitcnt lgkmcnt(0)
    s_cmp_eq_u32 s70, 1
    s_cbranch_scc1 k1_kernel_jw363
    s_mul_i32 s6, s69, 7
    s_add_u32 s6, s6, 0
    s_cmp_ge_u32 s6, 40
    s_cbranch_scc1 k1_kernel_js64
    s_mul_i32 s7, s6, 52
    s_lshr_b32 s7, s7, 8
    s_mul_i32 s8, s7, 5
    s_sub_u32 s6, s6, s8
    s_mul_i32 s7, s7, s72
    s_add_u32 s7, s7, s68
    s_mul_i32 s7, s7, 5
    s_add_u32 s7, s7, s6
    s_lshl_b32 s7, s7, 10
    s_add_u32 s7, s7, s71
    buffer_store_dwordx4 v[20:23], v6, s[76:79], s7 offen sc1
k1_kernel_js64:
    s_mul_i32 s6, s69, 7
    s_add_u32 s6, s6, 1
    s_cmp_ge_u32 s6, 40
    s_cbranch_scc1 k1_kernel_js65
    s_mul_i32 s7, s6, 52
    s_lshr_b32 s7, s7, 8
    s_mul_i32 s8, s7, 5
    s_sub_u32 s6, s6, s8
    s_mul_i32 s7, s7, s72
    s_add_u32 s7, s7, s68
    s_mul_i32 s7, s7, 5
    s_add_u32 s7, s7, s6
    s_lshl_b32 s7, s7, 10
    s_add_u32 s7, s7, s71
    buffer_store_dwordx4 v[24:27], v6, s[76:79], s7 offen sc1
k1_kernel_js65:
    s_mul_i32 s6, s69, 7
    s_add_u32 s6, s6, 2
    s_cmp_ge_u32 s6, 40
    s_cbranch_scc1 k1_kernel_js66
    s_mul_i32 s7, s6, 52
    s_lshr_b32 s7, s7, 8
    s_mul_i32 s8, s7, 5
    s_sub_u32 s6, s6, s8
    s_mul_i32 s7, s7, s72
    s_add_u32 s7, s7, s68
    s_mul_i32 s7, s7, 5
    s_add_u32 s7, s7, s6
    s_lshl_b32 s7, s7, 10
    s_add_u32 s7, s7, s71
    buffer_store_dwordx4 v[28:31], v6, s[76:79], s7 offen sc1
k1_kernel_js66:
    s_mul_i32 s6, s69, 7
    s_add_u32 s6, s6, 3
    s_cmp_ge_u32 s6, 40
    s_cbranch_scc1 k1_kernel_js67
    s_mul_i32 s7, s6, 52
    s_lshr_b32 s7, s7, 8
    s_mul_i32 s8, s7, 5
    s_sub_u32 s6, s6, s8
    s_mul_i32 s7, s7, s72
    s_add_u32 s7, s7, s68
    s_mul_i32 s7, s7, 5
    s_add_u32 s7, s7, s6
    s_lshl_b32 s7, s7, 10
    s_add_u32 s7, s7, s71
    buffer_store_dwordx4 v[32:35], v6, s[76:79], s7 offen sc1
k1_kernel_js67:
    s_mul_i32 s6, s69, 7
    s_add_u32 s6, s6, 4
    s_cmp_ge_u32 s6, 40
    s_cbranch_scc1 k1_kernel_js68
    s_mul_i32 s7, s6, 52
    s_lshr_b32 s7, s7, 8
    s_mul_i32 s8, s7, 5
    s_sub_u32 s6, s6, s8
    s_mul_i32 s7, s7, s72
    s_add_u32 s7, s7, s68
    s_mul_i32 s7, s7, 5
    s_add_u32 s7, s7, s6
    s_lshl_b32 s7, s7, 10
    s_add_u32 s7, s7, s71
    buffer_store_dwordx4 v[36:39], v6, s[76:79], s7 offen sc1
k1_kernel_js68:
    s_mul_i32 s6, s69, 7
    s_add_u32 s6, s6, 5
    s_cmp_ge_u32 s6, 40
    s_cbranch_scc1 k1_kernel_js69
    s_mul_i32 s7, s6, 52
    s_lshr_b32 s7, s7, 8
    s_mul_i32 s8, s7, 5
    s_sub_u32 s6, s6, s8
    s_mul_i32 s7, s7, s72
    s_add_u32 s7, s7, s68
    s_mul_i32 s7, s7, 5
    s_add_u32 s7, s7, s6
    s_lshl_b32 s7, s7, 10
    s_add_u32 s7, s7, s71
    buffer_store_dwordx4 v[40:43], v6, s[76:79], s7 offen sc1
k1_kernel_js69:
    s_mul_i32 s6, s69, 7
    s_add_u32 s6, s6, 6
    s_cmp_ge_u32 s6, 40
    s_cbranch_scc1 k1_kernel_js70
    s_mul_i32 s7, s6, 52
    s_lshr_b32 s7, s7, 8
    s_mul_i32 s8, s7, 5
    s_sub_u32 s6, s6, s8
    s_mul_i32 s7, s7, s72
    s_add_u32 s7, s7, s68
    s_mul_i32 s7, s7, 5
    s_add_u32 s7, s7, s6
    s_lshl_b32 s7, s7, 10
    s_add_u32 s7, s7, s71
    buffer_store_dwordx4 v[44:47], v6, s[76:79], s7 offen sc1
k1_kernel_js70:
    s_branch k1_kernel_jx62
k1_kernel_jw363:
    s_mul_i32 s7, s69, 20
    s_add_u32 s7, s7, s68
    s_mul_i32 s7, s7, 7168
    s_add_u32 s7, s7, s71
    buffer_store_dwordx4 v[20:23], v6, s[76:79], s7 offen offset:0 sc1
    buffer_store_dwordx4 v[24:27], v6, s[76:79], s7 offen offset:1024 sc1
    buffer_store_dwordx4 v[28:31], v6, s[76:79], s7 offen offset:2048 sc1
    buffer_store_dwordx4 v[32:35], v6, s[76:79], s7 offen offset:3072 sc1
    s_add_u32 s7, s7, 4096
    buffer_store_dwordx4 v[36:39], v6, s[76:79], s7 offen offset:0 sc1
    buffer_store_dwordx4 v[40:43], v6, s[76:79], s7 offen offset:1024 sc1
    buffer_store_dwordx4 v[44:47], v6, s[76:79], s7 offen offset:2048 sc1
k1_kernel_jx62:
    s_branch k1_kernel_end
k1_kernel_comp2:
    s_lshr_b32 s6, s3, 2
    s_lshl_b32 s60, s59, 1
    s_add_u32 s60, s60, s6
    s_cmp_ge_u32 s5, 4
    s_cbranch_scc1 k1_kernel_nokv71
    v_add_u32 v44, 512, v0
    v_mov_b32 v28, 0
    v_mov_b32 v36, 0
    v_mov_b32 v29, 0
    v_mov_b32 v37, 0
    v_mov_b32 v30, 0
    v_mov_b32 v38, 0
    v_mov_b32 v31, 0
    v_mov_b32 v39, 0
    v_mov_b32 v32, 0
    v_mov_b32 v40, 0
    v_mov_b32 v33, 0
    v_mov_b32 v41, 0
    v_mov_b32 v34, 0
    v_mov_b32 v42, 0
    v_mov_b32 v35, 0
    v_mov_b32 v43, 0
    v_mul_u32_u24 v45, 40, v0
    v_mul_u32_u24 v46, 40, v44
    s_waitcnt lgkmcnt(0)
    s_cmp_lt_u32 s5, 2
    s_cselect_b32 s36, s14, s16
    s_cselect_b32 s37, s15, s17
    s_mov_b32 s38, 25600
    s_mov_b32 s39, 0x20000
    s_and_b32 s6, s5, 1
    s_cmp_eq_u32 s6, 1
    s_cbranch_scc1 k1_kernel_kvodd72
    buffer_load_dwordx4 v[28:31], v45, s[36:39], 0 offen
    buffer_load_dwordx4 v[32:35], v45, s[36:39], 0 offen offset:16
    buffer_load_dwordx4 v[36:39], v46, s[36:39], 0 offen
    buffer_load_dwordx4 v[40:43], v46, s[36:39], 0 offen offset:16
    s_branch k1_kernel_kvdone73
k1_kernel_kvodd72:
    buffer_load_dwordx2 v[28:29], v45, s[36:39], 0 offen offset:32
    buffer_load_dwordx2 v[36:37], v46, s[36:39], 0 offen offset:32
    s_cmp_lg_u32 s5, 1
    s_cbranch_scc1 k1_kernel_kvdone73
    s_mov_b32 s36, s20
    s_mov_b32 s37, s21
    s_mov_b32 s38, 1280
    s_mov_b32 s39, 0x20000
    v_lshlrev_b32 v45, 1, v0
    v_lshlrev_b32 v46, 1, v44
    buffer_load_ushort v30, v45, s[36:39], 0 offen
    buffer_load_ushort v38, v46, s[36:39], 0 offen
k1_kernel_kvdone73:
k1_kernel_nokv71:
    s_lshr_b32 s43, s3, 2
    s_and_b32 s44, s3, 3
    v_and_b32 v2, 15, v1
    v_lshrrev_b32 v3, 4, v1
    v_mov_b32 v152, 0x3f803f80
    v_mov_b32 v153, 0x3f803f80
    v_mov_b32 v154, 0x3f803f80
    v_mov_b32 v155, 0x3f803f80
    s_and_b32 s45, s3, 1
    s_bfe_u32 s46, s3, 0x10001
    s_lshl_b32 s6, s46, 12
    v_lshlrev_b32 v4, 7, v2
    v_lshrrev_b32 v5, 1, v2
    v_lshrrev_b32 v6, 1, v3
    v_xor_b32 v5, v5, v6
    v_and_b32 v6, 1, v3
    v_lshl_add_u32 v4, v5, 4, v4
    v_lshl_add_u32 v4, v6, 3, v4
    s_lshl_b32 s7, s45, 6
    v_add_u32 v4, s6, v4
    v_xor_b32 v144, s7, v4
    v_xor_b32 v145, 32, v144
    v_add_u32 v146, 2048, v144
    v_add_u32 v147, 2048, v145
    v_lshrrev_b32 v4, 2, v1
    v_and_b32 v5, 3, v1
    v_lshlrev_b32 v5, 3, v5
    v_mul_u32_u24 v6, 160, v4
    s_mul_i32 s6, s43, 10240
    s_mul_i32 s7, s45, 5120
    s_add_u32 s6, s6, s7
    s_add_u32 s6, s6, 8192
    v_add3_u32 v148, v6, v5, s6
    v_lshl_add_u32 v149, v4, 5, v5
    s_lshl_b32 s6, s45, 10
    s_add_u32 s6, s6, 114688
    s_lshl_b32 s7, s61, 11
    s_add_u32 s6, s6, s7
    v_add_u32 v149, s6, v149
    v_mov_b32 v76, 0
    v_mov_b32 v77, 0
    v_mov_b32 v78, 0
    v_mov_b32 v79, 0
    v_mov_b32 v80, 0
    v_mov_b32 v81, 0
    v_mov_b32 v82, 0
    v_mov_b32 v83, 0
    v_mov_b32 v84, 0
    v_mov_b32 v85, 0
    v_mov_b32 v86, 0
    v_mov_b32 v87, 0
    v_mov_b32 v88, 0
    v_mov_b32 v89, 0
    v_mov_b32 v90, 0
    v_mov_b32 v91, 0
    v_mov_b32 v92, 0
    v_mov_b32 v93, 0
    v_mov_b32 v94, 0
    v_mov_b32 v95, 0
    v_mov_b32 v96, 0
    v_mov_b32 v97, 0
    v_mov_b32 v98, 0
    v_mov_b32 v99, 0
    v_mov_b32 v100, 0
    v_mov_b32 v101, 0
    v_mov_b32 v102, 0
    v_mov_b32 v103, 0
    v_mov_b32 v104, 0
    v_mov_b32 v105, 0
    v_mov_b32 v106, 0
    v_mov_b32 v107, 0
    v_mov_b32 v108, 0
    v_mov_b32 v109, 0
    v_mov_b32 v110, 0
    v_mov_b32 v111, 0
    v_mov_b32 v112, 0
    v_mov_b32 v113, 0
    v_mov_b32 v114, 0
    v_mov_b32 v115, 0
    v_mov_b32 v116, 0
    v_mov_b32 v117, 0
    v_mov_b32 v118, 0
    v_mov_b32 v119, 0
    v_mov_b32 v120, 0
    v_mov_b32 v121, 0
    v_mov_b32 v122, 0
    v_mov_b32 v123, 0
    v_mov_b32 v124, 0
    v_mov_b32 v125, 0
    v_mov_b32 v126, 0
    v_mov_b32 v127, 0
    v_mov_b32 v128, 0
    v_mov_b32 v129, 0
    v_mov_b32 v130, 0
    v_mov_b32 v131, 0
    v_mov_b32 v132, 0
    v_mov_b32 v133, 0
    v_mov_b32 v134, 0
    v_mov_b32 v135, 0
    v_mov_b32 v136, 0
    v_mov_b32 v137, 0
    v_mov_b32 v138, 0
    v_mov_b32 v139, 0
    v_mov_b32 v140, 0
    v_mov_b32 v141, 0
    v_mov_b32 v142, 0
    v_mov_b32 v143, 0
    s_cmp_ge_u32 s5, 4
    s_cbranch_scc1 k1_kernel_nokvb74
    s_waitcnt vmcnt(0)
    v_lshlrev_b32 v4, 5, v0
    v_add_u32 v4, 114688, v4
    ds_write_b128 v4, v[28:31]
    ds_write_b128 v4, v[32:35] offset:16
    v_cmp_gt_u32 vcc, 640, v44
    s_and_saveexec_b64 s[48:49], vcc
    s_cbranch_execz k1_kernel_z75
    ds_write_b128 v4, v[36:39] offset:16384
    ds_write_b128 v4, v[40:43] offset:16400
k1_kernel_z75:
    s_mov_b64 exec, s[48:49]
k1_kernel_nokvb74:
    s_waitcnt lgkmcnt(0)
    s_mov_b32 s32, s22
    s_mov_b32 s33, s23
    s_mov_b32 s34, 29815808
    s_mov_b32 s35, 0x20000
    s_cmp_lt_u32 s5, 4
    s_cselect_b32 s80, 1, 0
    s_cmp_lt_u32 s5, 2
    s_cselect_b32 s6, 0, s80
    s_add_u32 s80, s80, s6
    s_mov_b32 s81, 65536
    s_mov_b32 s82, 2048
    s_cmp_eq_u32 s58, 1
    s_cbranch_scc1 k1_kernel_H76
    s_cmp_eq_u32 s43, 1
    s_cselect_b32 s80, 0, s80
    s_cmp_eq_u32 s80, 1
    s_cbranch_scc1 k1_kernel_QN77
    s_cmp_eq_u32 s80, 2
    s_cbranch_scc1 k1_kernel_QS78
    s_barrier
    s_mov_b32 s40, 0
    s_mov_b32 s42, 28672
    ds_read_b64 v[12:13], v144
    ds_read_b64 v[14:15], v145
    ds_read_b64 v[16:17], v146
    ds_read_b64 v[18:19], v147
    ds_read_b64_tr_b16 v[28:29], v148 offset:0
    ds_read_b64_tr_b16 v[30:31], v148 offset:2560
    ds_read_b64_tr_b16 v[32:33], v148 offset:32
    ds_read_b64_tr_b16 v[34:35], v148 offset:2592
    ds_read_b64_tr_b16 v[36:37], v148 offset:64
    ds_read_b64_tr_b16 v[38:39], v148 offset:2624
    ds_read_b64_tr_b16 v[40:41], v148 offset:96
    ds_read_b64_tr_b16 v[42:43], v148 offset:2656
    ds_read_b64_tr_b16 v[44:45], v148 offset:128
    ds_read_b64_tr_b16 v[46:47], v148 offset:2688
    s_add_u32 s40, s40, 1
    s_and_b32 s8, s40, 3
    s_cmp_eq_u32 s8, 0
    s_cselect_b32 s8, 4294881280, s42
    v_add_u32 v144, s8, v144
    v_add_u32 v145, s8, v145
    v_add_u32 v146, s8, v146
    v_add_u32 v147, s8, v147
    v_add_u32 v148, s8, v148
    s_add_u32 s61, s61, 1
    s_cmp_eq_u32 s61, 10
    s_cselect_b32 s7, 4294948864, s82
    v_add_u32 v149, s7, v149
.p2align 6
k1_kernel_loop80:
    s_waitcnt lgkmcnt(0)
    s_barrier
    ds_read_b64 v[20:21], v144
    ds_read_b64 v[22:23], v145
    v_mfma_f32_16x16x32_bf16 v[76:79], v[28:31], v[12:15], v[76:79]
    ds_read_b64 v[24:25], v146
    ds_read_b64 v[26:27], v147
    v_mfma_f32_16x16x32_bf16 v[96:99], v[28:31], v[16:19], v[96:99]
    ds_read_b64_tr_b16 v[48:49], v148 offset:0
    ds_read_b64_tr_b16 v[50:51], v148 offset:2560
    ds_read_b64_tr_b16 v[52:53], v148 offset:32
    v_mfma_f32_16x16x32_bf16 v[80:83], v[32:35], v[12:15], v[80:83]
    ds_read_b64_tr_b16 v[54:55], v148 offset:2592
    ds_read_b64_tr_b16 v[56:57], v148 offset:64
    v_mfma_f32_16x16x32_bf16 v[100:103], v[32:35], v[16:19], v[100:103]
    ds_read_b64_tr_b16 v[58:59], v148 offset:2624
    ds_read_b64_tr_b16 v[60:61], v148 offset:96
    ds_read_b64_tr_b16 v[62:63], v148 offset:2656
    v_mfma_f32_16x16x32_bf16 v[84:87], v[36:39], v[12:15], v[84:87]
    ds_read_b64_tr_b16 v[64:65], v148 offset:128
    ds_read_b64_tr_b16 v[66:67], v148 offset:2688
    v_mfma_f32_16x16x32_bf16 v[104:107], v[36:39], v[16:19], v[104:107]
    s_add_u32 s40, s40, 1
    s_and_b32 s8, s40, 3
    s_cmp_eq_u32 s8, 0
    v_mfma_f32_16x16x32_bf16 v[88:91], v[40:43], v[12:15], v[88:91]
    s_cselect_b32 s8, 4294881280, s42
    v_add_u32 v144, s8, v144
    v_mfma_f32_16x16x32_bf16 v[108:111], v[40:43], v[16:19], v[108:111]
    v_add_u32 v145, s8, v145
    v_add_u32 v146, s8, v146
    v_add_u32 v147, s8, v147
    v_mfma_f32_16x16x32_bf16 v[92:95], v[44:47], v[12:15], v[92:95]
    v_add_u32 v148, s8, v148
    s_add_u32 s61, s61, 1
    v_mfma_f32_16x16x32_bf16 v[112:115], v[44:47], v[16:19], v[112:115]
    s_cmp_eq_u32 s61, 10
    s_cselect_b32 s7, 4294948864, s82
    v_add_u32 v149, s7, v149
    s_cmp_lg_u32 s40, 4
    s_cbranch_scc1 k1_kernel_cp82
    s_getpc_b64 s[48:49]
k1_kernel_here83:
    s_add_u32 s48, s48, k2_kernel-k1_kernel_here83
    s_addc_u32 s49, s49, 0
    v_lshlrev_b32 v9, 7, v0
    v_cmp_gt_u32 vcc, K2_CODE_BYTES, v9
    s_and_saveexec_b64 s[36:37], vcc
    s_cbranch_execz k1_kernel_cz84
    global_load_dword v11, v9, s[48:49]
k1_kernel_cz84:
    s_mov_b64 exec, s[36:37]
k1_kernel_cp82:
    s_waitcnt lgkmcnt(0)
    s_cmp_eq_u32 s40, 10
    s_cbranch_scc1 k1_kernel_last81
    s_barrier
    ds_read_b64 v[12:13], v144
    ds_read_b64 v[14:15], v145
    v_mfma_f32_16x16x32_bf16 v[76:79], v[48:51], v[20:23], v[76:79]
    ds_read_b64 v[16:17], v146
    ds_read_b64 v[18:19], v147
    v_mfma_f32_16x16x32_bf16 v[96:99], v[48:51], v[24:27], v[96:99]
    ds_read_b64_tr_b16 v[28:29], v148 offset:0
    ds_read_b64_tr_b16 v[30:31], v148 offset:2560
    ds_read_b64_tr_b16 v[32:33], v148 offset:32
    v_mfma_f32_16x16x32_bf16 v[80:83], v[52:55], v[20:23], v[80:83]
    ds_read_b64_tr_b16 v[34:35], v148 offset:2592
    ds_read_b64_tr_b16 v[36:37], v148 offset:64
    v_mfma_f32_16x16x32_bf16 v[100:103], v[52:55], v[24:27], v[100:103]
    ds_read_b64_tr_b16 v[38:39], v148 offset:2624
    ds_read_b64_tr_b16 v[40:41], v148 offset:96
    ds_read_b64_tr_b16 v[42:43], v148 offset:2656
    v_mfma_f32_16x16x32_bf16 v[84:87], v[56:59], v[20:23], v[84:87]
    ds_read_b64_tr_b16 v[44:45], v148 offset:128
    ds_read_b64_tr_b16 v[46:47], v148 offset:2688
    v_mfma_f32_16x16x32_bf16 v[104:107], v[56:59], v[24:27], v[104:107]
    s_add_u32 s40, s40, 1
    s_and_b32 s8, s40, 3
    s_cmp_eq_u32 s8, 0
    v_mfma_f32_16x16x32_bf16 v[88:91], v[60:63], v[20:23], v[88:91]
    s_cselect_b32 s8, 4294881280, s42
    v_add_u32 v144, s8, v144
    v_mfma_f32_16x16x32_bf16 v[108:111], v[60:63], v[24:27], v[108:111]
    v_add_u32 v145, s8, v145
    v_add_u32 v146, s8, v146
    v_add_u32 v147, s8, v147
    v_mfma_f32_16x16x32_bf16 v[92:95], v[64:67], v[20:23], v[92:95]
    v_add_u32 v148, s8, v148
    s_add_u32 s61, s61, 1
    v_mfma_f32_16x16x32_bf16 v[112:115], v[64:67], v[24:27], v[112:115]
    s_cmp_eq_u32 s61, 10
    s_cselect_b32 s7, 4294948864, s82
    v_add_u32 v149, s7, v149
    s_branch k1_kernel_loop80
k1_kernel_last81:
    v_mfma_f32_16x16x32_bf16 v[76:79], v[48:51], v[20:23], v[76:79]
    v_mfma_f32_16x16x32_bf16 v[96:99], v[48:51], v[24:27], v[96:99]
    v_mfma_f32_16x16x32_bf16 v[80:83], v[52:55], v[20:23], v[80:83]
    v_mfma_f32_16x16x32_bf16 v[100:103], v[52:55], v[24:27], v[100:103]
    v_mfma_f32_16x16x32_bf16 v[84:87], v[56:59], v[20:23], v[84:87]
    v_mfma_f32_16x16x32_bf16 v[104:107], v[56:59], v[24:27], v[104:107]
    v_mfma_f32_16x16x32_bf16 v[88:91], v[60:63], v[20:23], v[88:91]
    v_mfma_f32_16x16x32_bf16 v[108:111], v[60:63], v[24:27], v[108:111]
    v_mfma_f32_16x16x32_bf16 v[92:95], v[64:67], v[20:23], v[92:95]
    v_mfma_f32_16x16x32_bf16 v[112:115], v[64:67], v[24:27], v[112:115]
    s_nop 7
    s_xor_b32 s6, s3, 1
    s_mul_i32 s6, s6, 7168
    s_add_u32 s6, s6, 57344
    v_lshlrev_b32 v9, 4, v1
    v_add_u32 v8, s6, v9
    s_cmp_eq_u32 s45, 1
    s_cbranch_scc1 k1_kernel_x185
    ds_write_b128 v8, v[96:99] offset:0
    ds_write_b128 v8, v[100:103] offset:1024
    ds_write_b128 v8, v[104:107] offset:2048
    ds_write_b128 v8, v[108:111] offset:3072
    ds_write_b128 v8, v[112:115] offset:4096
    s_branch k1_kernel_x286
k1_kernel_x185:
    ds_write_b128 v8, v[76:79] offset:0
    ds_write_b128 v8, v[80:83] offset:1024
    ds_write_b128 v8, v[84:87] offset:2048
    ds_write_b128 v8, v[88:91] offset:3072
    ds_write_b128 v8, v[92:95] offset:4096
    s_waitcnt lgkmcnt(0)
    v_mov_b32 v76, v96
    v_mov_b32 v77, v97
    v_mov_b32 v78, v98
    v_mov_b32 v79, v99
    v_mov_b32 v80, v100
    v_mov_b32 v81, v101
    v_mov_b32 v82, v102
    v_mov_b32 v83, v103
    v_mov_b32 v84, v104
    v_mov_b32 v85, v105
    v_mov_b32 v86, v106
    v_mov_b32 v87, v107
    v_mov_b32 v88, v108
    v_mov_b32 v89, v109
    v_mov_b32 v90, v110
    v_mov_b32 v91, v111
    v_mov_b32 v92, v112
    v_mov_b32 v93, v113
    v_mov_b32 v94, v114
    v_mov_b32 v95, v115
k1_kernel_x286:
    s_waitcnt lgkmcnt(0)
    s_barrier
    s_mul_i32 s6, s3, 7168
    s_add_u32 s6, s6, 57344
    v_add_u32 v8, s6, v9
    ds_read_b128 v[96:99], v8 offset:0
    ds_read_b128 v[100:103], v8 offset:1024
    ds_read_b128 v[104:107], v8 offset:2048
    ds_read_b128 v[108:111], v8 offset:3072
    ds_read_b128 v[112:115], v8 offset:4096
    s_waitcnt lgkmcnt(0)
    v_pk_add_f32 v[76:77], v[76:77], v[96:97]
    v_pk_add_f32 v[78:79], v[78:79], v[98:99]
    v_pk_add_f32 v[80:81], v[80:81], v[100:101]
    v_pk_add_f32 v[82:83], v[82:83], v[102:103]
    v_pk_add_f32 v[84:85], v[84:85], v[104:105]
    v_pk_add_f32 v[86:87], v[86:87], v[106:107]
    v_pk_add_f32 v[88:89], v[88:89], v[108:109]
    v_pk_add_f32 v[90:91], v[90:91], v[110:111]
    v_pk_add_f32 v[92:93], v[92:93], v[112:113]
    v_pk_add_f32 v[94:95], v[94:95], v[114:115]
    s_branch k1_kernel_qepi79
k1_kernel_QN77:
    s_barrier
    s_mov_b32 s40, 0
    s_mov_b32 s42, 28672
    ds_read_b64 v[12:13], v144
    ds_read_b64 v[14:15], v145
    ds_read_b64 v[16:17], v146
    ds_read_b64 v[18:19], v147
    ds_read_b64_tr_b16 v[28:29], v148 offset:0
    ds_read_b64_tr_b16 v[30:31], v148 offset:2560
    ds_read_b64_tr_b16 v[32:33], v148 offset:32
    ds_read_b64_tr_b16 v[34:35], v148 offset:2592
    ds_read_b64_tr_b16 v[36:37], v148 offset:64
    ds_read_b64_tr_b16 v[38:39], v148 offset:2624
    ds_read_b64_tr_b16 v[40:41], v148 offset:96
    ds_read_b64_tr_b16 v[42:43], v148 offset:2656
    ds_read_b64_tr_b16 v[44:45], v148 offset:128
    ds_read_b64_tr_b16 v[46:47], v148 offset:2688
    ds_read_b64_tr_b16 v[68:69], v149
    ds_read_b64_tr_b16 v[70:71], v149 offset:512
    s_add_u32 s40, s40, 1
    s_and_b32 s8, s40, 3
    s_cmp_eq_u32 s8, 0
    s_cselect_b32 s8, 4294881280, s42
    v_add_u32 v144, s8, v144
    v_add_u32 v145, s8, v145
    v_add_u32 v146, s8, v146
    v_add_u32 v147, s8, v147
    v_add_u32 v148, s8, v148
    s_add_u32 s61, s61, 1
    s_cmp_eq_u32 s61, 10
    s_cselect_b32 s7, 4294948864, s82
    v_add_u32 v149, s7, v149
.p2align 6
k1_kernel_loop87:
    s_waitcnt lgkmcnt(0)
    s_barrier
    ds_read_b64 v[20:21], v144
    ds_read_b64 v[22:23], v145
    v_mfma_f32_16x16x32_bf16 v[76:79], v[28:31], v[12:15], v[76:79]
    ds_read_b64 v[24:25], v146
    ds_read_b64 v[26:27], v147
    v_mfma_f32_16x16x32_bf16 v[96:99], v[28:31], v[16:19], v[96:99]
    ds_read_b64_tr_b16 v[48:49], v148 offset:0
    ds_read_b64_tr_b16 v[50:51], v148 offset:2560
    v_mfma_f32_16x16x32_bf16 v[80:83], v[32:35], v[12:15], v[80:83]
    ds_read_b64_tr_b16 v[52:53], v148 offset:32
    ds_read_b64_tr_b16 v[54:55], v148 offset:2592
    v_mfma_f32_16x16x32_bf16 v[100:103], v[32:35], v[16:19], v[100:103]
    ds_read_b64_tr_b16 v[56:57], v148 offset:64
    ds_read_b64_tr_b16 v[58:59], v148 offset:2624
    ds_read_b64_tr_b16 v[60:61], v148 offset:96
    v_mfma_f32_16x16x32_bf16 v[84:87], v[36:39], v[12:15], v[84:87]
    ds_read_b64_tr_b16 v[62:63], v148 offset:2656
    ds_read_b64_tr_b16 v[64:65], v148 offset:128
    v_mfma_f32_16x16x32_bf16 v[104:107], v[36:39], v[16:19], v[104:107]
    ds_read_b64_tr_b16 v[66:67], v148 offset:2688
    ds_read_b64_tr_b16 v[72:73], v149
    v_mfma_f32_16x16x32_bf16 v[88:91], v[40:43], v[12:15], v[88:91]
    ds_read_b64_tr_b16 v[74:75], v149 offset:512
    s_add_u32 s40, s40, 1
    v_mfma_f32_16x16x32_bf16 v[108:111], v[40:43], v[16:19], v[108:111]
    s_and_b32 s8, s40, 3
    s_cmp_eq_u32 s8, 0
    s_cselect_b32 s8, 4294881280, s42
    v_mfma_f32_16x16x32_bf16 v[92:95], v[44:47], v[12:15], v[92:95]
    v_add_u32 v144, s8, v144
    v_add_u32 v145, s8, v145
    v_mfma_f32_16x16x32_bf16 v[112:115], v[44:47], v[16:19], v[112:115]
    v_add_u32 v146, s8, v146
    v_add_u32 v147, s8, v147
    v_mfma_f32_16x16x32_bf16 v[116:119], v[68:71], v[12:15], v[116:119]
    v_add_u32 v148, s8, v148
    s_add_u32 s61, s61, 1
    v_mfma_f32_16x16x32_bf16 v[120:123], v[68:71], v[16:19], v[120:123]
    s_cmp_eq_u32 s61, 10
    s_cselect_b32 s7, 4294948864, s82
    v_add_u32 v149, s7, v149
    s_cmp_lg_u32 s40, 4
    s_cbranch_scc1 k1_kernel_cp89
    s_getpc_b64 s[48:49]
k1_kernel_here90:
    s_add_u32 s48, s48, k2_kernel-k1_kernel_here90
    s_addc_u32 s49, s49, 0
    v_lshlrev_b32 v9, 7, v0
    v_cmp_gt_u32 vcc, K2_CODE_BYTES, v9
    s_and_saveexec_b64 s[36:37], vcc
    s_cbranch_execz k1_kernel_cz91
    global_load_dword v11, v9, s[48:49]
k1_kernel_cz91:
    s_mov_b64 exec, s[36:37]
k1_kernel_cp89:
    s_waitcnt lgkmcnt(0)
    s_cmp_eq_u32 s40, 10
    s_cbranch_scc1 k1_kernel_last88
    s_barrier
    ds_read_b64 v[12:13], v144
    ds_read_b64 v[14:15], v145
    v_mfma_f32_16x16x32_bf16 v[76:79], v[48:51], v[20:23], v[76:79]
    ds_read_b64 v[16:17], v146
    ds_read_b64 v[18:19], v147
    v_mfma_f32_16x16x32_bf16 v[96:99], v[48:51], v[24:27], v[96:99]
    ds_read_b64_tr_b16 v[28:29], v148 offset:0
    ds_read_b64_tr_b16 v[30:31], v148 offset:2560
    v_mfma_f32_16x16x32_bf16 v[80:83], v[52:55], v[20:23], v[80:83]
    ds_read_b64_tr_b16 v[32:33], v148 offset:32
    ds_read_b64_tr_b16 v[34:35], v148 offset:2592
    v_mfma_f32_16x16x32_bf16 v[100:103], v[52:55], v[24:27], v[100:103]
    ds_read_b64_tr_b16 v[36:37], v148 offset:64
    ds_read_b64_tr_b16 v[38:39], v148 offset:2624
    ds_read_b64_tr_b16 v[40:41], v148 offset:96
    v_mfma_f32_16x16x32_bf16 v[84:87], v[56:59], v[20:23], v[84:87]
    ds_read_b64_tr_b16 v[42:43], v148 offset:2656
    ds_read_b64_tr_b16 v[44:45], v148 offset:128
    v_mfma_f32_16x16x32_bf16 v[104:107], v[56:59], v[24:27], v[104:107]
    ds_read_b64_tr_b16 v[46:47], v148 offset:2688
    ds_read_b64_tr_b16 v[68:69], v149
    v_mfma_f32_16x16x32_bf16 v[88:91], v[60:63], v[20:23], v[88:91]
    ds_read_b64_tr_b16 v[70:71], v149 offset:512
    s_add_u32 s40, s40, 1
    v_mfma_f32_16x16x32_bf16 v[108:111], v[60:63], v[24:27], v[108:111]
    s_and_b32 s8, s40, 3
    s_cmp_eq_u32 s8, 0
    s_cselect_b32 s8, 4294881280, s42
    v_mfma_f32_16x16x32_bf16 v[92:95], v[64:67], v[20:23], v[92:95]
    v_add_u32 v144, s8, v144
    v_add_u32 v145, s8, v145
    v_mfma_f32_16x16x32_bf16 v[112:115], v[64:67], v[24:27], v[112:115]
    v_add_u32 v146, s8, v146
    v_add_u32 v147, s8, v147
    v_mfma_f32_16x16x32_bf16 v[116:119], v[72:75], v[20:23], v[116:119]
    v_add_u32 v148, s8, v148
    s_add_u32 s61, s61, 1
    v_mfma_f32_16x16x32_bf16 v[120:123], v[72:75], v[24:27], v[120:123]
    s_cmp_eq_u32 s61, 10
    s_cselect_b32 s7, 4294948864, s82
    v_add_u32 v149, s7, v149
    s_branch k1_kernel_loop87
k1_kernel_last88:
    v_mfma_f32_16x16x32_bf16 v[76:79], v[48:51], v[20:23], v[76:79]
    v_mfma_f32_16x16x32_bf16 v[96:99], v[48:51], v[24:27], v[96:99]
    v_mfma_f32_16x16x32_bf16 v[80:83], v[52:55], v[20:23], v[80:83]
    v_mfma_f32_16x16x32_bf16 v[100:103], v[52:55], v[24:27], v[100:103]
    v_mfma_f32_16x16x32_bf16 v[84:87], v[56:59], v[20:23], v[84:87]
    v_mfma_f32_16x16x32_bf16 v[104:107], v[56:59], v[24:27], v[104:107]
    v_mfma_f32_16x16x32_bf16 v[88:91], v[60:63], v[20:23], v[88:91]
    v_mfma_f32_16x16x32_bf16 v[108:111], v[60:63], v[24:27], v[108:111]
    v_mfma_f32_16x16x32_bf16 v[92:95], v[64:67], v[20:23], v[92:95]
    v_mfma_f32_16x16x32_bf16 v[112:115], v[64:67], v[24:27], v[112:115]
    v_mfma_f32_16x16x32_bf16 v[116:119], v[72:75], v[20:23], v[116:119]
    v_mfma_f32_16x16x32_bf16 v[120:123], v[72:75], v[24:27], v[120:123]
    s_nop 7
    s_xor_b32 s6, s3, 1
    s_mul_i32 s6, s6, 7168
    s_add_u32 s6, s6, 57344
    v_lshlrev_b32 v9, 4, v1
    v_add_u32 v8, s6, v9
    s_cmp_eq_u32 s45, 1
    s_cbranch_scc1 k1_kernel_x192
    ds_write_b128 v8, v[96:99] offset:0
    ds_write_b128 v8, v[100:103] offset:1024
    ds_write_b128 v8, v[104:107] offset:2048
    ds_write_b128 v8, v[108:111] offset:3072
    ds_write_b128 v8, v[112:115] offset:4096
    ds_write_b128 v8, v[120:123] offset:5120
    s_branch k1_kernel_x293
k1_kernel_x192:
    ds_write_b128 v8, v[76:79] offset:0
    ds_write_b128 v8, v[80:83] offset:1024
    ds_write_b128 v8, v[84:87] offset:2048
    ds_write_b128 v8, v[88:91] offset:3072
    ds_write_b128 v8, v[92:95] offset:4096
    ds_write_b128 v8, v[116:119] offset:5120
    s_waitcnt lgkmcnt(0)
    v_mov_b32 v76, v96
    v_mov_b32 v77, v97
    v_mov_b32 v78, v98
    v_mov_b32 v79, v99
    v_mov_b32 v80, v100
    v_mov_b32 v81, v101
    v_mov_b32 v82, v102
    v_mov_b32 v83, v103
    v_mov_b32 v84, v104
    v_mov_b32 v85, v105
    v_mov_b32 v86, v106
    v_mov_b32 v87, v107
    v_mov_b32 v88, v108
    v_mov_b32 v89, v109
    v_mov_b32 v90, v110
    v_mov_b32 v91, v111
    v_mov_b32 v92, v112
    v_mov_b32 v93, v113
    v_mov_b32 v94, v114
    v_mov_b32 v95, v115
    v_mov_b32 v116, v120
    v_mov_b32 v117, v121
    v_mov_b32 v118, v122
    v_mov_b32 v119, v123
k1_kernel_x293:
    s_waitcnt lgkmcnt(0)
    s_barrier
    s_mul_i32 s6, s3, 7168
    s_add_u32 s6, s6, 57344
    v_add_u32 v8, s6, v9
    ds_read_b128 v[96:99], v8 offset:0
    ds_read_b128 v[100:103], v8 offset:1024
    ds_read_b128 v[104:107], v8 offset:2048
    ds_read_b128 v[108:111], v8 offset:3072
    ds_read_b128 v[112:115], v8 offset:4096
    ds_read_b128 v[120:123], v8 offset:5120
    s_waitcnt lgkmcnt(0)
    v_pk_add_f32 v[76:77], v[76:77], v[96:97]
    v_pk_add_f32 v[78:79], v[78:79], v[98:99]
    v_pk_add_f32 v[80:81], v[80:81], v[100:101]
    v_pk_add_f32 v[82:83], v[82:83], v[102:103]
    v_pk_add_f32 v[84:85], v[84:85], v[104:105]
    v_pk_add_f32 v[86:87], v[86:87], v[106:107]
    v_pk_add_f32 v[88:89], v[88:89], v[108:109]
    v_pk_add_f32 v[90:91], v[90:91], v[110:111]
    v_pk_add_f32 v[92:93], v[92:93], v[112:113]
    v_pk_add_f32 v[94:95], v[94:95], v[114:115]
    v_pk_add_f32 v[116:117], v[116:117], v[120:121]
    v_pk_add_f32 v[118:119], v[118:119], v[122:123]
    s_branch k1_kernel_qepi79
k1_kernel_QS78:
    s_barrier
    s_mov_b32 s40, 0
    s_mov_b32 s42, 28672
    ds_read_b64 v[12:13], v144
    ds_read_b64 v[14:15], v145
    ds_read_b64 v[16:17], v146
    ds_read_b64 v[18:19], v147
    ds_read_b64_tr_b16 v[28:29], v148 offset:0
    ds_read_b64_tr_b16 v[30:31], v148 offset:2560
    ds_read_b64_tr_b16 v[32:33], v148 offset:32
    ds_read_b64_tr_b16 v[34:35], v148 offset:2592
    ds_read_b64_tr_b16 v[36:37], v148 offset:64
    ds_read_b64_tr_b16 v[38:39], v148 offset:2624
    ds_read_b64_tr_b16 v[40:41], v148 offset:96
    ds_read_b64_tr_b16 v[42:43], v148 offset:2656
    ds_read_b64_tr_b16 v[44:45], v148 offset:128
    ds_read_b64_tr_b16 v[46:47], v148 offset:2688
    ds_read_b64_tr_b16 v[68:69], v149
    ds_read_b64_tr_b16 v[70:71], v149 offset:512
    s_add_u32 s40, s40, 1
    s_and_b32 s8, s40, 3
    s_cmp_eq_u32 s8, 0
    s_cselect_b32 s8, 4294881280, s42
    v_add_u32 v144, s8, v144
    v_add_u32 v145, s8, v145
    v_add_u32 v146, s8, v146
    v_add_u32 v147, s8, v147
    v_add_u32 v148, s8, v148
    s_add_u32 s61, s61, 1
    s_cmp_eq_u32 s61, 10
    s_cselect_b32 s7, 4294948864, s82
    v_add_u32 v149, s7, v149
.p2align 6
k1_kernel_loop94:
    s_waitcnt lgkmcnt(0)
    s_barrier
    ds_read_b64 v[20:21], v144
    ds_read_b64 v[22:23], v145
    v_mfma_f32_16x16x32_bf16 v[76:79], v[28:31], v[12:15], v[76:79]
    ds_read_b64 v[24:25], v146
    ds_read_b64 v[26:27], v147
    v_mfma_f32_16x16x32_bf16 v[96:99], v[28:31], v[16:19], v[96:99]
    ds_read_b64_tr_b16 v[48:49], v148 offset:0
    ds_read_b64_tr_b16 v[50:51], v148 offset:2560
    v_mfma_f32_16x16x32_bf16 v[80:83], v[32:35], v[12:15], v[80:83]
    ds_read_b64_tr_b16 v[52:53], v148 offset:32
    ds_read_b64_tr_b16 v[54:55], v148 offset:2592
    v_mfma_f32_16x16x32_bf16 v[100:103], v[32:35], v[16:19], v[100:103]
    ds_read_b64_tr_b16 v[56:57], v148 offset:64
    ds_read_b64_tr_b16 v[58:59], v148 offset:2624
    ds_read_b64_tr_b16 v[60:61], v148 offset:96
    v_mfma_f32_16x16x32_bf16 v[84:87], v[36:39], v[12:15], v[84:87]
    ds_read_b64_tr_b16 v[62:63], v148 offset:2656
    ds_read_b64_tr_b16 v[64:65], v148 offset:128
    v_mfma_f32_16x16x32_bf16 v[104:107], v[36:39], v[16:19], v[104:107]
    ds_read_b64_tr_b16 v[66:67], v148 offset:2688
    ds_read_b64_tr_b16 v[72:73], v149
    v_mfma_f32_16x16x32_bf16 v[88:91], v[40:43], v[12:15], v[88:91]
    ds_read_b64_tr_b16 v[74:75], v149 offset:512
    s_add_u32 s40, s40, 1
    v_mfma_f32_16x16x32_bf16 v[108:111], v[40:43], v[16:19], v[108:111]
    s_and_b32 s8, s40, 3
    s_cmp_eq_u32 s8, 0
    s_cselect_b32 s8, 4294881280, s42
    v_mfma_f32_16x16x32_bf16 v[92:95], v[44:47], v[12:15], v[92:95]
    v_add_u32 v144, s8, v144
    v_add_u32 v145, s8, v145
    v_mfma_f32_16x16x32_bf16 v[112:115], v[44:47], v[16:19], v[112:115]
    v_add_u32 v146, s8, v146
    v_add_u32 v147, s8, v147
    v_mfma_f32_16x16x32_bf16 v[116:119], v[12:15], v[68:71], v[116:119]
    v_add_u32 v148, s8, v148
    s_add_u32 s61, s61, 1
    v_mfma_f32_16x16x32_bf16 v[120:123], v[16:19], v[68:71], v[120:123]
    s_cmp_eq_u32 s61, 10
    s_cselect_b32 s7, 4294948864, s82
    v_add_u32 v149, s7, v149
    s_cmp_lg_u32 s40, 4
    s_cbranch_scc1 k1_kernel_cp96
    s_getpc_b64 s[48:49]
k1_kernel_here97:
    s_add_u32 s48, s48, k2_kernel-k1_kernel_here97
    s_addc_u32 s49, s49, 0
    v_lshlrev_b32 v9, 7, v0
    v_cmp_gt_u32 vcc, K2_CODE_BYTES, v9
    s_and_saveexec_b64 s[36:37], vcc
    s_cbranch_execz k1_kernel_cz98
    global_load_dword v11, v9, s[48:49]
k1_kernel_cz98:
    s_mov_b64 exec, s[36:37]
k1_kernel_cp96:
    s_waitcnt lgkmcnt(0)
    s_cmp_eq_u32 s40, 10
    s_cbranch_scc1 k1_kernel_last95
    s_barrier
    ds_read_b64 v[12:13], v144
    ds_read_b64 v[14:15], v145
    v_mfma_f32_16x16x32_bf16 v[76:79], v[48:51], v[20:23], v[76:79]
    ds_read_b64 v[16:17], v146
    ds_read_b64 v[18:19], v147
    v_mfma_f32_16x16x32_bf16 v[96:99], v[48:51], v[24:27], v[96:99]
    ds_read_b64_tr_b16 v[28:29], v148 offset:0
    ds_read_b64_tr_b16 v[30:31], v148 offset:2560
    v_mfma_f32_16x16x32_bf16 v[80:83], v[52:55], v[20:23], v[80:83]
    ds_read_b64_tr_b16 v[32:33], v148 offset:32
    ds_read_b64_tr_b16 v[34:35], v148 offset:2592
    v_mfma_f32_16x16x32_bf16 v[100:103], v[52:55], v[24:27], v[100:103]
    ds_read_b64_tr_b16 v[36:37], v148 offset:64
    ds_read_b64_tr_b16 v[38:39], v148 offset:2624
    ds_read_b64_tr_b16 v[40:41], v148 offset:96
    v_mfma_f32_16x16x32_bf16 v[84:87], v[56:59], v[20:23], v[84:87]
    ds_read_b64_tr_b16 v[42:43], v148 offset:2656
    ds_read_b64_tr_b16 v[44:45], v148 offset:128
    v_mfma_f32_16x16x32_bf16 v[104:107], v[56:59], v[24:27], v[104:107]
    ds_read_b64_tr_b16 v[46:47], v148 offset:2688
    ds_read_b64_tr_b16 v[68:69], v149
    v_mfma_f32_16x16x32_bf16 v[88:91], v[60:63], v[20:23], v[88:91]
    ds_read_b64_tr_b16 v[70:71], v149 offset:512
    s_add_u32 s40, s40, 1
    v_mfma_f32_16x16x32_bf16 v[108:111], v[60:63], v[24:27], v[108:111]
    s_and_b32 s8, s40, 3
    s_cmp_eq_u32 s8, 0
    s_cselect_b32 s8, 4294881280, s42
    v_mfma_f32_16x16x32_bf16 v[92:95], v[64:67], v[20:23], v[92:95]
    v_add_u32 v144, s8, v144
    v_add_u32 v145, s8, v145
    v_mfma_f32_16x16x32_bf16 v[112:115], v[64:67], v[24:27], v[112:115]
    v_add_u32 v146, s8, v146
    v_add_u32 v147, s8, v147
    v_mfma_f32_16x16x32_bf16 v[116:119], v[20:23], v[72:75], v[116:119]
    v_add_u32 v148, s8, v148
    s_add_u32 s61, s61, 1
    v_mfma_f32_16x16x32_bf16 v[120:123], v[24:27], v[72:75], v[120:123]
    s_cmp_eq_u32 s61, 10
    s_cselect_b32 s7, 4294948864, s82
    v_add_u32 v149, s7, v149
    s_branch k1_kernel_loop94
k1_kernel_last95:
    v_mfma_f32_16x16x32_bf16 v[76:79], v[48:51], v[20:23], v[76:79]
    v_mfma_f32_16x16x32_bf16 v[96:99], v[48:51], v[24:27], v[96:99]
    v_mfma_f32_16x16x32_bf16 v[80:83], v[52:55], v[20:23], v[80:83]
    v_mfma_f32_16x16x32_bf16 v[100:103], v[52:55], v[24:27], v[100:103]
    v_mfma_f32_16x16x32_bf16 v[84:87], v[56:59], v[20:23], v[84:87]
    v_mfma_f32_16x16x32_bf16 v[104:107], v[56:59], v[24:27], v[104:107]
    v_mfma_f32_16x16x32_bf16 v[88:91], v[60:63], v[20:23], v[88:91]
    v_mfma_f32_16x16x32_bf16 v[108:111], v[60:63], v[24:27], v[108:111]
    v_mfma_f32_16x16x32_bf16 v[92:95], v[64:67], v[20:23], v[92:95]
    v_mfma_f32_16x16x32_bf16 v[112:115], v[64:67], v[24:27], v[112:115]
    v_mfma_f32_16x16x32_bf16 v[116:119], v[20:23], v[72:75], v[116:119]
    v_mfma_f32_16x16x32_bf16 v[120:123], v[24:27], v[72:75], v[120:123]
    s_nop 7
    s_xor_b32 s6, s3, 1
    s_mul_i32 s6, s6, 7168
    s_add_u32 s6, s6, 57344
    v_lshlrev_b32 v9, 4, v1
    v_add_u32 v8, s6, v9
    s_cmp_eq_u32 s45, 1
    s_cbranch_scc1 k1_kernel_x199
    ds_write_b128 v8, v[96:99] offset:0
    ds_write_b128 v8, v[100:103] offset:1024
    ds_write_b128 v8, v[104:107] offset:2048
    ds_write_b128 v8, v[108:111] offset:3072
    ds_write_b128 v8, v[112:115] offset:4096
    ds_write_b128 v8, v[120:123] offset:5120
    s_branch k1_kernel_x2100
k1_kernel_x199:
    ds_write_b128 v8, v[76:79] offset:0
    ds_write_b128 v8, v[80:83] offset:1024
    ds_write_b128 v8, v[84:87] offset:2048
    ds_write_b128 v8, v[88:91] offset:3072
    ds_write_b128 v8, v[92:95] offset:4096
    ds_write_b128 v8, v[116:119] offset:5120
    s_waitcnt lgkmcnt(0)
    v_mov_b32 v76, v96
    v_mov_b32 v77, v97
    v_mov_b32 v78, v98
    v_mov_b32 v79, v99
    v_mov_b32 v80, v100
    v_mov_b32 v81, v101
    v_mov_b32 v82, v102
    v_mov_b32 v83, v103
    v_mov_b32 v84, v104
    v_mov_b32 v85, v105
    v_mov_b32 v86, v106
    v_mov_b32 v87, v107
    v_mov_b32 v88, v108
    v_mov_b32 v89, v109
    v_mov_b32 v90, v110
    v_mov_b32 v91, v111
    v_mov_b32 v92, v112
    v_mov_b32 v93, v113
    v_mov_b32 v94, v114
    v_mov_b32 v95, v115
    v_mov_b32 v116, v120
    v_mov_b32 v117, v121
    v_mov_b32 v118, v122
    v_mov_b32 v119, v123
k1_kernel_x2100:
    s_waitcnt lgkmcnt(0)
    s_barrier
    s_mul_i32 s6, s3, 7168
    s_add_u32 s6, s6, 57344
    v_add_u32 v8, s6, v9
    ds_read_b128 v[96:99], v8 offset:0
    ds_read_b128 v[100:103], v8 offset:1024
    ds_read_b128 v[104:107], v8 offset:2048
    ds_read_b128 v[108:111], v8 offset:3072
    ds_read_b128 v[112:115], v8 offset:4096
    ds_read_b128 v[120:123], v8 offset:5120
    s_waitcnt lgkmcnt(0)
    v_pk_add_f32 v[76:77], v[76:77], v[96:97]
    v_pk_add_f32 v[78:79], v[78:79], v[98:99]
    v_pk_add_f32 v[80:81], v[80:81], v[100:101]
    v_pk_add_f32 v[82:83], v[82:83], v[102:103]
    v_pk_add_f32 v[84:85], v[84:85], v[104:105]
    v_pk_add_f32 v[86:87], v[86:87], v[106:107]
    v_pk_add_f32 v[88:89], v[88:89], v[108:109]
    v_pk_add_f32 v[90:91], v[90:91], v[110:111]
    v_pk_add_f32 v[92:93], v[92:93], v[112:113]
    v_pk_add_f32 v[94:95], v[94:95], v[114:115]
    v_pk_add_f32 v[116:117], v[116:117], v[120:121]
    v_pk_add_f32 v[118:119], v[118:119], v[122:123]
    s_branch k1_kernel_qepi79
k1_kernel_H76:
    s_cmp_eq_u32 s46, 1
    s_cbranch_scc1 k1_kernel_H1101
    s_barrier
    s_mov_b32 s40, 0
    s_mov_b32 s42, 28672
    ds_read_b64 v[12:13], v144
    ds_read_b64 v[14:15], v145
    ds_read_b64 v[16:17], v146
    ds_read_b64 v[18:19], v147
    ds_read_b64_tr_b16 v[28:29], v148 offset:0
    ds_read_b64_tr_b16 v[30:31], v148 offset:2560
    ds_read_b64_tr_b16 v[32:33], v148 offset:32
    ds_read_b64_tr_b16 v[34:35], v148 offset:2592
    ds_read_b64_tr_b16 v[36:37], v148 offset:64
    ds_read_b64_tr_b16 v[38:39], v148 offset:2624
    ds_read_b64_tr_b16 v[40:41], v148 offset:96
    ds_read_b64_tr_b16 v[42:43], v148 offset:2656
    ds_read_b64_tr_b16 v[44:45], v148 offset:128
    ds_read_b64_tr_b16 v[46:47], v148 offset:2688
    s_add_u32 s40, s40, 1
    s_and_b32 s8, s40, 3
    s_cmp_eq_u32 s8, 0
    s_cselect_b32 s8, 4294881280, s42
    v_add_u32 v144, s8, v144
    v_add_u32 v145, s8, v145
    v_add_u32 v146, s8, v146
    v_add_u32 v147, s8, v147
    v_add_u32 v148, s8, v148
    s_add_u32 s61, s61, 1
    s_cmp_eq_u32 s61, 10
    s_cselect_b32 s7, 4294948864, s82
    v_add_u32 v149, s7, v149
.p2align 6
k1_kernel_loop103:
    s_waitcnt lgkmcnt(0)
    s_barrier
    ds_read_b64 v[20:21], v144
    ds_read_b64 v[22:23], v145
    v_mfma_f32_16x16x32_bf16 v[76:79], v[28:31], v[12:15], v[76:79]
    ds_read_b64 v[24:25], v146
    v_mfma_f32_16x16x32_bf16 v[96:99], v[28:31], v[16:19], v[96:99]
    ds_read_b64 v[26:27], v147
    v_mfma_f32_16x16x32_bf16 v[80:83], v[32:35], v[12:15], v[80:83]
    ds_read_b64_tr_b16 v[48:49], v148 offset:0
    ds_read_b64_tr_b16 v[50:51], v148 offset:2560
    v_mfma_f32_16x16x32_bf16 v[100:103], v[32:35], v[16:19], v[100:103]
    ds_read_b64_tr_b16 v[52:53], v148 offset:32
    v_mfma_f32_16x16x32_bf16 v[84:87], v[36:39], v[12:15], v[84:87]
    ds_read_b64_tr_b16 v[54:55], v148 offset:2592
    ds_read_b64_tr_b16 v[56:57], v148 offset:64
    v_mfma_f32_16x16x32_bf16 v[104:107], v[36:39], v[16:19], v[104:107]
    ds_read_b64_tr_b16 v[58:59], v148 offset:2624
    v_mfma_f32_16x16x32_bf16 v[88:91], v[40:43], v[12:15], v[88:91]
    ds_read_b64_tr_b16 v[60:61], v148 offset:96
    ds_read_b64_tr_b16 v[62:63], v148 offset:2656
    v_mfma_f32_16x16x32_bf16 v[108:111], v[40:43], v[16:19], v[108:111]
    ds_read_b64_tr_b16 v[64:65], v148 offset:128
    v_mfma_f32_16x16x32_bf16 v[92:95], v[44:47], v[12:15], v[92:95]
    ds_read_b64_tr_b16 v[66:67], v148 offset:2688
    s_add_u32 s40, s40, 1
    v_mfma_f32_16x16x32_bf16 v[112:115], v[44:47], v[16:19], v[112:115]
    s_and_b32 s8, s40, 3
    v_mfma_f32_16x16x32_bf16 v[116:119], v[152:155], v[12:15], v[116:119]
    s_cmp_eq_u32 s8, 0
    s_cselect_b32 s8, 4294881280, s42
    v_mfma_f32_16x16x32_bf16 v[124:127], v[12:15], v[12:15], v[124:127]
    v_add_u32 v144, s8, v144
    v_mfma_f32_16x16x32_bf16 v[120:123], v[152:155], v[16:19], v[120:123]
    v_add_u32 v145, s8, v145
    v_add_u32 v146, s8, v146
    v_mfma_f32_16x16x32_bf16 v[128:131], v[16:19], v[16:19], v[128:131]
    v_add_u32 v147, s8, v147
    v_mfma_f32_16x16x32_bf16 v[132:135], v[28:31], v[152:155], v[132:135]
    v_add_u32 v148, s8, v148
    s_add_u32 s61, s61, 1
    v_mfma_f32_16x16x32_bf16 v[136:139], v[32:35], v[152:155], v[136:139]
    s_cmp_eq_u32 s61, 10
    v_mfma_f32_16x16x32_bf16 v[140:143], v[36:39], v[152:155], v[140:143]
    s_cselect_b32 s7, 4294948864, s82
    v_add_u32 v149, s7, v149
    s_cmp_lg_u32 s40, 4
    s_cbranch_scc1 k1_kernel_cp105
    s_getpc_b64 s[48:49]
k1_kernel_here106:
    s_add_u32 s48, s48, k2_kernel-k1_kernel_here106
    s_addc_u32 s49, s49, 0
    v_lshlrev_b32 v9, 7, v0
    v_cmp_gt_u32 vcc, K2_CODE_BYTES, v9
    s_and_saveexec_b64 s[36:37], vcc
    s_cbranch_execz k1_kernel_cz107
    global_load_dword v11, v9, s[48:49]
k1_kernel_cz107:
    s_mov_b64 exec, s[36:37]
k1_kernel_cp105:
    s_waitcnt lgkmcnt(0)
    s_cmp_eq_u32 s40, 10
    s_cbranch_scc1 k1_kernel_last104
    s_barrier
    ds_read_b64 v[12:13], v144
    ds_read_b64 v[14:15], v145
    v_mfma_f32_16x16x32_bf16 v[76:79], v[48:51], v[20:23], v[76:79]
    ds_read_b64 v[16:17], v146
    v_mfma_f32_16x16x32_bf16 v[96:99], v[48:51], v[24:27], v[96:99]
    ds_read_b64 v[18:19], v147
    v_mfma_f32_16x16x32_bf16 v[80:83], v[52:55], v[20:23], v[80:83]
    ds_read_b64_tr_b16 v[28:29], v148 offset:0
    ds_read_b64_tr_b16 v[30:31], v148 offset:2560
    v_mfma_f32_16x16x32_bf16 v[100:103], v[52:55], v[24:27], v[100:103]
    ds_read_b64_tr_b16 v[32:33], v148 offset:32
    v_mfma_f32_16x16x32_bf16 v[84:87], v[56:59], v[20:23], v[84:87]
    ds_read_b64_tr_b16 v[34:35], v148 offset:2592
    ds_read_b64_tr_b16 v[36:37], v148 offset:64
    v_mfma_f32_16x16x32_bf16 v[104:107], v[56:59], v[24:27], v[104:107]
    ds_read_b64_tr_b16 v[38:39], v148 offset:2624
    v_mfma_f32_16x16x32_bf16 v[88:91], v[60:63], v[20:23], v[88:91]
    ds_read_b64_tr_b16 v[40:41], v148 offset:96
    ds_read_b64_tr_b16 v[42:43], v148 offset:2656
    v_mfma_f32_16x16x32_bf16 v[108:111], v[60:63], v[24:27], v[108:111]
    ds_read_b64_tr_b16 v[44:45], v148 offset:128
    v_mfma_f32_16x16x32_bf16 v[92:95], v[64:67], v[20:23], v[92:95]
    ds_read_b64_tr_b16 v[46:47], v148 offset:2688
    s_add_u32 s40, s40, 1
    v_mfma_f32_16x16x32_bf16 v[112:115], v[64:67], v[24:27], v[112:115]
    s_and_b32 s8, s40, 3
    v_mfma_f32_16x16x32_bf16 v[116:119], v[152:155], v[20:23], v[116:119]
    s_cmp_eq_u32 s8, 0
    s_cselect_b32 s8, 4294881280, s42
    v_mfma_f32_16x16x32_bf16 v[124:127], v[20:23], v[20:23], v[124:127]
    v_add_u32 v144, s8, v144
    v_mfma_f32_16x16x32_bf16 v[120:123], v[152:155], v[24:27], v[120:123]
    v_add_u32 v145, s8, v145
    v_add_u32 v146, s8, v146
    v_mfma_f32_16x16x32_bf16 v[128:131], v[24:27], v[24:27], v[128:131]
    v_add_u32 v147, s8, v147
    v_mfma_f32_16x16x32_bf16 v[132:135], v[48:51], v[152:155], v[132:135]
    v_add_u32 v148, s8, v148
    s_add_u32 s61, s61, 1
    v_mfma_f32_16x16x32_bf16 v[136:139], v[52:55], v[152:155], v[136:139]
    s_cmp_eq_u32 s61, 10
    v_mfma_f32_16x16x32_bf16 v[140:143], v[56:59], v[152:155], v[140:143]
    s_cselect_b32 s7, 4294948864, s82
    v_add_u32 v149, s7, v149
    s_branch k1_kernel_loop103
k1_kernel_last104:
    v_mfma_f32_16x16x32_bf16 v[76:79], v[48:51], v[20:23], v[76:79]
    v_mfma_f32_16x16x32_bf16 v[96:99], v[48:51], v[24:27], v[96:99]
    v_mfma_f32_16x16x32_bf16 v[80:83], v[52:55], v[20:23], v[80:83]
    v_mfma_f32_16x16x32_bf16 v[100:103], v[52:55], v[24:27], v[100:103]
    v_mfma_f32_16x16x32_bf16 v[84:87], v[56:59], v[20:23], v[84:87]
    v_mfma_f32_16x16x32_bf16 v[104:107], v[56:59], v[24:27], v[104:107]
    v_mfma_f32_16x16x32_bf16 v[88:91], v[60:63], v[20:23], v[88:91]
    v_mfma_f32_16x16x32_bf16 v[108:111], v[60:63], v[24:27], v[108:111]
    v_mfma_f32_16x16x32_bf16 v[92:95], v[64:67], v[20:23], v[92:95]
    v_mfma_f32_16x16x32_bf16 v[112:115], v[64:67], v[24:27], v[112:115]
    v_mfma_f32_16x16x32_bf16 v[116:119], v[152:155], v[20:23], v[116:119]
    v_mfma_f32_16x16x32_bf16 v[124:127], v[20:23], v[20:23], v[124:127]
    v_mfma_f32_16x16x32_bf16 v[120:123], v[152:155], v[24:27], v[120:123]
    v_mfma_f32_16x16x32_bf16 v[128:131], v[24:27], v[24:27], v[128:131]
    v_mfma_f32_16x16x32_bf16 v[132:135], v[48:51], v[152:155], v[132:135]
    v_mfma_f32_16x16x32_bf16 v[136:139], v[52:55], v[152:155], v[136:139]
    v_mfma_f32_16x16x32_bf16 v[140:143], v[56:59], v[152:155], v[140:143]
    s_nop 7
    s_xor_b32 s6, s3, 1
    s_mul_i32 s6, s6, 7168
    s_add_u32 s6, s6, 57344
    v_lshlrev_b32 v9, 4, v1
    v_add_u32 v8, s6, v9
    s_cmp_eq_u32 s45, 1
    s_cbranch_scc1 k1_kernel_x1108
    ds_write_b128 v8, v[96:99] offset:0
    ds_write_b128 v8, v[100:103] offset:1024
    ds_write_b128 v8, v[104:107] offset:2048
    ds_write_b128 v8, v[108:111] offset:3072
    ds_write_b128 v8, v[112:115] offset:4096
    ds_write_b128 v8, v[120:123] offset:5120
    ds_write_b128 v8, v[128:131] offset:6144
    s_branch k1_kernel_x2109
k1_kernel_x1108:
    ds_write_b128 v8, v[76:79] offset:0
    ds_write_b128 v8, v[80:83] offset:1024
    ds_write_b128 v8, v[84:87] offset:2048
    ds_write_b128 v8, v[88:91] offset:3072
    ds_write_b128 v8, v[92:95] offset:4096
    ds_write_b128 v8, v[116:119] offset:5120
    ds_write_b128 v8, v[124:127] offset:6144
    s_waitcnt lgkmcnt(0)
    v_mov_b32 v76, v96
    v_mov_b32 v77, v97
    v_mov_b32 v78, v98
    v_mov_b32 v79, v99
    v_mov_b32 v80, v100
    v_mov_b32 v81, v101
    v_mov_b32 v82, v102
    v_mov_b32 v83, v103
    v_mov_b32 v84, v104
    v_mov_b32 v85, v105
    v_mov_b32 v86, v106
    v_mov_b32 v87, v107
    v_mov_b32 v88, v108
    v_mov_b32 v89, v109
    v_mov_b32 v90, v110
    v_mov_b32 v91, v111
    v_mov_b32 v92, v112
    v_mov_b32 v93, v113
    v_mov_b32 v94, v114
    v_mov_b32 v95, v115
    v_mov_b32 v116, v120
    v_mov_b32 v117, v121
    v_mov_b32 v118, v122
    v_mov_b32 v119, v123
    v_mov_b32 v124, v128
    v_mov_b32 v125, v129
    v_mov_b32 v126, v130
    v_mov_b32 v127, v131
k1_kernel_x2109:
    v_lshlrev_b32 v4, 4, v3
    s_mul_i32 s6, s43, 640
    s_mul_i32 s7, s45, 320
    s_add_u32 s6, s6, s7
    s_add_u32 s6, s6, 114688
    v_add_u32 v4, s6, v4
    s_mov_b32 s48, 0x00010001
    s_mov_b32 s49, 0x00010001
    s_mov_b64 exec, s[48:49]
    ds_write_b128 v4, v[132:135] offset:0
    ds_write_b128 v4, v[136:139] offset:64
    ds_write_b128 v4, v[140:143] offset:128
    s_mov_b64 exec, -1
    s_waitcnt lgkmcnt(0)
    s_barrier
    s_mul_i32 s6, s3, 7168
    s_add_u32 s6, s6, 57344
    v_add_u32 v8, s6, v9
    ds_read_b128 v[96:99], v8 offset:0
    ds_read_b128 v[100:103], v8 offset:1024
    ds_read_b128 v[104:107], v8 offset:2048
    ds_read_b128 v[108:111], v8 offset:3072
    ds_read_b128 v[112:115], v8 offset:4096
    ds_read_b128 v[120:123], v8 offset:5120
    ds_read_b128 v[128:131], v8 offset:6144
    s_waitcnt lgkmcnt(0)
    v_pk_add_f32 v[76:77], v[76:77], v[96:97]
    v_pk_add_f32 v[78:79], v[78:79], v[98:99]
    v_pk_add_f32 v[80:81], v[80:81], v[100:101]
    v_pk_add_f32 v[82:83], v[82:83], v[102:103]
    v_pk_add_f32 v[84:85], v[84:85], v[104:105]
    v_pk_add_f32 v[86:87], v[86:87], v[106:107]
    v_pk_add_f32 v[88:89], v[88:89], v[108:109]
    v_pk_add_f32 v[90:91], v[90:91], v[110:111]
    v_pk_add_f32 v[92:93], v[92:93], v[112:113]
    v_pk_add_f32 v[94:95], v[94:95], v[114:115]
    v_pk_add_f32 v[116:117], v[116:117], v[120:121]
    v_pk_add_f32 v[118:119], v[118:119], v[122:123]
    v_pk_add_f32 v[124:125], v[124:125], v[128:129]
    v_pk_add_f32 v[126:127], v[126:127], v[130:131]
    s_branch k1_kernel_HE102
k1_kernel_H1101:
    s_barrier
    s_mov_b32 s40, 0
    s_mov_b32 s42, 28672
    ds_read_b64 v[12:13], v144
    ds_read_b64 v[14:15], v145
    ds_read_b64 v[16:17], v146
    ds_read_b64 v[18:19], v147
    ds_read_b64_tr_b16 v[28:29], v148 offset:0
    ds_read_b64_tr_b16 v[30:31], v148 offset:2560
    ds_read_b64_tr_b16 v[32:33], v148 offset:32
    ds_read_b64_tr_b16 v[34:35], v148 offset:2592
    ds_read_b64_tr_b16 v[36:37], v148 offset:64
    ds_read_b64_tr_b16 v[38:39], v148 offset:2624
    ds_read_b64_tr_b16 v[40:41], v148 offset:96
    ds_read_b64_tr_b16 v[42:43], v148 offset:2656
    ds_read_b64_tr_b16 v[44:45], v148 offset:128
    ds_read_b64_tr_b16 v[46:47], v148 offset:2688
    s_add_u32 s40, s40, 1
    s_and_b32 s8, s40, 3
    s_cmp_eq_u32 s8, 0
    s_cselect_b32 s8, 4294881280, s42
    v_add_u32 v144, s8, v144
    v_add_u32 v145, s8, v145
    v_add_u32 v146, s8, v146
    v_add_u32 v147, s8, v147
    v_add_u32 v148, s8, v148
    s_add_u32 s61, s61, 1
    s_cmp_eq_u32 s61, 10
    s_cselect_b32 s7, 4294948864, s82
    v_add_u32 v149, s7, v149
.p2align 6
k1_kernel_loop110:
    s_waitcnt lgkmcnt(0)
    s_barrier
    ds_read_b64 v[20:21], v144
    ds_read_b64 v[22:23], v145
    v_mfma_f32_16x16x32_bf16 v[76:79], v[28:31], v[12:15], v[76:79]
    ds_read_b64 v[24:25], v146
    v_mfma_f32_16x16x32_bf16 v[96:99], v[28:31], v[16:19], v[96:99]
    ds_read_b64 v[26:27], v147
    ds_read_b64_tr_b16 v[48:49], v148 offset:0
    v_mfma_f32_16x16x32_bf16 v[80:83], v[32:35], v[12:15], v[80:83]
    ds_read_b64_tr_b16 v[50:51], v148 offset:2560
    v_mfma_f32_16x16x32_bf16 v[100:103], v[32:35], v[16:19], v[100:103]
    ds_read_b64_tr_b16 v[52:53], v148 offset:32
    ds_read_b64_tr_b16 v[54:55], v148 offset:2592
    v_mfma_f32_16x16x32_bf16 v[84:87], v[36:39], v[12:15], v[84:87]
    ds_read_b64_tr_b16 v[56:57], v148 offset:64
    v_mfma_f32_16x16x32_bf16 v[104:107], v[36:39], v[16:19], v[104:107]
    ds_read_b64_tr_b16 v[58:59], v148 offset:2624
    ds_read_b64_tr_b16 v[60:61], v148 offset:96
    v_mfma_f32_16x16x32_bf16 v[88:91], v[40:43], v[12:15], v[88:91]
    ds_read_b64_tr_b16 v[62:63], v148 offset:2656
    v_mfma_f32_16x16x32_bf16 v[108:111], v[40:43], v[16:19], v[108:111]
    ds_read_b64_tr_b16 v[64:65], v148 offset:128
    ds_read_b64_tr_b16 v[66:67], v148 offset:2688
    v_mfma_f32_16x16x32_bf16 v[92:95], v[44:47], v[12:15], v[92:95]
    s_add_u32 s40, s40, 1
    s_and_b32 s8, s40, 3
    v_mfma_f32_16x16x32_bf16 v[112:115], v[44:47], v[16:19], v[112:115]
    s_cmp_eq_u32 s8, 0
    v_mfma_f32_16x16x32_bf16 v[116:119], v[152:155], v[12:15], v[116:119]
    s_cselect_b32 s8, 4294881280, s42
    v_add_u32 v144, s8, v144
    v_mfma_f32_16x16x32_bf16 v[124:127], v[12:15], v[12:15], v[124:127]
    v_add_u32 v145, s8, v145
    v_mfma_f32_16x16x32_bf16 v[120:123], v[152:155], v[16:19], v[120:123]
    v_add_u32 v146, s8, v146
    v_add_u32 v147, s8, v147
    v_mfma_f32_16x16x32_bf16 v[128:131], v[16:19], v[16:19], v[128:131]
    v_add_u32 v148, s8, v148
    v_mfma_f32_16x16x32_bf16 v[132:135], v[40:43], v[152:155], v[132:135]
    s_add_u32 s61, s61, 1
    s_cmp_eq_u32 s61, 10
    v_mfma_f32_16x16x32_bf16 v[136:139], v[44:47], v[152:155], v[136:139]
    s_cselect_b32 s7, 4294948864, s82
    v_add_u32 v149, s7, v149
    s_cmp_lg_u32 s40, 4
    s_cbranch_scc1 k1_kernel_cp112
    s_getpc_b64 s[48:49]
k1_kernel_here113:
    s_add_u32 s48, s48, k2_kernel-k1_kernel_here113
    s_addc_u32 s49, s49, 0
    v_lshlrev_b32 v9, 7, v0
    v_cmp_gt_u32 vcc, K2_CODE_BYTES, v9
    s_and_saveexec_b64 s[36:37], vcc
    s_cbranch_execz k1_kernel_cz114
    global_load_dword v11, v9, s[48:49]
k1_kernel_cz114:
    s_mov_b64 exec, s[36:37]
k1_kernel_cp112:
    s_waitcnt lgkmcnt(0)
    s_cmp_eq_u32 s40, 10
    s_cbranch_scc1 k1_kernel_last111
    s_barrier
    ds_read_b64 v[12:13], v144
    ds_read_b64 v[14:15], v145
    v_mfma_f32_16x16x32_bf16 v[76:79], v[48:51], v[20:23], v[76:79]
    ds_read_b64 v[16:17], v146
    v_mfma_f32_16x16x32_bf16 v[96:99], v[48:51], v[24:27], v[96:99]
    ds_read_b64 v[18:19], v147
    ds_read_b64_tr_b16 v[28:29], v148 offset:0
    v_mfma_f32_16x16x32_bf16 v[80:83], v[52:55], v[20:23], v[80:83]
    ds_read_b64_tr_b16 v[30:31], v148 offset:2560
    v_mfma_f32_16x16x32_bf16 v[100:103], v[52:55], v[24:27], v[100:103]
    ds_read_b64_tr_b16 v[32:33], v148 offset:32
    ds_read_b64_tr_b16 v[34:35], v148 offset:2592
    v_mfma_f32_16x16x32_bf16 v[84:87], v[56:59], v[20:23], v[84:87]
    ds_read_b64_tr_b16 v[36:37], v148 offset:64
    v_mfma_f32_16x16x32_bf16 v[104:107], v[56:59], v[24:27], v[104:107]
    ds_read_b64_tr_b16 v[38:39], v148 offset:2624
    ds_read_b64_tr_b16 v[40:41], v148 offset:96
    v_mfma_f32_16x16x32_bf16 v[88:91], v[60:63], v[20:23], v[88:91]
    ds_read_b64_tr_b16 v[42:43], v148 offset:2656
    v_mfma_f32_16x16x32_bf16 v[108:111], v[60:63], v[24:27], v[108:111]
    ds_read_b64_tr_b16 v[44:45], v148 offset:128
    ds_read_b64_tr_b16 v[46:47], v148 offset:2688
    v_mfma_f32_16x16x32_bf16 v[92:95], v[64:67], v[20:23], v[92:95]
    s_add_u32 s40, s40, 1
    s_and_b32 s8, s40, 3
    v_mfma_f32_16x16x32_bf16 v[112:115], v[64:67], v[24:27], v[112:115]
    s_cmp_eq_u32 s8, 0
    v_mfma_f32_16x16x32_bf16 v[116:119], v[152:155], v[20:23], v[116:119]
    s_cselect_b32 s8, 4294881280, s42
    v_add_u32 v144, s8, v144
    v_mfma_f32_16x16x32_bf16 v[124:127], v[20:23], v[20:23], v[124:127]
    v_add_u32 v145, s8, v145
    v_mfma_f32_16x16x32_bf16 v[120:123], v[152:155], v[24:27], v[120:123]
    v_add_u32 v146, s8, v146
    v_add_u32 v147, s8, v147
    v_mfma_f32_16x16x32_bf16 v[128:131], v[24:27], v[24:27], v[128:131]
    v_add_u32 v148, s8, v148
    v_mfma_f32_16x16x32_bf16 v[132:135], v[60:63], v[152:155], v[132:135]
    s_add_u32 s61, s61, 1
    s_cmp_eq_u32 s61, 10
    v_mfma_f32_16x16x32_bf16 v[136:139], v[64:67], v[152:155], v[136:139]
    s_cselect_b32 s7, 4294948864, s82
    v_add_u32 v149, s7, v149
    s_branch k1_kernel_loop110
k1_kernel_last111:
    v_mfma_f32_16x16x32_bf16 v[76:79], v[48:51], v[20:23], v[76:79]
    v_mfma_f32_16x16x32_bf16 v[96:99], v[48:51], v[24:27], v[96:99]
    v_mfma_f32_16x16x32_bf16 v[80:83], v[52:55], v[20:23], v[80:83]
    v_mfma_f32_16x16x32_bf16 v[100:103], v[52:55], v[24:27], v[100:103]
    v_mfma_f32_16x16x32_bf16 v[84:87], v[56:59], v[20:23], v[84:87]
    v_mfma_f32_16x16x32_bf16 v[104:107], v[56:59], v[24:27], v[104:107]
    v_mfma_f32_16x16x32_bf16 v[88:91], v[60:63], v[20:23], v[88:91]
    v_mfma_f32_16x16x32_bf16 v[108:111], v[60:63], v[24:27], v[108:111]
    v_mfma_f32_16x16x32_bf16 v[92:95], v[64:67], v[20:23], v[92:95]
    v_mfma_f32_16x16x32_bf16 v[112:115], v[64:67], v[24:27], v[112:115]
    v_mfma_f32_16x16x32_bf16 v[116:119], v[152:155], v[20:23], v[116:119]
    v_mfma_f32_16x16x32_bf16 v[124:127], v[20:23], v[20:23], v[124:127]
    v_mfma_f32_16x16x32_bf16 v[120:123], v[152:155], v[24:27], v[120:123]
    v_mfma_f32_16x16x32_bf16 v[128:131], v[24:27], v[24:27], v[128:131]
    v_mfma_f32_16x16x32_bf16 v[132:135], v[60:63], v[152:155], v[132:135]
    v_mfma_f32_16x16x32_bf16 v[136:139], v[64:67], v[152:155], v[136:139]
    s_nop 7
    s_xor_b32 s6, s3, 1
    s_mul_i32 s6, s6, 7168
    s_add_u32 s6, s6, 57344
    v_lshlrev_b32 v9, 4, v1
    v_add_u32 v8, s6, v9
    s_cmp_eq_u32 s45, 1
    s_cbranch_scc1 k1_kernel_x1115
    ds_write_b128 v8, v[96:99] offset:0
    ds_write_b128 v8, v[100:103] offset:1024
    ds_write_b128 v8, v[104:107] offset:2048
    ds_write_b128 v8, v[108:111] offset:3072
    ds_write_b128 v8, v[112:115] offset:4096
    ds_write_b128 v8, v[120:123] offset:5120
    ds_write_b128 v8, v[128:131] offset:6144
    s_branch k1_kernel_x2116
k1_kernel_x1115:
    ds_write_b128 v8, v[76:79] offset:0
    ds_write_b128 v8, v[80:83] offset:1024
    ds_write_b128 v8, v[84:87] offset:2048
    ds_write_b128 v8, v[88:91] offset:3072
    ds_write_b128 v8, v[92:95] offset:4096
    ds_write_b128 v8, v[116:119] offset:5120
    ds_write_b128 v8, v[124:127] offset:6144
    s_waitcnt lgkmcnt(0)
    v_mov_b32 v76, v96
    v_mov_b32 v77, v97
    v_mov_b32 v78, v98
    v_mov_b32 v79, v99
    v_mov_b32 v80, v100
    v_mov_b32 v81, v101
    v_mov_b32 v82, v102
    v_mov_b32 v83, v103
    v_mov_b32 v84, v104
    v_mov_b32 v85, v105
    v_mov_b32 v86, v106
    v_mov_b32 v87, v107
    v_mov_b32 v88, v108
    v_mov_b32 v89, v109
    v_mov_b32 v90, v110
    v_mov_b32 v91, v111
    v_mov_b32 v92, v112
    v_mov_b32 v93, v113
    v_mov_b32 v94, v114
    v_mov_b32 v95, v115
    v_mov_b32 v116, v120
    v_mov_b32 v117, v121
    v_mov_b32 v118, v122
    v_mov_b32 v119, v123
    v_mov_b32 v124, v128
    v_mov_b32 v125, v129
    v_mov_b32 v126, v130
    v_mov_b32 v127, v131
k1_kernel_x2116:
    v_lshlrev_b32 v4, 4, v3
    s_mul_i32 s6, s43, 640
    s_mul_i32 s7, s45, 320
    s_add_u32 s6, s6, s7
    s_add_u32 s6, s6, 114688
    v_add_u32 v4, s6, v4
    s_mov_b32 s48, 0x00010001
    s_mov_b32 s49, 0x00010001
    s_mov_b64 exec, s[48:49]
    ds_write_b128 v4, v[132:135] offset:192
    ds_write_b128 v4, v[136:139] offset:256
    s_mov_b64 exec, -1
    s_waitcnt lgkmcnt(0)
    s_barrier
    s_mul_i32 s6, s3, 7168
    s_add_u32 s6, s6, 57344
    v_add_u32 v8, s6, v9
    ds_read_b128 v[96:99], v8 offset:0
    ds_read_b128 v[100:103], v8 offset:1024
    ds_read_b128 v[104:107], v8 offset:2048
    ds_read_b128 v[108:111], v8 offset:3072
    ds_read_b128 v[112:115], v8 offset:4096
    ds_read_b128 v[120:123], v8 offset:5120
    ds_read_b128 v[128:131], v8 offset:6144
    s_waitcnt lgkmcnt(0)
    v_pk_add_f32 v[76:77], v[76:77], v[96:97]
    v_pk_add_f32 v[78:79], v[78:79], v[98:99]
    v_pk_add_f32 v[80:81], v[80:81], v[100:101]
    v_pk_add_f32 v[82:83], v[82:83], v[102:103]
    v_pk_add_f32 v[84:85], v[84:85], v[104:105]
    v_pk_add_f32 v[86:87], v[86:87], v[106:107]
    v_pk_add_f32 v[88:89], v[88:89], v[108:109]
    v_pk_add_f32 v[90:91], v[90:91], v[110:111]
    v_pk_add_f32 v[92:93], v[92:93], v[112:113]
    v_pk_add_f32 v[94:95], v[94:95], v[114:115]
    v_pk_add_f32 v[116:117], v[116:117], v[120:121]
    v_pk_add_f32 v[118:119], v[118:119], v[122:123]
    v_pk_add_f32 v[124:125], v[124:125], v[128:129]
    v_pk_add_f32 v[126:127], v[126:127], v[130:131]
k1_kernel_HE102:
    v_lshlrev_b32 v4, 4, v3
    s_mul_i32 s6, s43, 640
    s_add_u32 s6, s6, 114688
    v_add_u32 v4, s6, v4
    ds_read_b128 v[48:51], v4 offset:0
    ds_read_b128 v[96:99], v4 offset:320
    ds_read_b128 v[52:55], v4 offset:64
    ds_read_b128 v[100:103], v4 offset:384
    ds_read_b128 v[56:59], v4 offset:128
    ds_read_b128 v[104:107], v4 offset:448
    ds_read_b128 v[60:63], v4 offset:192
    ds_read_b128 v[108:111], v4 offset:512
    ds_read_b128 v[64:67], v4 offset:256
    ds_read_b128 v[112:115], v4 offset:576
    v_and_b32 v5, 3, v2
    v_lshrrev_b32 v6, 2, v2
    v_cmp_eq_u32 vcc, 1, v5
    v_cmp_eq_u32 s[48:49], 2, v5
    v_mov_b32 v70, 0xc0135761
    v_cndmask_b32 v7, v124, v125, vcc
    v_cmp_eq_u32 vcc, 3, v5
    v_cndmask_b32 v7, v7, v126, s[48:49]
    v_cmp_eq_u32 s[48:49], v6, v3
    v_mov_b32 v71, 0xbdd2d3e8
    v_cndmask_b32 v7, v7, v127, vcc
    v_mov_b32 v8, 0
    v_cndmask_b32 v7, v8, v7, s[48:49]
    v_mov_b32 v5, v7
    v_mov_b32 v6, v7
    s_nop 1
    v_permlane32_swap_b32 v5, v6
    s_nop 1
    v_add_f32 v7, v5, v6
    v_mov_b32 v5, v7
    v_mov_b32 v6, v7
    s_nop 1
    v_permlane16_swap_b32 v5, v6
    s_nop 1
    v_add_f32 v7, v5, v6
    v_mul_f32 v68, 0x3acccccd, v116
    v_mul_f32 v5, 0x3acccccd, v7
    v_fma_f32 v5, -v68, v68, v5
    v_max_f32 v5, 0, v5
    v_add_f32 v5, 0x3727c5ac, v5
    v_rsq_f32 v69, v5
    s_waitcnt lgkmcnt(0)
    v_pk_add_f32 v[48:49], v[48:49], v[96:97]
    v_pk_add_f32 v[50:51], v[50:51], v[98:99]
    v_pk_add_f32 v[52:53], v[52:53], v[100:101]
    v_pk_add_f32 v[54:55], v[54:55], v[102:103]
    v_pk_add_f32 v[56:57], v[56:57], v[104:105]
    v_pk_add_f32 v[58:59], v[58:59], v[106:107]
    v_pk_add_f32 v[60:61], v[60:61], v[108:109]
    v_pk_add_f32 v[62:63], v[62:63], v[110:111]
    v_pk_add_f32 v[64:65], v[64:65], v[112:113]
    v_pk_add_f32 v[66:67], v[66:67], v[114:115]
    v_mul_f32 v68, v68, v69
    v_sub_f32 v68, 0, v68
    v_pk_mul_f32 v[28:29], v[48:49], v[68:69] op_sel_hi:[1,0]
    v_pk_mul_f32 v[30:31], v[50:51], v[68:69] op_sel_hi:[1,0]
    v_pk_mul_f32 v[32:33], v[52:53], v[68:69] op_sel_hi:[1,0]
    v_pk_mul_f32 v[34:35], v[54:55], v[68:69] op_sel_hi:[1,0]
    v_pk_mul_f32 v[36:37], v[56:57], v[68:69] op_sel_hi:[1,0]
    v_pk_mul_f32 v[38:39], v[58:59], v[68:69] op_sel_hi:[1,0]
    v_pk_mul_f32 v[40:41], v[60:61], v[68:69] op_sel_hi:[1,0]
    v_pk_mul_f32 v[42:43], v[62:63], v[68:69] op_sel_hi:[1,0]
    v_pk_mul_f32 v[44:45], v[64:65], v[68:69] op_sel_hi:[1,0]
    v_pk_mul_f32 v[46:47], v[66:67], v[68:69] op_sel_hi:[1,0]
    v_pk_fma_f32 v[76:77], v[76:77], v[68:69], v[28:29] op_sel:[0,1,0] op_sel_hi:[1,1,1]
    v_pk_fma_f32 v[78:79], v[78:79], v[68:69], v[30:31] op_sel:[0,1,0] op_sel_hi:[1,1,1]
    v_pk_fma_f32 v[80:81], v[80:81], v[68:69], v[32:33] op_sel:[0,1,0] op_sel_hi:[1,1,1]
    v_pk_fma_f32 v[82:83], v[82:83], v[68:69], v[34:35] op_sel:[0,1,0] op_sel_hi:[1,1,1]
    v_pk_fma_f32 v[84:85], v[84:85], v[68:69], v[36:37] op_sel:[0,1,0] op_sel_hi:[1,1,1]
    v_pk_fma_f32 v[86:87], v[86:87], v[68:69], v[38:39] op_sel:[0,1,0] op_sel_hi:[1,1,1]
    v_pk_fma_f32 v[88:89], v[88:89], v[68:69], v[40:41] op_sel:[0,1,0] op_sel_hi:[1,1,1]
    v_pk_fma_f32 v[90:91], v[90:91], v[68:69], v[42:43] op_sel:[0,1,0] op_sel_hi:[1,1,1]
    v_pk_fma_f32 v[92:93], v[92:93], v[68:69], v[44:45] op_sel:[0,1,0] op_sel_hi:[1,1,1]
    v_pk_fma_f32 v[94:95], v[94:95], v[68:69], v[46:47] op_sel:[0,1,0] op_sel_hi:[1,1,1]
    v_pk_mul_f32 v[28:29], v[76:77], v[76:77]
    v_pk_mul_f32 v[30:31], v[78:79], v[78:79]
    v_pk_mul_f32 v[32:33], v[80:81], v[80:81]
    v_pk_mul_f32 v[34:35], v[82:83], v[82:83]
    v_pk_mul_f32 v[36:37], v[84:85], v[84:85]
    v_pk_mul_f32 v[38:39], v[86:87], v[86:87]
    v_pk_mul_f32 v[40:41], v[88:89], v[88:89]
    v_pk_mul_f32 v[42:43], v[90:91], v[90:91]
    v_pk_mul_f32 v[44:45], v[92:93], v[92:93]
    v_pk_mul_f32 v[46:47], v[94:95], v[94:95]
    v_pk_fma_f32 v[28:29], v[28:29], v[70:71], v[70:71] op_sel:[0,1,0] op_sel_hi:[1,1,0]
    v_pk_fma_f32 v[30:31], v[30:31], v[70:71], v[70:71] op_sel:[0,1,0] op_sel_hi:[1,1,0]
    v_pk_fma_f32 v[32:33], v[32:33], v[70:71], v[70:71] op_sel:[0,1,0] op_sel_hi:[1,1,0]
    v_pk_fma_f32 v[34:35], v[34:35], v[70:71], v[70:71] op_sel:[0,1,0] op_sel_hi:[1,1,0]
    v_pk_fma_f32 v[36:37], v[36:37], v[70:71], v[70:71] op_sel:[0,1,0] op_sel_hi:[1,1,0]
    v_pk_fma_f32 v[38:39], v[38:39], v[70:71], v[70:71] op_sel:[0,1,0] op_sel_hi:[1,1,0]
    v_pk_fma_f32 v[40:41], v[40:41], v[70:71], v[70:71] op_sel:[0,1,0] op_sel_hi:[1,1,0]
    v_pk_fma_f32 v[42:43], v[42:43], v[70:71], v[70:71] op_sel:[0,1,0] op_sel_hi:[1,1,0]
    v_pk_fma_f32 v[44:45], v[44:45], v[70:71], v[70:71] op_sel:[0,1,0] op_sel_hi:[1,1,0]
    v_pk_fma_f32 v[46:47], v[46:47], v[70:71], v[70:71] op_sel:[0,1,0] op_sel_hi:[1,1,0]
    v_pk_mul_f32 v[28:29], v[28:29], v[76:77]
    v_pk_mul_f32 v[30:31], v[30:31], v[78:79]
    v_pk_mul_f32 v[32:33], v[32:33], v[80:81]
    v_pk_mul_f32 v[34:35], v[34:35], v[82:83]
    v_pk_mul_f32 v[36:37], v[36:37], v[84:85]
    v_pk_mul_f32 v[38:39], v[38:39], v[86:87]
    v_pk_mul_f32 v[40:41], v[40:41], v[88:89]
    v_pk_mul_f32 v[42:43], v[42:43], v[90:91]
    v_pk_mul_f32 v[44:45], v[44:45], v[92:93]
    v_pk_mul_f32 v[46:47], v[46:47], v[94:95]
    v_exp_f32 v28, v28
    v_exp_f32 v29, v29
    v_exp_f32 v30, v30
    v_exp_f32 v31, v31
    v_exp_f32 v32, v32
    v_exp_f32 v33, v33
    v_exp_f32 v34, v34
    v_exp_f32 v35, v35
    v_exp_f32 v36, v36
    v_exp_f32 v37, v37
    v_exp_f32 v38, v38
    v_exp_f32 v39, v39
    v_exp_f32 v40, v40
    v_exp_f32 v41, v41
    v_exp_f32 v42, v42
    v_exp_f32 v43, v43
    v_exp_f32 v44, v44
    v_exp_f32 v45, v45
    v_exp_f32 v46, v46
    v_exp_f32 v47, v47
    v_pk_add_f32 v[28:29], v[28:29], 1.0 op_sel_hi:[1,0]
    v_pk_add_f32 v[30:31], v[30:31], 1.0 op_sel_hi:[1,0]
    v_pk_add_f32 v[32:33], v[32:33], 1.0 op_sel_hi:[1,0]
    v_pk_add_f32 v[34:35], v[34:35], 1.0 op_sel_hi:[1,0]
    v_pk_add_f32 v[36:37], v[36:37], 1.0 op_sel_hi:[1,0]
    v_pk_add_f32 v[38:39], v[38:39], 1.0 op_sel_hi:[1,0]
    v_pk_add_f32 v[40:41], v[40:41], 1.0 op_sel_hi:[1,0]
    v_pk_add_f32 v[42:43], v[42:43], 1.0 op_sel_hi:[1,0]
    v_pk_add_f32 v[44:45], v[44:45], 1.0 op_sel_hi:[1,0]
    v_pk_add_f32 v[46:47], v[46:47], 1.0 op_sel_hi:[1,0]
    v_rcp_f32 v28, v28
    v_rcp_f32 v29, v29
    v_rcp_f32 v30, v30
    v_rcp_f32 v31, v31
    v_rcp_f32 v32, v32
    v_rcp_f32 v33, v33
    v_rcp_f32 v34, v34
    v_rcp_f32 v35, v35
    v_rcp_f32 v36, v36
    v_rcp_f32 v37, v37
    v_rcp_f32 v38, v38
    v_rcp_f32 v39, v39
    v_rcp_f32 v40, v40
    v_rcp_f32 v41, v41
    v_rcp_f32 v42, v42
    v_rcp_f32 v43, v43
    v_rcp_f32 v44, v44
    v_rcp_f32 v45, v45
    v_rcp_f32 v46, v46
    v_rcp_f32 v47, v47
    v_pk_mul_f32 v[76:77], v[76:77], v[28:29]
    v_pk_mul_f32 v[78:79], v[78:79], v[30:31]
    v_pk_mul_f32 v[80:81], v[80:81], v[32:33]
    v_pk_mul_f32 v[82:83], v[82:83], v[34:35]
    v_pk_mul_f32 v[84:85], v[84:85], v[36:37]
    v_pk_mul_f32 v[86:87], v[86:87], v[38:39]
    v_pk_mul_f32 v[88:89], v[88:89], v[40:41]
    v_pk_mul_f32 v[90:91], v[90:91], v[42:43]
    v_pk_mul_f32 v[92:93], v[92:93], v[44:45]
    v_pk_mul_f32 v[94:95], v[94:95], v[46:47]
    v_cvt_pk_bf16_f32 v12, v76, v77
    v_cvt_pk_bf16_f32 v13, v78, v79
    v_cvt_pk_bf16_f32 v14, v80, v81
    v_cvt_pk_bf16_f32 v15, v82, v83
    v_cvt_pk_bf16_f32 v16, v84, v85
    v_cvt_pk_bf16_f32 v17, v86, v87
    v_cvt_pk_bf16_f32 v18, v88, v89
    v_cvt_pk_bf16_f32 v19, v90, v91
    v_cvt_pk_bf16_f32 v20, v92, v93
    v_cvt_pk_bf16_f32 v21, v94, v95
    s_lshl_b32 s6, s4, 2
    s_add_u32 s6, s6, s44
    s_mul_i32 s6, s6, 20480
    s_add_u32 s6, s6, 2810880
    s_mul_i32 s7, s60, 2560
    s_add_u32 s6, s6, s7
    v_lshrrev_b32 v4, 1, v3
    v_and_b32 v5, 1, v3
    v_lshlrev_b32 v4, 8, v4
    v_lshl_add_u32 v4, v2, 4, v4
    v_permlane16_swap_b32 v12, v14
    v_permlane16_swap_b32 v13, v15
    v_permlane16_swap_b32 v16, v18
    v_permlane16_swap_b32 v17, v19
    v_lshl_add_u32 v6, v5, 9, v4
    v_lshl_add_u32 v7, v5, 3, v4
    buffer_store_dwordx4 v[12:15], v6, s[32:35], s6 offen offset:0 sc1
    buffer_store_dwordx4 v[16:19], v6, s[32:35], s6 offen offset:1024 sc1
    buffer_store_dwordx2 v[20:21], v7, s[32:35], s6 offen offset:2048 sc1
    s_branch k1_kernel_end
k1_kernel_qepi79:
    v_mov_b32 v72, 0x3ea52b5c
    s_and_b32 s6, s44, 1
    s_lshl_b32 s6, s6, 4
    v_add_u32 v73, s6, v2
    s_lshr_b32 s6, s44, 1
    s_lshl_b32 s7, s4, 1
    s_add_u32 s83, s6, s7
    s_lshl_b32 s7, s60, 8
    s_add_u32 s6, s83, s7
    s_mul_i32 s6, s6, 1280
    s_add_u32 s6, s6, 0
    v_lshlrev_b32 v4, 8, v3
    v_lshl_add_u32 v4, v73, 3, v4
    s_mov_b32 s7, 80640
    v_add_u32 v5, 0, v3
    v_add_u32 v6, 4, v3
    v_add_u32 v7, 8, v3
    v_add_u32 v8, 12, v3
    v_add_u32 v9, 16, v3
    v_mul_u32_u24 v5, 52, v5
    v_mul_u32_u24 v6, 52, v6
    v_mul_u32_u24 v7, 52, v7
    v_mul_u32_u24 v8, 52, v8
    v_mul_u32_u24 v9, 52, v9
    v_lshrrev_b32 v5, 8, v5
    v_lshrrev_b32 v6, 8, v6
    v_lshrrev_b32 v7, 8, v7
    v_lshrrev_b32 v8, 8, v8
    v_lshrrev_b32 v9, 8, v9
    v_mad_u32_u24 v5, v5, s7, v4
    v_mad_u32_u24 v6, v6, s7, v4
    v_mad_u32_u24 v7, v7, s7, v4
    v_mad_u32_u24 v8, v8, s7, v4
    v_mad_u32_u24 v9, v9, s7, v4
    v_mul_f32 v76, v72, v76
    v_mul_f32 v77, v72, v77
    v_mul_f32 v78, v72, v78
    v_mul_f32 v79, v72, v79
    v_mul_f32 v80, v72, v80
    v_mul_f32 v81, v72, v81
    v_mul_f32 v82, v72, v82
    v_mul_f32 v83, v72, v83
    v_mul_f32 v84, v72, v84
    v_mul_f32 v85, v72, v85
    v_mul_f32 v86, v72, v86
    v_mul_f32 v87, v72, v87
    v_mul_f32 v88, v72, v88
    v_mul_f32 v89, v72, v89
    v_mul_f32 v90, v72, v90
    v_mul_f32 v91, v72, v91
    v_mul_f32 v92, v72, v92
    v_mul_f32 v93, v72, v93
    v_mul_f32 v94, v72, v94
    v_mul_f32 v95, v72, v95
    v_cvt_pk_bf16_f32 v12, v76, v77
    v_cvt_pk_bf16_f32 v13, v78, v79
    v_cvt_pk_bf16_f32 v14, v80, v81
    v_cvt_pk_bf16_f32 v15, v82, v83
    v_cvt_pk_bf16_f32 v16, v84, v85
    v_cvt_pk_bf16_f32 v17, v86, v87
    v_cvt_pk_bf16_f32 v18, v88, v89
    v_cvt_pk_bf16_f32 v19, v90, v91
    v_cvt_pk_bf16_f32 v20, v92, v93
    v_cvt_pk_bf16_f32 v21, v94, v95
    buffer_store_dwordx2 v[12:13], v5, s[32:35], s6 offen offset:0 sc1
    buffer_store_dwordx2 v[14:15], v6, s[32:35], s6 offen offset:1024 sc1
    buffer_store_dwordx2 v[16:17], v7, s[32:35], s6 offen offset:2048 sc1
    buffer_store_dwordx2 v[18:19], v8, s[32:35], s6 offen offset:3072 sc1
    s_add_u32 s6, s6, 4096
    buffer_store_dwordx2 v[20:21], v9, s[32:35], s6 offen sc1
    s_cmp_eq_u32 s43, 1
    s_cbranch_scc1 k1_kernel_end
    s_lshr_b32 s84, s83, 3
    s_mul_i32 s84, s84, 22528
    s_add_u32 s84, s84, 2621440
    s_and_b32 s85, s83, 7
    v_cvt_pk_bf16_f32 v22, v116, v117
    v_cvt_pk_bf16_f32 v23, v118, v119
    s_cmp_eq_u32 s5, 1
    s_cbranch_scc1 k1_kernel_c1117
    s_cmp_eq_u32 s5, 2
    s_cbranch_scc1 k1_kernel_c2118
    s_cmp_eq_u32 s5, 3
    s_cbranch_scc1 k1_kernel_c3119
    v_lshrrev_b32 v7, 1, v3
    v_lshlrev_b32 v7, 9, v7
    v_and_b32 v9, 1, v3
    v_lshl_add_u32 v7, v73, 4, v7
    v_lshl_add_u32 v7, v9, 3, v7
    s_lshl_b32 s7, s85, 10
    s_add_u32 s7, s7, s84
    buffer_store_dwordx2 v[22:23], v7, s[32:35], s7 offen sc1
    v_mov_b32 v4, 0
    s_nop 1
    v_dot2c_f32_bf16 v4, v22, v22
    v_dot2c_f32_bf16 v4, v23, v23
    s_nop 3
    v_mov_b32 v5, v4
    v_mov_b32 v6, v4
    s_nop 1
    v_permlane32_swap_b32 v5, v6
    s_nop 1
    v_add_f32 v4, v5, v6
    v_mov_b32 v5, v4
    v_mov_b32 v6, v4
    s_nop 1
    v_permlane16_swap_b32 v5, v6
    s_nop 1
    v_add_f32 v4, v5, v6
    s_nop 1
    v_max_f32_dpp v4, v4, v4 row_ror:8 row_mask:0xf bank_mask:0xf
    s_nop 1
    v_max_f32_dpp v4, v4, v4 row_ror:4 row_mask:0xf bank_mask:0xf
    s_nop 1
    v_max_f32_dpp v4, v4, v4 row_ror:2 row_mask:0xf bank_mask:0xf
    s_nop 1
    v_max_f32_dpp v4, v4, v4 row_ror:1 row_mask:0xf bank_mask:0xf
    s_nop 1
    s_lshl_b32 s6, s4, 2
    s_add_u32 s6, s6, s44
    s_lshl_b32 s6, s6, 2
    s_add_u32 s6, s6, 2801664
    v_mov_b32 v5, 0
    s_mov_b64 exec, 1
    buffer_store_dword v4, v5, s[32:35], s6 offen sc1
    s_mov_b64 exec, -1
    s_branch k1_kernel_end
k1_kernel_c1117:
    v_lshlrev_b32 v7, 3, v73
    s_lshl_b32 s7, s85, 8
    s_add_u32 s7, s7, s84
    s_add_u32 s7, s7, 8192
    s_mov_b64 exec, 0xffff
    buffer_store_dwordx2 v[22:23], v7, s[32:35], s7 offen sc1
    s_mov_b64 exec, -1
    v_cvt_pk_bf16_f32 v8, v116, v116
    v_lshlrev_b32 v8, 16, v8
    v_mul_f32 v8, 0xbfb8aa3b, v8
    v_exp_f32 v8, v8
    s_nop 0
    v_add_f32 v8, 1.0, v8
    v_rcp_f32 v8, v8
    s_nop 0
    v_cvt_pk_bf16_f32 v8, v8, v8
    v_lshlrev_b32 v8, 16, v8
    s_lshl_b32 s6, s4, 2
    s_add_u32 s6, s6, s44
    s_lshl_b32 s6, s6, 6
    s_add_u32 s6, s6, 2802688
    v_lshlrev_b32 v9, 2, v2
    s_mov_b64 exec, 0xffff0000
    buffer_store_dword v8, v9, s[32:35], s6 offen sc1
    s_mov_b64 exec, -1
    v_mov_b32 v4, 0
    s_nop 1
    v_dot2c_f32_bf16 v4, v22, v22
    v_dot2c_f32_bf16 v4, v23, v23
    s_nop 3
    s_nop 1
    v_max_f32_dpp v4, v4, v4 row_ror:8 row_mask:0xf bank_mask:0xf
    s_nop 1
    v_max_f32_dpp v4, v4, v4 row_ror:4 row_mask:0xf bank_mask:0xf
    s_nop 1
    v_max_f32_dpp v4, v4, v4 row_ror:2 row_mask:0xf bank_mask:0xf
    s_nop 1
    v_max_f32_dpp v4, v4, v4 row_ror:1 row_mask:0xf bank_mask:0xf
    s_nop 1
    s_lshl_b32 s6, s4, 2
    s_add_u32 s6, s6, s44
    s_lshl_b32 s6, s6, 2
    s_add_u32 s6, s6, 2802176
    v_mov_b32 v5, 0
    s_mov_b64 exec, 1
    buffer_store_dword v4, v5, s[32:35], s6 offen sc1
    s_mov_b64 exec, -1
    s_branch k1_kernel_end
k1_kernel_c2118:
    v_and_b32 v7, 1, v3
    v_mul_u32_u24 v7, 384, v7
    v_add_u32 v8, 0, v2
    v_lshrrev_b32 v9, 1, v3
    v_lshl_add_u32 v7, v8, 4, v7
    v_lshl_add_u32 v7, v9, 3, v7
    s_mul_i32 s7, s85, 1536
    s_add_u32 s7, s7, s84
    s_add_u32 s7, s7, 10240
    s_and_b32 s6, s44, 1
    s_mul_i32 s6, s6, 768
    s_add_u32 s7, s7, s6
    buffer_store_dwordx2 v[22:23], v7, s[32:35], s7 offen sc1
    s_branch k1_kernel_end
k1_kernel_c3119:
    v_and_b32 v7, 1, v3
    v_mul_u32_u24 v7, 384, v7
    v_add_u32 v8, 16, v2
    v_lshrrev_b32 v9, 1, v3
    v_lshl_add_u32 v7, v8, 4, v7
    v_lshl_add_u32 v7, v9, 3, v7
    s_mul_i32 s7, s85, 1536
    s_add_u32 s7, s7, s84
    s_add_u32 s7, s7, 10240
    s_and_b32 s6, s44, 1
    s_mul_i32 s6, s6, 768
    s_add_u32 s7, s7, s6
    v_mov_b32 v10, 0x3f803f80
    v_cmp_eq_u32 vcc, 4, v2
    s_nop 1
    v_cndmask_b32 v22, v22, v10, vcc
    v_cndmask_b32 v23, v23, v10, vcc
    s_mov_b32 s48, 0x00ff00ff
    s_mov_b32 s49, 0x00ff00ff
    s_mov_b64 exec, s[48:49]
    buffer_store_dwordx2 v[22:23], v7, s[32:35], s7 offen sc1
k1_kernel_end:
k1_kernel_end2:
    s_endpgm

.section .rodata,"a"
.p2align 6
.amdhsa_kernel k1_kernel
  .amdhsa_next_free_vgpr 156
  .amdhsa_next_free_sgpr 86
  .amdhsa_accum_offset 156
  .amdhsa_group_segment_fixed_size 0
  .amdhsa_kernarg_size 112
  .amdhsa_user_sgpr_count 2
  .amdhsa_user_sgpr_kernarg_segment_ptr 1
  .amdhsa_system_sgpr_workgroup_id_x 1
  .amdhsa_float_denorm_mode_32 3
  .amdhsa_float_denorm_mode_16_64 3
.end_amdhsa_kernel
.text

.globl k2_kernel
.p2align 8
.type k2_kernel,@function
k2_kernel:
    s_cmp_ge_u32 s2, 512
    s_cbranch_scc1 k2_kernel_x
    s_cmp_ge_u32 s2, 256
    s_cbranch_scc1 k2_kernel_g
    s_setprio 3
    s_load_dwordx2 s[10:11], s[0:1], 104
    s_load_dwordx2 s[12:13], s[0:1], 96
    v_lshrrev_b32 v2, 6, v0
    v_and_b32 v1, 63, v0
    v_readfirstlane_b32 s3, v2
    s_and_b32 s6, s2, 7
    s_lshl_b32 s4, s6, 2
    s_bfe_u32 s6, s2, 0x20006
    s_add_u32 s4, s4, s6
    s_bfe_u32 s5, s2, 0x30003
    s_mov_b32 s25, 0
    v_and_b32 v22, 31, v1
    v_lshrrev_b32 v23, 5, v1
    v_lshlrev_b32 v21, 4, v1
    s_lshl_b32 s6, s5, 2
    s_lshr_b32 s7, s3, 1
    s_add_u32 s29, s6, s7
    s_lshl_b32 s6, s29, 6
    s_lshl_b32 s7, s4, 1
    s_add_u32 s6, s6, s7
    s_and_b32 s7, s3, 1
    s_add_u32 s6, s6, s7
    s_mul_i32 s6, s6, 1280
    s_add_u32 s8, s6, 0
    v_lshlrev_b32 v2, 9, v23
    v_lshl_add_u32 v2, v22, 3, v2
    v_lshlrev_b32 v3, 3, v22
    v_lshlrev_b32 v4, 31, v23
    v_or_b32 v3, v3, v4
    v_lshlrev_b32 v4, 2, v1
    s_waitcnt lgkmcnt(0)
    s_add_u32 s20, s10, 2621440
    s_addc_u32 s21, s11, 0
    s_mov_b32 s22, 180224
    s_mov_b32 s23, 0x20000
    s_mov_b32 s16, s10
    s_mov_b32 s17, s11
    s_mov_b32 s18, 29815808
    s_mov_b32 s19, 0x20000
    s_mov_b32 s24, 0
    s_mov_b32 s27, 0
    s_mul_i32 s6, s24, 22528
    s_lshl_b32 s7, s3, 10
    s_add_u32 s6, s6, s7
    s_add_u32 s7, s7, s27
    s_add_u32 m0, s7, 0
    s_add_u32 s28, s6, 0
    buffer_load_dwordx4 v21, s[20:23], s28 offen lds
    s_add_u32 m0, s7, 8192
    s_add_u32 s28, s6, 8192
    buffer_load_dwordx4 v21, s[20:23], s28 offen lds
    s_cmp_ge_u32 s3, 6
    s_cbranch_scc1 k2_kernel_sk2
    s_add_u32 m0, s7, 16384
    s_add_u32 s28, s6, 16384
    buffer_load_dwordx4 v21, s[20:23], s28 offen lds
k2_kernel_sk2:
    buffer_load_dwordx2 v[8:9], v2, s[16:19], s8 offen
    buffer_load_dwordx2 v[10:11], v2, s[16:19], s8 offen offset:256
    buffer_load_dwordx2 v[12:13], v3, s[16:19], s8 offen offset:1024
    s_mov_b32 s7, 2801664
    buffer_load_dword v40, v4, s[16:19], s7 offen offset:0
    buffer_load_dword v41, v4, s[16:19], s7 offen offset:256
    buffer_load_dword v42, v4, s[16:19], s7 offen offset:512
    buffer_load_dword v43, v4, s[16:19], s7 offen offset:768
    v_lshlrev_b32 v18, 4, v1
    v_lshlrev_b32 v19, 3, v22
    v_add_u32 v19, 8192, v19
    v_min_u32 v5, 23, v22
    v_mul_u32_u24 v6, 384, v23
    v_lshl_add_u32 v20, v5, 4, v6
    v_add_u32 v20, 10240, v20
    v_lshrrev_b32 v5, 4, v22
    v_mul_u32_u24 v5, 20480, v5
    v_and_b32 v6, 15, v22
    v_lshl_add_u32 v5, v6, 4, v5
    s_mul_i32 s7, s29, 5
    v_add_u32 v6, s7, v23
    v_lshrrev_b32 v7, 1, v6
    v_lshl_add_u32 v120, v7, 8, v5
    v_and_b32 v6, 1, v6
    v_lshl_add_u32 v120, v6, 3, v120
    v_add_u32 v6, s7, v23
    v_add_u32 v6, 2, v6
    v_lshrrev_b32 v7, 1, v6
    v_lshl_add_u32 v121, v7, 8, v5
    v_and_b32 v6, 1, v6
    v_lshl_add_u32 v121, v6, 3, v121
    v_add_u32 v6, s7, v23
    v_add_u32 v6, 4, v6
    v_lshrrev_b32 v7, 1, v6
    v_lshl_add_u32 v122, v7, 8, v5
    v_and_b32 v6, 1, v6
    v_lshl_add_u32 v122, v6, 3, v122
    s_lshl_b32 s30, s4, 1
    s_and_b32 s7, s3, 1
    s_add_u32 s30, s30, s7
    s_mul_i32 s30, s30, 40960
    s_add_u32 s30, s30, 17884160
    s_lshl_b32 s7, s4, 1
    s_and_b32 s6, s3, 1
    s_add_u32 s7, s7, s6
    s_lshl_b32 s7, s7, 7
    s_add_u32 s7, s7, 2802688
    v_lshlrev_b32 v5, 2, v22
    buffer_load_dword v123, v5, s[16:19], s7 offen
    v_mov_b32 v5, 67584
    v_mov_b32 v6, 0
    ds_write_b32 v5, v6
    s_waitcnt vmcnt(0)
    v_max_f32 v40, v40, v41
    v_max_f32 v42, v42, v43
    v_mov_b32 v56, 0
    v_max_f32_dpp v40, v40, v40 row_ror:8 row_mask:0xf bank_mask:0xf
    v_max_f32_dpp v42, v42, v42 row_ror:8 row_mask:0xf bank_mask:0xf
    s_nop 0
    v_max_f32_dpp v40, v40, v40 row_ror:4 row_mask:0xf bank_mask:0xf
    v_max_f32_dpp v42, v42, v42 row_ror:4 row_mask:0xf bank_mask:0xf
    s_nop 0
    v_max_f32_dpp v40, v40, v40 row_ror:2 row_mask:0xf bank_mask:0xf
    v_max_f32_dpp v42, v42, v42 row_ror:2 row_mask:0xf bank_mask:0xf
    s_nop 0
    v_max_f32_dpp v40, v40, v40 row_ror:1 row_mask:0xf bank_mask:0xf
    v_max_f32_dpp v42, v42, v42 row_ror:1 row_mask:0xf bank_mask:0xf
    s_nop 0
    v_dot2c_f32_bf16 v56, v8, v8
    v_dot2c_f32_bf16 v56, v9, v9
    v_dot2c_f32_bf16 v56, v10, v10
    v_dot2c_f32_bf16 v56, v11, v11
    v_dot2c_f32_bf16 v56, v12, v12
    v_dot2c_f32_bf16 v56, v13, v13
    v_mov_b32 v5, v40
    v_mov_b32 v6, v40
    s_nop 1
    v_permlane32_swap_b32 v5, v6
    s_nop 1
    v_max_f32 v40, v5, v6
    v_mov_b32 v5, v40
    v_mov_b32 v6, v40
    s_nop 1
    v_permlane16_swap_b32 v5, v6
    s_nop 1
    v_max_f32 v40, v5, v6
    v_mov_b32 v5, v42
    v_mov_b32 v6, v42
    s_nop 1
    v_permlane32_swap_b32 v5, v6
    s_nop 1
    v_max_f32 v42, v5, v6
    v_mov_b32 v5, v42
    v_mov_b32 v6, v42
    s_nop 1
    v_permlane16_swap_b32 v5, v6
    s_nop 1
    v_max_f32 v42, v5, v6
    v_add_f32 v7, v40, v42
    v_mov_b32 v5, v56
    v_mov_b32 v6, v56
    s_nop 1
    v_permlane32_swap_b32 v5, v6
    s_nop 1
    v_add_f32 v56, v5, v6
    v_mul_f32 v56, v56, v7
    v_sqrt_f32 v56, v56
    s_nop 0
    v_sub_f32 v56, 0, v56
    v_mov_b32 v24, v56
    v_mov_b32 v25, v56
    v_mov_b32 v26, v56
    v_mov_b32 v27, v56
    v_mov_b32 v28, v56
    v_mov_b32 v29, v56
    v_mov_b32 v30, v56
    v_mov_b32 v31, v56
    v_mov_b32 v32, v56
    v_mov_b32 v33, v56
    v_mov_b32 v34, v56
    v_mov_b32 v35, v56
    v_mov_b32 v36, v56
    v_mov_b32 v37, v56
    v_mov_b32 v38, v56
    v_mov_b32 v39, v56
k2_kernel_cpass3:
    s_cmp_eq_u32 s25, 1
    s_cbranch_scc1 k2_kernel_maxp4
    v_mov_b32 v80, 0
    v_mov_b32 v81, 0
    v_mov_b32 v82, 0
    v_mov_b32 v83, 0
    v_mov_b32 v84, 0
    v_mov_b32 v85, 0
    v_mov_b32 v86, 0
    v_mov_b32 v87, 0
    v_mov_b32 v88, 0
    v_mov_b32 v89, 0
    v_mov_b32 v90, 0
    v_mov_b32 v91, 0
    v_mov_b32 v92, 0
    v_mov_b32 v93, 0
    v_mov_b32 v94, 0
    v_mov_b32 v95, 0
    v_mov_b32 v72, 0
    v_mov_b32 v73, 0
    v_mov_b32 v74, 0
    v_mov_b32 v75, 0
    v_mov_b32 v76, 0
    v_mov_b32 v77, 0
    v_mov_b32 v78, 0
    v_mov_b32 v79, 0
    v_mov_b32 v112, 0
    v_mov_b32 v113, 0
    v_mov_b32 v114, 0
    v_mov_b32 v115, 0
    v_mov_b32 v116, 0
    v_mov_b32 v117, 0
    v_mov_b32 v118, 0
    v_mov_b32 v119, 0
    s_waitcnt vmcnt(0) lgkmcnt(0)
    s_barrier
    s_mov_b32 s24, 0
    s_mov_b32 s27, 0
    ds_read_b128 v[96:99], v18 offset:0
    ds_read_b64 v[14:15], v19 offset:0
    ds_read_b128 v[100:103], v18 offset:1024
    ds_read_b64 v[16:17], v19 offset:256
    s_add_u32 s8, s24, 1
    s_add_u32 s27, s27, 22528
    s_cmp_eq_u32 s27, 67584
    s_cselect_b32 s27, 0, s27
    s_cmp_ge_u32 s8, 8
    s_cbranch_scc1 k2_kernel_ni6
    s_mul_i32 s6, s8, 22528
    s_lshl_b32 s7, s3, 10
    s_add_u32 s6, s6, s7
    s_add_u32 s7, s7, s27
    s_add_u32 m0, s7, 0
    s_add_u32 s28, s6, 0
    buffer_load_dwordx4 v21, s[20:23], s28 offen lds
    s_add_u32 m0, s7, 8192
    s_add_u32 s28, s6, 8192
    buffer_load_dwordx4 v21, s[20:23], s28 offen lds
    s_cmp_ge_u32 s3, 6
    s_cbranch_scc1 k2_kernel_sk7
    s_add_u32 m0, s7, 16384
    s_add_u32 s28, s6, 16384
    buffer_load_dwordx4 v21, s[20:23], s28 offen lds
k2_kernel_sk7:
k2_kernel_ni6:
    s_lshl_b32 s33, s3, 10
    s_add_u32 s31, s33, 22528
    s_mov_b32 s32, 0x40000000
    s_cmp_lt_u32 s3, 6
    s_cselect_b32 s34, 16384, s32
    s_cselect_b32 s35, 16384, s32
    s_mov_b32 s37, 75840
    s_mov_b32 s36, 67648
    s_waitcnt lgkmcnt(0)
    v_mfma_f32_32x32x16_bf16 v[40:55], v[96:99], v[8:11], v[24:39]
    v_mfma_f32_32x32x8_bf16 v[40:55], v[14:15], v[12:13], v[40:55]
    s_mov_b32 s26, 22528
    s_setprio 0
    s_nop 7
    s_nop 3
    s_cmp_ge_u32 s3, 4
    s_cbranch_scc1 k2_kernel_par19
.p2align 6
k2_kernel_aloop10:
    s_setprio 0
    s_waitcnt lgkmcnt(0)
    v_mfma_f32_32x32x16_bf16 v[56:71], v[100:103], v[8:11], v[24:39]
    v_exp_f32 v40, v40
    v_exp_f32 v41, v41
    v_exp_f32 v42, v42
    v_mfma_f32_32x32x16_bf16 v[80:95], v[112:115], v[72:75], v[80:95]
    v_exp_f32 v43, v43
    v_exp_f32 v44, v44
    v_exp_f32 v45, v45
    v_cvt_pk_bf16_f32 v72, v40, v41
    v_exp_f32 v46, v46
    v_mfma_f32_32x32x8_bf16 v[56:71], v[16:17], v[12:13], v[56:71]
    v_exp_f32 v47, v47
    v_cvt_pk_bf16_f32 v73, v42, v43
    v_exp_f32 v48, v48
    ds_read_b128 v[96:99], v18 offset:2048
    v_exp_f32 v49, v49
    ds_read_b64 v[14:15], v19 offset:512
    v_cvt_pk_bf16_f32 v74, v44, v45
    v_mfma_f32_32x32x16_bf16 v[80:95], v[116:119], v[76:79], v[80:95]
    v_exp_f32 v50, v50
    ds_read_b128 v[104:107], v20 offset:0
    v_exp_f32 v51, v51
    ds_read_b128 v[108:111], v20 offset:768
    v_cvt_pk_bf16_f32 v75, v46, v47
    v_exp_f32 v52, v52
    v_exp_f32 v53, v53
    v_cvt_pk_bf16_f32 v76, v48, v49
    v_exp_f32 v54, v54
    v_exp_f32 v55, v55
    v_cvt_pk_bf16_f32 v77, v50, v51
    v_cvt_pk_bf16_f32 v78, v52, v53
    v_cvt_pk_bf16_f32 v79, v54, v55
    s_setprio 1
    s_waitcnt lgkmcnt(0)
    v_mfma_f32_32x32x16_bf16 v[40:55], v[96:99], v[8:11], v[24:39]
    v_exp_f32 v56, v56
    v_exp_f32 v57, v57
    v_exp_f32 v58, v58
    v_mfma_f32_32x32x16_bf16 v[80:95], v[104:107], v[72:75], v[80:95]
    v_exp_f32 v59, v59
    v_exp_f32 v60, v60
    v_exp_f32 v61, v61
    v_cvt_pk_bf16_f32 v72, v56, v57
    v_exp_f32 v62, v62
    v_mfma_f32_32x32x8_bf16 v[40:55], v[14:15], v[12:13], v[40:55]
    v_exp_f32 v63, v63
    v_cvt_pk_bf16_f32 v73, v58, v59
    v_exp_f32 v64, v64
    ds_read_b128 v[100:103], v18 offset:3072
    v_exp_f32 v65, v65
    ds_read_b64 v[16:17], v19 offset:768
    v_cvt_pk_bf16_f32 v74, v60, v61
    v_mfma_f32_32x32x16_bf16 v[80:95], v[108:111], v[76:79], v[80:95]
    v_exp_f32 v66, v66
    ds_read_b128 v[112:115], v20 offset:1536
    v_exp_f32 v67, v67
    ds_read_b128 v[116:119], v20 offset:2304
    v_cvt_pk_bf16_f32 v75, v62, v63
    v_exp_f32 v68, v68
    v_exp_f32 v69, v69
    v_cvt_pk_bf16_f32 v76, v64, v65
    v_exp_f32 v70, v70
    v_exp_f32 v71, v71
    v_cvt_pk_bf16_f32 v77, v66, v67
    v_cvt_pk_bf16_f32 v78, v68, v69
    v_cvt_pk_bf16_f32 v79, v70, v71
    s_setprio 0
    s_waitcnt lgkmcnt(0)
    v_mfma_f32_32x32x16_bf16 v[56:71], v[100:103], v[8:11], v[24:39]
    v_exp_f32 v40, v40
    v_exp_f32 v41, v41
    v_exp_f32 v42, v42
    v_mfma_f32_32x32x16_bf16 v[80:95], v[112:115], v[72:75], v[80:95]
    v_exp_f32 v43, v43
    v_exp_f32 v44, v44
    v_exp_f32 v45, v45
    v_cvt_pk_bf16_f32 v72, v40, v41
    v_exp_f32 v46, v46
    v_mfma_f32_32x32x8_bf16 v[56:71], v[16:17], v[12:13], v[56:71]
    v_exp_f32 v47, v47
    v_cvt_pk_bf16_f32 v73, v42, v43
    v_exp_f32 v48, v48
    ds_read_b128 v[96:99], v18 offset:4096
    v_exp_f32 v49, v49
    ds_read_b64 v[14:15], v19 offset:1024
    v_cvt_pk_bf16_f32 v74, v44, v45
    v_mfma_f32_32x32x16_bf16 v[80:95], v[116:119], v[76:79], v[80:95]
    v_exp_f32 v50, v50
    ds_read_b128 v[104:107], v20 offset:3072
    v_exp_f32 v51, v51
    ds_read_b128 v[108:111], v20 offset:3840
    v_cvt_pk_bf16_f32 v75, v46, v47
    v_exp_f32 v52, v52
    v_exp_f32 v53, v53
    v_cvt_pk_bf16_f32 v76, v48, v49
    v_exp_f32 v54, v54
    v_exp_f32 v55, v55
    v_cvt_pk_bf16_f32 v77, v50, v51
    v_cvt_pk_bf16_f32 v78, v52, v53
    v_cvt_pk_bf16_f32 v79, v54, v55
    s_setprio 1
    s_waitcnt lgkmcnt(0)
    v_mfma_f32_32x32x16_bf16 v[40:55], v[96:99], v[8:11], v[24:39]
    v_exp_f32 v56, v56
    v_exp_f32 v57, v57
    v_exp_f32 v58, v58
    v_mfma_f32_32x32x16_bf16 v[80:95], v[104:107], v[72:75], v[80:95]
    v_exp_f32 v59, v59
    v_exp_f32 v60, v60
    v_exp_f32 v61, v61
    v_cvt_pk_bf16_f32 v72, v56, v57
    v_exp_f32 v62, v62
    v_mfma_f32_32x32x8_bf16 v[40:55], v[14:15], v[12:13], v[40:55]
    v_exp_f32 v63, v63
    v_cvt_pk_bf16_f32 v73, v58, v59
    v_exp_f32 v64, v64
    ds_read_b128 v[100:103], v18 offset:5120
    v_exp_f32 v65, v65
    ds_read_b64 v[16:17], v19 offset:1280
    v_cvt_pk_bf16_f32 v74, v60, v61
    v_mfma_f32_32x32x16_bf16 v[80:95], v[108:111], v[76:79], v[80:95]
    v_exp_f32 v66, v66
    ds_read_b128 v[112:115], v20 offset:4608
    v_exp_f32 v67, v67
    ds_read_b128 v[116:119], v20 offset:5376
    v_cvt_pk_bf16_f32 v75, v62, v63
    v_exp_f32 v68, v68
    v_exp_f32 v69, v69
    v_cvt_pk_bf16_f32 v76, v64, v65
    v_exp_f32 v70, v70
    v_exp_f32 v71, v71
    v_cvt_pk_bf16_f32 v77, v66, v67
    v_cvt_pk_bf16_f32 v78, v68, v69
    v_cvt_pk_bf16_f32 v79, v70, v71
    s_setprio 0
    s_waitcnt lgkmcnt(0)
    v_mfma_f32_32x32x16_bf16 v[56:71], v[100:103], v[8:11], v[24:39]
    v_exp_f32 v40, v40
    v_exp_f32 v41, v41
    v_exp_f32 v42, v42
    v_mfma_f32_32x32x16_bf16 v[80:95], v[112:115], v[72:75], v[80:95]
    v_exp_f32 v43, v43
    v_exp_f32 v44, v44
    v_exp_f32 v45, v45
    v_cvt_pk_bf16_f32 v72, v40, v41
    v_exp_f32 v46, v46
    v_mfma_f32_32x32x8_bf16 v[56:71], v[16:17], v[12:13], v[56:71]
    v_exp_f32 v47, v47
    v_cvt_pk_bf16_f32 v73, v42, v43
    v_exp_f32 v48, v48
    ds_read_b128 v[96:99], v18 offset:6144
    v_exp_f32 v49, v49
    ds_read_b64 v[14:15], v19 offset:1536
    v_cvt_pk_bf16_f32 v74, v44, v45
    v_mfma_f32_32x32x16_bf16 v[80:95], v[116:119], v[76:79], v[80:95]
    v_exp_f32 v50, v50
    ds_read_b128 v[104:107], v20 offset:6144
    v_exp_f32 v51, v51
    ds_read_b128 v[108:111], v20 offset:6912
    v_cvt_pk_bf16_f32 v75, v46, v47
    v_exp_f32 v52, v52
    v_exp_f32 v53, v53
    v_cvt_pk_bf16_f32 v76, v48, v49
    v_exp_f32 v54, v54
    v_exp_f32 v55, v55
    v_cvt_pk_bf16_f32 v77, v50, v51
    v_cvt_pk_bf16_f32 v78, v52, v53
    v_cvt_pk_bf16_f32 v79, v54, v55
    s_setprio 1
    s_waitcnt lgkmcnt(0)
    v_mfma_f32_32x32x16_bf16 v[40:55], v[96:99], v[8:11], v[24:39]
    v_exp_f32 v56, v56
    v_exp_f32 v57, v57
    v_exp_f32 v58, v58
    v_mfma_f32_32x32x16_bf16 v[80:95], v[104:107], v[72:75], v[80:95]
    v_exp_f32 v59, v59
    v_exp_f32 v60, v60
    v_exp_f32 v61, v61
    v_cvt_pk_bf16_f32 v72, v56, v57
    v_exp_f32 v62, v62
    v_mfma_f32_32x32x8_bf16 v[40:55], v[14:15], v[12:13], v[40:55]
    v_exp_f32 v63, v63
    v_cvt_pk_bf16_f32 v73, v58, v59
    v_exp_f32 v64, v64
    ds_read_b128 v[100:103], v18 offset:7168
    v_exp_f32 v65, v65
    ds_read_b64 v[16:17], v19 offset:1792
    v_cvt_pk_bf16_f32 v74, v60, v61
    v_mfma_f32_32x32x16_bf16 v[80:95], v[108:111], v[76:79], v[80:95]
    v_exp_f32 v66, v66
    ds_read_b128 v[112:115], v20 offset:7680
    v_exp_f32 v67, v67
    ds_read_b128 v[116:119], v20 offset:8448
    v_cvt_pk_bf16_f32 v75, v62, v63
    v_exp_f32 v68, v68
    v_exp_f32 v69, v69
    v_cvt_pk_bf16_f32 v76, v64, v65
    v_exp_f32 v70, v70
    v_exp_f32 v71, v71
    v_cvt_pk_bf16_f32 v77, v66, v67
    v_cvt_pk_bf16_f32 v78, v68, v69
    v_cvt_pk_bf16_f32 v79, v70, v71
    s_setprio 0
    s_cmp_eq_u32 s24, 7
    s_cbranch_scc1 k2_kernel_nb11
    s_waitcnt vmcnt(0)
    s_barrier
k2_kernel_nb11:
    v_add_u32 v18, s26, v18
    v_add_u32 v19, s26, v19
    s_waitcnt lgkmcnt(0)
    v_mfma_f32_32x32x16_bf16 v[56:71], v[100:103], v[8:11], v[24:39]
    v_exp_f32 v40, v40
    v_exp_f32 v41, v41
    ds_read_b128 v[96:99], v18 offset:0
    ds_read_b64 v[14:15], v19 offset:0
    v_exp_f32 v42, v42
    v_mfma_f32_32x32x16_bf16 v[80:95], v[112:115], v[72:75], v[80:95]
    v_exp_f32 v43, v43
    ds_read_b128 v[104:107], v20 offset:9216
    ds_read_b128 v[108:111], v20 offset:9984
    v_exp_f32 v44, v44
    s_add_u32 s27, s27, 22528
    s_cmp_eq_u32 s27, 67584
    v_exp_f32 v45, v45
    s_cselect_b32 s27, 0, s27
    s_add_u32 s31, s31, 22528
    v_cvt_pk_bf16_f32 v72, v40, v41
    v_exp_f32 v46, v46
    v_mfma_f32_32x32x8_bf16 v[56:71], v[16:17], v[12:13], v[56:71]
    v_exp_f32 v47, v47
    s_add_u32 s8, s27, s33
    s_cmp_ge_u32 s24, 6
    v_cvt_pk_bf16_f32 v73, v42, v43
    v_exp_f32 v48, v48
    s_cselect_b32 s28, s32, s31
    s_cselect_b32 s7, s36, s8
    v_exp_f32 v49, v49
    s_mov_b32 m0, s7
    s_add_u32 s6, s28, 8192
    v_cvt_pk_bf16_f32 v74, v44, v45
    v_mfma_f32_32x32x16_bf16 v[80:95], v[116:119], v[76:79], v[80:95]
    v_exp_f32 v50, v50
    buffer_load_dwordx4 v21, s[20:23], s28 offen lds
    s_add_u32 m0, s7, 8192
    v_exp_f32 v51, v51
    s_add_u32 s8, s28, s34
    buffer_load_dwordx4 v21, s[20:23], s6 offen lds
    v_cvt_pk_bf16_f32 v75, v46, v47
    v_exp_f32 v52, v52
    s_add_u32 s7, s7, s35
    s_min_u32 s7, s7, s37
    v_exp_f32 v53, v53
    s_mov_b32 m0, s7
    s_nop 0
    v_cvt_pk_bf16_f32 v76, v48, v49
    v_exp_f32 v54, v54
    buffer_load_dwordx4 v21, s[20:23], s8 offen lds
    v_exp_f32 v55, v55
    v_cvt_pk_bf16_f32 v77, v50, v51
    v_cvt_pk_bf16_f32 v78, v52, v53
    v_cvt_pk_bf16_f32 v79, v54, v55
    s_setprio 1
    s_waitcnt lgkmcnt(0)
    v_mfma_f32_32x32x16_bf16 v[40:55], v[96:99], v[8:11], v[24:39]
    v_exp_f32 v56, v56
    v_exp_f32 v57, v57
    v_exp_f32 v58, v58
    v_mfma_f32_32x32x16_bf16 v[80:95], v[104:107], v[72:75], v[80:95]
    v_exp_f32 v59, v59
    v_exp_f32 v60, v60
    v_exp_f32 v61, v61
    v_cvt_pk_bf16_f32 v72, v56, v57
    v_exp_f32 v62, v62
    v_mfma_f32_32x32x8_bf16 v[40:55], v[14:15], v[12:13], v[40:55]
    v_exp_f32 v63, v63
    v_cvt_pk_bf16_f32 v73, v58, v59
    v_exp_f32 v64, v64
    ds_read_b128 v[100:103], v18 offset:1024
    v_exp_f32 v65, v65
    ds_read_b64 v[16:17], v19 offset:256
    v_cvt_pk_bf16_f32 v74, v60, v61
    v_mfma_f32_32x32x16_bf16 v[80:95], v[108:111], v[76:79], v[80:95]
    v_exp_f32 v66, v66
    ds_read_b128 v[112:115], v20 offset:10752
    v_exp_f32 v67, v67
    ds_read_b128 v[116:119], v20 offset:11520
    v_cvt_pk_bf16_f32 v75, v62, v63
    v_exp_f32 v68, v68
    v_exp_f32 v69, v69
    v_cvt_pk_bf16_f32 v76, v64, v65
    v_exp_f32 v70, v70
    v_exp_f32 v71, v71
    v_cvt_pk_bf16_f32 v77, v66, v67
    v_cvt_pk_bf16_f32 v78, v68, v69
    v_cvt_pk_bf16_f32 v79, v70, v71
    v_add_u32 v20, s26, v20
    s_add_u32 s24, s24, 1
    s_add_u32 s6, s24, 1
    s_mul_i32 s7, s6, 0xaaab
    s_lshr_b32 s7, s7, 17
    s_mul_i32 s7, s7, 3
    s_cmp_eq_u32 s6, s7
    s_mov_b32 s26, 22528
    s_cselect_b32 s26, 4294922240, s26
    s_cmp_lt_u32 s24, 8
    s_cbranch_scc1 k2_kernel_aloop10
    s_branch k2_kernel_adone8
k2_kernel_par19:
.p2align 6
k2_kernel_aloop12:
    s_setprio 1
    s_waitcnt lgkmcnt(0)
    v_mfma_f32_32x32x16_bf16 v[56:71], v[100:103], v[8:11], v[24:39]
    v_exp_f32 v40, v40
    v_exp_f32 v41, v41
    v_exp_f32 v42, v42
    v_mfma_f32_32x32x16_bf16 v[80:95], v[112:115], v[72:75], v[80:95]
    v_exp_f32 v43, v43
    v_exp_f32 v44, v44
    v_exp_f32 v45, v45
    v_cvt_pk_bf16_f32 v72, v40, v41
    v_exp_f32 v46, v46
    v_mfma_f32_32x32x8_bf16 v[56:71], v[16:17], v[12:13], v[56:71]
    v_exp_f32 v47, v47
    v_cvt_pk_bf16_f32 v73, v42, v43
    v_exp_f32 v48, v48
    ds_read_b128 v[96:99], v18 offset:2048
    v_exp_f32 v49, v49
    ds_read_b64 v[14:15], v19 offset:512
    v_cvt_pk_bf16_f32 v74, v44, v45
    v_mfma_f32_32x32x16_bf16 v[80:95], v[116:119], v[76:79], v[80:95]
    v_exp_f32 v50, v50
    ds_read_b128 v[104:107], v20 offset:0
    v_exp_f32 v51, v51
    ds_read_b128 v[108:111], v20 offset:768
    v_cvt_pk_bf16_f32 v75, v46, v47
    v_exp_f32 v52, v52
    v_exp_f32 v53, v53
    v_cvt_pk_bf16_f32 v76, v48, v49
    v_exp_f32 v54, v54
    v_exp_f32 v55, v55
    v_cvt_pk_bf16_f32 v77, v50, v51
    v_cvt_pk_bf16_f32 v78, v52, v53
    v_cvt_pk_bf16_f32 v79, v54, v55
    s_setprio 0
    s_waitcnt lgkmcnt(0)
    v_mfma_f32_32x32x16_bf16 v[40:55], v[96:99], v[8:11], v[24:39]
    v_exp_f32 v56, v56
    v_exp_f32 v57, v57
    v_exp_f32 v58, v58
    v_mfma_f32_32x32x16_bf16 v[80:95], v[104:107], v[72:75], v[80:95]
    v_exp_f32 v59, v59
    v_exp_f32 v60, v60
    v_exp_f32 v61, v61
    v_cvt_pk_bf16_f32 v72, v56, v57
    v_exp_f32 v62, v62
    v_mfma_f32_32x32x8_bf16 v[40:55], v[14:15], v[12:13], v[40:55]
    v_exp_f32 v63, v63
    v_cvt_pk_bf16_f32 v73, v58, v59
    v_exp_f32 v64, v64
    ds_read_b128 v[100:103], v18 offset:3072
    v_exp_f32 v65, v65
    ds_read_b64 v[16:17], v19 offset:768
    v_cvt_pk_bf16_f32 v74, v60, v61
    v_mfma_f32_32x32x16_bf16 v[80:95], v[108:111], v[76:79], v[80:95]
    v_exp_f32 v66, v66
    ds_read_b128 v[112:115], v20 offset:1536
    v_exp_f32 v67, v67
    ds_read_b128 v[116:119], v20 offset:2304
    v_cvt_pk_bf16_f32 v75, v62, v63
    v_exp_f32 v68, v68
    v_exp_f32 v69, v69
    v_cvt_pk_bf16_f32 v76, v64, v65
    v_exp_f32 v70, v70
    v_exp_f32 v71, v71
    v_cvt_pk_bf16_f32 v77, v66, v67
    v_cvt_pk_bf16_f32 v78, v68, v69
    v_cvt_pk_bf16_f32 v79, v70, v71
    s_setprio 1
    s_waitcnt lgkmcnt(0)
    v_mfma_f32_32x32x16_bf16 v[56:71], v[100:103], v[8:11], v[24:39]
    v_exp_f32 v40, v40
    v_exp_f32 v41, v41
    v_exp_f32 v42, v42
    v_mfma_f32_32x32x16_bf16 v[80:95], v[112:115], v[72:75], v[80:95]
    v_exp_f32 v43, v43
    v_exp_f32 v44, v44
    v_exp_f32 v45, v45
    v_cvt_pk_bf16_f32 v72, v40, v41
    v_exp_f32 v46, v46
    v_mfma_f32_32x32x8_bf16 v[56:71], v[16:17], v[12:13], v[56:71]
    v_exp_f32 v47, v47
    v_cvt_pk_bf16_f32 v73, v42, v43
    v_exp_f32 v48, v48
    ds_read_b128 v[96:99], v18 offset:4096
    v_exp_f32 v49, v49
    ds_read_b64 v[14:15], v19 offset:1024
    v_cvt_pk_bf16_f32 v74, v44, v45
    v_mfma_f32_32x32x16_bf16 v[80:95], v[116:119], v[76:79], v[80:95]
    v_exp_f32 v50, v50
    ds_read_b128 v[104:107], v20 offset:3072
    v_exp_f32 v51, v51
    ds_read_b128 v[108:111], v20 offset:3840
    v_cvt_pk_bf16_f32 v75, v46, v47
    v_exp_f32 v52, v52
    v_exp_f32 v53, v53
    v_cvt_pk_bf16_f32 v76, v48, v49
    v_exp_f32 v54, v54
    v_exp_f32 v55, v55
    v_cvt_pk_bf16_f32 v77, v50, v51
    v_cvt_pk_bf16_f32 v78, v52, v53
    v_cvt_pk_bf16_f32 v79, v54, v55
    s_setprio 0
    s_waitcnt lgkmcnt(0)
    v_mfma_f32_32x32x16_bf16 v[40:55], v[96:99], v[8:11], v[24:39]
    v_exp_f32 v56, v56
    v_exp_f32 v57, v57
    v_exp_f32 v58, v58
    v_mfma_f32_32x32x16_bf16 v[80:95], v[104:107], v[72:75], v[80:95]
    v_exp_f32 v59, v59
    v_exp_f32 v60, v60
    v_exp_f32 v61, v61
    v_cvt_pk_bf16_f32 v72, v56, v57
    v_exp_f32 v62, v62
    v_mfma_f32_32x32x8_bf16 v[40:55], v[14:15], v[12:13], v[40:55]
    v_exp_f32 v63, v63
    v_cvt_pk_bf16_f32 v73, v58, v59
    v_exp_f32 v64, v64
    ds_read_b128 v[100:103], v18 offset:5120
    v_exp_f32 v65, v65
    ds_read_b64 v[16:17], v19 offset:1280
    v_cvt_pk_bf16_f32 v74, v60, v61
    v_mfma_f32_32x32x16_bf16 v[80:95], v[108:111], v[76:79], v[80:95]
    v_exp_f32 v66, v66
    ds_read_b128 v[112:115], v20 offset:4608
    v_exp_f32 v67, v67
    ds_read_b128 v[116:119], v20 offset:5376
    v_cvt_pk_bf16_f32 v75, v62, v63
    v_exp_f32 v68, v68
    v_exp_f32 v69, v69
    v_cvt_pk_bf16_f32 v76, v64, v65
    v_exp_f32 v70, v70
    v_exp_f32 v71, v71
    v_cvt_pk_bf16_f32 v77, v66, v67
    v_cvt_pk_bf16_f32 v78, v68, v69
    v_cvt_pk_bf16_f32 v79, v70, v71
    s_setprio 1
    s_waitcnt lgkmcnt(0)
    v_mfma_f32_32x32x16_bf16 v[56:71], v[100:103], v[8:11], v[24:39]
    v_exp_f32 v40, v40
    v_exp_f32 v41, v41
    v_exp_f32 v42, v42
    v_mfma_f32_32x32x16_bf16 v[80:95], v[112:115], v[72:75], v[80:95]
    v_exp_f32 v43, v43
    v_exp_f32 v44, v44
    v_exp_f32 v45, v45
    v_cvt_pk_bf16_f32 v72, v40, v41
    v_exp_f32 v46, v46
    v_mfma_f32_32x32x8_bf16 v[56:71], v[16:17], v[12:13], v[56:71]
    v_exp_f32 v47, v47
    v_cvt_pk_bf16_f32 v73, v42, v43
    v_exp_f32 v48, v48
    ds_read_b128 v[96:99], v18 offset:6144
    v_exp_f32 v49, v49
    ds_read_b64 v[14:15], v19 offset:1536
    v_cvt_pk_bf16_f32 v74, v44, v45
    v_mfma_f32_32x32x16_bf16 v[80:95], v[116:119], v[76:79], v[80:95]
    v_exp_f32 v50, v50
    ds_read_b128 v[104:107], v20 offset:6144
    v_exp_f32 v51, v51
    ds_read_b128 v[108:111], v20 offset:6912
    v_cvt_pk_bf16_f32 v75, v46, v47
    v_exp_f32 v52, v52
    v_exp_f32 v53, v53
    v_cvt_pk_bf16_f32 v76, v48, v49
    v_exp_f32 v54, v54
    v_exp_f32 v55, v55
    v_cvt_pk_bf16_f32 v77, v50, v51
    v_cvt_pk_bf16_f32 v78, v52, v53
    v_cvt_pk_bf16_f32 v79, v54, v55
    s_setprio 0
    s_waitcnt lgkmcnt(0)
    v_mfma_f32_32x32x16_bf16 v[40:55], v[96:99], v[8:11], v[24:39]
    v_exp_f32 v56, v56
    v_exp_f32 v57, v57
    v_exp_f32 v58, v58
    v_mfma_f32_32x32x16_bf16 v[80:95], v[104:107], v[72:75], v[80:95]
    v_exp_f32 v59, v59
    v_exp_f32 v60, v60
    v_exp_f32 v61, v61
    v_cvt_pk_bf16_f32 v72, v56, v57
    v_exp_f32 v62, v62
    v_mfma_f32_32x32x8_bf16 v[40:55], v[14:15], v[12:13], v[40:55]
    v_exp_f32 v63, v63
    v_cvt_pk_bf16_f32 v73, v58, v59
    v_exp_f32 v64, v64
    ds_read_b128 v[100:103], v18 offset:7168
    v_exp_f32 v65, v65
    ds_read_b64 v[16:17], v19 offset:1792
    v_cvt_pk_bf16_f32 v74, v60, v61
    v_mfma_f32_32x32x16_bf16 v[80:95], v[108:111], v[76:79], v[80:95]
    v_exp_f32 v66, v66
    ds_read_b128 v[112:115], v20 offset:7680
    v_exp_f32 v67, v67
    ds_read_b128 v[116:119], v20 offset:8448
    v_cvt_pk_bf16_f32 v75, v62, v63
    v_exp_f32 v68, v68
    v_exp_f32 v69, v69
    v_cvt_pk_bf16_f32 v76, v64, v65
    v_exp_f32 v70, v70
    v_exp_f32 v71, v71
    v_cvt_pk_bf16_f32 v77, v66, v67
    v_cvt_pk_bf16_f32 v78, v68, v69
    v_cvt_pk_bf16_f32 v79, v70, v71
    s_setprio 1
    s_cmp_eq_u32 s24, 7
    s_cbranch_scc1 k2_kernel_nb13
    s_waitcnt vmcnt(0)
    s_barrier
k2_kernel_nb13:
    v_add_u32 v18, s26, v18
    v_add_u32 v19, s26, v19
    s_waitcnt lgkmcnt(0)
    v_mfma_f32_32x32x16_bf16 v[56:71], v[100:103], v[8:11], v[24:39]
    v_exp_f32 v40, v40
    v_exp_f32 v41, v41
    ds_read_b128 v[96:99], v18 offset:0
    ds_read_b64 v[14:15], v19 offset:0
    v_exp_f32 v42, v42
    v_mfma_f32_32x32x16_bf16 v[80:95], v[112:115], v[72:75], v[80:95]
    v_exp_f32 v43, v43
    ds_read_b128 v[104:107], v20 offset:9216
    ds_read_b128 v[108:111], v20 offset:9984
    v_exp_f32 v44, v44
    s_add_u32 s27, s27, 22528
    s_cmp_eq_u32 s27, 67584
    v_exp_f32 v45, v45
    s_cselect_b32 s27, 0, s27
    s_add_u32 s31, s31, 22528
    v_cvt_pk_bf16_f32 v72, v40, v41
    v_exp_f32 v46, v46
    v_mfma_f32_32x32x8_bf16 v[56:71], v[16:17], v[12:13], v[56:71]
    v_exp_f32 v47, v47
    s_add_u32 s8, s27, s33
    s_cmp_ge_u32 s24, 6
    v_cvt_pk_bf16_f32 v73, v42, v43
    v_exp_f32 v48, v48
    s_cselect_b32 s28, s32, s31
    s_cselect_b32 s7, s36, s8
    v_exp_f32 v49, v49
    s_mov_b32 m0, s7
    s_add_u32 s6, s28, 8192
    v_cvt_pk_bf16_f32 v74, v44, v45
    v_mfma_f32_32x32x16_bf16 v[80:95], v[116:119], v[76:79], v[80:95]
    v_exp_f32 v50, v50
    buffer_load_dwordx4 v21, s[20:23], s28 offen lds
    s_add_u32 m0, s7, 8192
    v_exp_f32 v51, v51
    s_add_u32 s8, s28, s34
    buffer_load_dwordx4 v21, s[20:23], s6 offen lds
    v_cvt_pk_bf16_f32 v75, v46, v47
    v_exp_f32 v52, v52
    s_add_u32 s7, s7, s35
    s_min_u32 s7, s7, s37
    v_exp_f32 v53, v53
    s_mov_b32 m0, s7
    s_nop 0
    v_cvt_pk_bf16_f32 v76, v48, v49
    v_exp_f32 v54, v54
    buffer_load_dwordx4 v21, s[20:23], s8 offen lds
    v_exp_f32 v55, v55
    v_cvt_pk_bf16_f32 v77, v50, v51
    v_cvt_pk_bf16_f32 v78, v52, v53
    v_cvt_pk_bf16_f32 v79, v54, v55
    s_setprio 0
    s_waitcnt lgkmcnt(0)
    v_mfma_f32_32x32x16_bf16 v[40:55], v[96:99], v[8:11], v[24:39]
    v_exp_f32 v56, v56
    v_exp_f32 v57, v57
    v_exp_f32 v58, v58
    v_mfma_f32_32x32x16_bf16 v[80:95], v[104:107], v[72:75], v[80:95]
    v_exp_f32 v59, v59
    v_exp_f32 v60, v60
    v_exp_f32 v61, v61
    v_cvt_pk_bf16_f32 v72, v56, v57
    v_exp_f32 v62, v62
    v_mfma_f32_32x32x8_bf16 v[40:55], v[14:15], v[12:13], v[40:55]
    v_exp_f32 v63, v63
    v_cvt_pk_bf16_f32 v73, v58, v59
    v_exp_f32 v64, v64
    ds_read_b128 v[100:103], v18 offset:1024
    v_exp_f32 v65, v65
    ds_read_b64 v[16:17], v19 offset:256
    v_cvt_pk_bf16_f32 v74, v60, v61
    v_mfma_f32_32x32x16_bf16 v[80:95], v[108:111], v[76:79], v[80:95]
    v_exp_f32 v66, v66
    ds_read_b128 v[112:115], v20 offset:10752
    v_exp_f32 v67, v67
    ds_read_b128 v[116:119], v20 offset:11520
    v_cvt_pk_bf16_f32 v75, v62, v63
    v_exp_f32 v68, v68
    v_exp_f32 v69, v69
    v_cvt_pk_bf16_f32 v76, v64, v65
    v_exp_f32 v70, v70
    v_exp_f32 v71, v71
    v_cvt_pk_bf16_f32 v77, v66, v67
    v_cvt_pk_bf16_f32 v78, v68, v69
    v_cvt_pk_bf16_f32 v79, v70, v71
    v_add_u32 v20, s26, v20
    s_add_u32 s24, s24, 1
    s_add_u32 s6, s24, 1
    s_mul_i32 s7, s6, 0xaaab
    s_lshr_b32 s7, s7, 17
    s_mul_i32 s7, s7, 3
    s_cmp_eq_u32 s6, s7
    s_mov_b32 s26, 22528
    s_cselect_b32 s26, 4294922240, s26
    s_cmp_lt_u32 s24, 8
    s_cbranch_scc1 k2_kernel_aloop12
k2_kernel_adone8:
    s_waitcnt lgkmcnt(0)
    v_mfma_f32_32x32x16_bf16 v[80:95], v[112:115], v[72:75], v[80:95]
    v_mfma_f32_32x32x16_bf16 v[80:95], v[116:119], v[76:79], v[80:95]
    s_setprio 3
    s_nop 15
    v_mov_b32 v5, v88
    v_mov_b32 v6, v88
    s_nop 1
    v_permlane32_swap_b32 v5, v6
    s_nop 1
    v_mov_b32 v2, v6
    v_mov_b32 v5, 0x21800000
    v_cmp_nge_f32 vcc, v2, v5
    s_cmp_eq_u64 vcc, 0
    s_cbranch_scc1 k2_kernel_ok14
    v_mov_b32 v4, 67584
    v_mov_b32 v5, 1
    ds_write_b32 v4, v5
k2_kernel_ok14:
    v_rcp_f32 v2, v2
    s_nop 0
    v_mul_f32 v2, v2, v123
    v_mul_f32 v80, v2, v80
    v_mul_f32 v81, v2, v81
    v_mul_f32 v82, v2, v82
    v_mul_f32 v83, v2, v83
    v_mul_f32 v84, v2, v84
    v_mul_f32 v85, v2, v85
    v_mul_f32 v86, v2, v86
    v_mul_f32 v87, v2, v87
    v_mul_f32 v88, v2, v88
    v_mul_f32 v89, v2, v89
    v_mul_f32 v90, v2, v90
    v_mul_f32 v91, v2, v91
    v_cvt_pk_bf16_f32 v72, v80, v81
    v_cvt_pk_bf16_f32 v73, v82, v83
    v_cvt_pk_bf16_f32 v74, v84, v85
    v_cvt_pk_bf16_f32 v75, v86, v87
    v_cvt_pk_bf16_f32 v76, v88, v89
    v_cvt_pk_bf16_f32 v77, v90, v91
    buffer_store_dwordx2 v[72:73], v120, s[16:19], s30 offen sc1
    buffer_store_dwordx2 v[74:75], v121, s[16:19], s30 offen sc1
    s_mov_b32 exec_hi, 0
    buffer_store_dwordx2 v[76:77], v122, s[16:19], s30 offen sc1
    s_mov_b64 exec, -1
    s_waitcnt vmcnt(0) lgkmcnt(0)
    s_barrier
    v_mov_b32 v4, 67584
    ds_read_b32 v5, v4
    s_waitcnt lgkmcnt(0)
    v_readfirstlane_b32 s6, v5
    s_cmp_eq_u32 s25, 2
    s_cbranch_scc1 k2_kernel_cend5
    s_cmp_eq_u32 s6, 0
    s_cbranch_scc1 k2_kernel_cend5
k2_kernel_next15:
    s_add_u32 s25, s25, 1
    s_barrier
    v_lshlrev_b32 v18, 4, v1
    v_lshlrev_b32 v19, 3, v22
    v_add_u32 v19, 8192, v19
    v_min_u32 v5, 23, v22
    v_mul_u32_u24 v6, 384, v23
    v_lshl_add_u32 v20, v5, 4, v6
    v_add_u32 v20, 10240, v20
    s_mov_b32 s24, 0
    s_mov_b32 s27, 0
    s_mul_i32 s6, s24, 22528
    s_lshl_b32 s7, s3, 10
    s_add_u32 s6, s6, s7
    s_add_u32 s7, s7, s27
    s_add_u32 m0, s7, 0
    s_add_u32 s28, s6, 0
    buffer_load_dwordx4 v21, s[20:23], s28 offen lds
    s_add_u32 m0, s7, 8192
    s_add_u32 s28, s6, 8192
    buffer_load_dwordx4 v21, s[20:23], s28 offen lds
    s_cmp_ge_u32 s3, 6
    s_cbranch_scc1 k2_kernel_sk16
    s_add_u32 m0, s7, 16384
    s_add_u32 s28, s6, 16384
    buffer_load_dwordx4 v21, s[20:23], s28 offen lds
k2_kernel_sk16:
    s_branch k2_kernel_cpass3
k2_kernel_maxp4:
    v_mov_b32 v80, 0xff800000
    s_waitcnt vmcnt(0) lgkmcnt(0)
    s_barrier
    s_mov_b32 s24, 0
    s_mov_b32 s27, 0
    s_add_u32 s8, s24, 1
    s_add_u32 s27, s27, 22528
    s_cmp_eq_u32 s27, 67584
    s_cselect_b32 s27, 0, s27
    s_cmp_ge_u32 s8, 8
    s_cbranch_scc1 k2_kernel_ni17
    s_mul_i32 s6, s8, 22528
    s_lshl_b32 s7, s3, 10
    s_add_u32 s6, s6, s7
    s_add_u32 s7, s7, s27
    s_add_u32 m0, s7, 0
    s_add_u32 s28, s6, 0
    buffer_load_dwordx4 v21, s[20:23], s28 offen lds
    s_add_u32 m0, s7, 8192
    s_add_u32 s28, s6, 8192
    buffer_load_dwordx4 v21, s[20:23], s28 offen lds
    s_cmp_ge_u32 s3, 6
    s_cbranch_scc1 k2_kernel_sk18
    s_add_u32 m0, s7, 16384
    s_add_u32 s28, s6, 16384
    buffer_load_dwordx4 v21, s[20:23], s28 offen lds
k2_kernel_sk18:
k2_kernel_ni17:
    s_mov_b32 s26, 22528
k2_kernel_mloop19:
    ds_read_b128 v[96:99], v18 offset:0
    ds_read_b64 v[14:15], v19 offset:0
    s_waitcnt lgkmcnt(0)
    v_mfma_f32_32x32x16_bf16 v[40:55], v[96:99], v[8:11], 0
    v_mfma_f32_32x32x8_bf16 v[40:55], v[14:15], v[12:13], v[40:55]
    s_nop 15
    s_nop 3
    v_max_f32 v80, v80, v40
    v_max_f32 v80, v80, v41
    v_max_f32 v80, v80, v42
    v_max_f32 v80, v80, v43
    v_max_f32 v80, v80, v44
    v_max_f32 v80, v80, v45
    v_max_f32 v80, v80, v46
    v_max_f32 v80, v80, v47
    v_max_f32 v80, v80, v48
    v_max_f32 v80, v80, v49
    v_max_f32 v80, v80, v50
    v_max_f32 v80, v80, v51
    v_max_f32 v80, v80, v52
    v_max_f32 v80, v80, v53
    v_max_f32 v80, v80, v54
    v_max_f32 v80, v80, v55
    ds_read_b128 v[96:99], v18 offset:1024
    ds_read_b64 v[14:15], v19 offset:256
    s_waitcnt lgkmcnt(0)
    v_mfma_f32_32x32x16_bf16 v[40:55], v[96:99], v[8:11], 0
    v_mfma_f32_32x32x8_bf16 v[40:55], v[14:15], v[12:13], v[40:55]
    s_nop 15
    s_nop 3
    v_max_f32 v80, v80, v40
    v_max_f32 v80, v80, v41
    v_max_f32 v80, v80, v42
    v_max_f32 v80, v80, v43
    v_max_f32 v80, v80, v44
    v_max_f32 v80, v80, v45
    v_max_f32 v80, v80, v46
    v_max_f32 v80, v80, v47
    v_max_f32 v80, v80, v48
    v_max_f32 v80, v80, v49
    v_max_f32 v80, v80, v50
    v_max_f32 v80, v80, v51
    v_max_f32 v80, v80, v52
    v_max_f32 v80, v80, v53
    v_max_f32 v80, v80, v54
    v_max_f32 v80, v80, v55
    ds_read_b128 v[96:99], v18 offset:2048
    ds_read_b64 v[14:15], v19 offset:512
    s_waitcnt lgkmcnt(0)
    v_mfma_f32_32x32x16_bf16 v[40:55], v[96:99], v[8:11], 0
    v_mfma_f32_32x32x8_bf16 v[40:55], v[14:15], v[12:13], v[40:55]
    s_nop 15
    s_nop 3
    v_max_f32 v80, v80, v40
    v_max_f32 v80, v80, v41
    v_max_f32 v80, v80, v42
    v_max_f32 v80, v80, v43
    v_max_f32 v80, v80, v44
    v_max_f32 v80, v80, v45
    v_max_f32 v80, v80, v46
    v_max_f32 v80, v80, v47
    v_max_f32 v80, v80, v48
    v_max_f32 v80, v80, v49
    v_max_f32 v80, v80, v50
    v_max_f32 v80, v80, v51
    v_max_f32 v80, v80, v52
    v_max_f32 v80, v80, v53
    v_max_f32 v80, v80, v54
    v_max_f32 v80, v80, v55
    ds_read_b128 v[96:99], v18 offset:3072
    ds_read_b64 v[14:15], v19 offset:768
    s_waitcnt lgkmcnt(0)
    v_mfma_f32_32x32x16_bf16 v[40:55], v[96:99], v[8:11], 0
    v_mfma_f32_32x32x8_bf16 v[40:55], v[14:15], v[12:13], v[40:55]
    s_nop 15
    s_nop 3
    v_max_f32 v80, v80, v40
    v_max_f32 v80, v80, v41
    v_max_f32 v80, v80, v42
    v_max_f32 v80, v80, v43
    v_max_f32 v80, v80, v44
    v_max_f32 v80, v80, v45
    v_max_f32 v80, v80, v46
    v_max_f32 v80, v80, v47
    v_max_f32 v80, v80, v48
    v_max_f32 v80, v80, v49
    v_max_f32 v80, v80, v50
    v_max_f32 v80, v80, v51
    v_max_f32 v80, v80, v52
    v_max_f32 v80, v80, v53
    v_max_f32 v80, v80, v54
    v_max_f32 v80, v80, v55
    ds_read_b128 v[96:99], v18 offset:4096
    ds_read_b64 v[14:15], v19 offset:1024
    s_waitcnt lgkmcnt(0)
    v_mfma_f32_32x32x16_bf16 v[40:55], v[96:99], v[8:11], 0
    v_mfma_f32_32x32x8_bf16 v[40:55], v[14:15], v[12:13], v[40:55]
    s_nop 15
    s_nop 3
    v_max_f32 v80, v80, v40
    v_max_f32 v80, v80, v41
    v_max_f32 v80, v80, v42
    v_max_f32 v80, v80, v43
    v_max_f32 v80, v80, v44
    v_max_f32 v80, v80, v45
    v_max_f32 v80, v80, v46
    v_max_f32 v80, v80, v47
    v_max_f32 v80, v80, v48
    v_max_f32 v80, v80, v49
    v_max_f32 v80, v80, v50
    v_max_f32 v80, v80, v51
    v_max_f32 v80, v80, v52
    v_max_f32 v80, v80, v53
    v_max_f32 v80, v80, v54
    v_max_f32 v80, v80, v55
    ds_read_b128 v[96:99], v18 offset:5120
    ds_read_b64 v[14:15], v19 offset:1280
    s_waitcnt lgkmcnt(0)
    v_mfma_f32_32x32x16_bf16 v[40:55], v[96:99], v[8:11], 0
    v_mfma_f32_32x32x8_bf16 v[40:55], v[14:15], v[12:13], v[40:55]
    s_nop 15
    s_nop 3
    v_max_f32 v80, v80, v40
    v_max_f32 v80, v80, v41
    v_max_f32 v80, v80, v42
    v_max_f32 v80, v80, v43
    v_max_f32 v80, v80, v44
    v_max_f32 v80, v80, v45
    v_max_f32 v80, v80, v46
    v_max_f32 v80, v80, v47
    v_max_f32 v80, v80, v48
    v_max_f32 v80, v80, v49
    v_max_f32 v80, v80, v50
    v_max_f32 v80, v80, v51
    v_max_f32 v80, v80, v52
    v_max_f32 v80, v80, v53
    v_max_f32 v80, v80, v54
    v_max_f32 v80, v80, v55
    ds_read_b128 v[96:99], v18 offset:6144
    ds_read_b64 v[14:15], v19 offset:1536
    s_waitcnt lgkmcnt(0)
    v_mfma_f32_32x32x16_bf16 v[40:55], v[96:99], v[8:11], 0
    v_mfma_f32_32x32x8_bf16 v[40:55], v[14:15], v[12:13], v[40:55]
    s_nop 15
    s_nop 3
    v_max_f32 v80, v80, v40
    v_max_f32 v80, v80, v41
    v_max_f32 v80, v80, v42
    v_max_f32 v80, v80, v43
    v_max_f32 v80, v80, v44
    v_max_f32 v80, v80, v45
    v_max_f32 v80, v80, v46
    v_max_f32 v80, v80, v47
    v_max_f32 v80, v80, v48
    v_max_f32 v80, v80, v49
    v_max_f32 v80, v80, v50
    v_max_f32 v80, v80, v51
    v_max_f32 v80, v80, v52
    v_max_f32 v80, v80, v53
    v_max_f32 v80, v80, v54
    v_max_f32 v80, v80, v55
    ds_read_b128 v[96:99], v18 offset:7168
    ds_read_b64 v[14:15], v19 offset:1792
    s_waitcnt lgkmcnt(0)
    s_cmp_eq_u32 s24, 7
    s_cbranch_scc1 k2_kernel_nb20
    s_waitcnt vmcnt(0)
    s_barrier
    s_add_u32 s24, s24, 1
    s_add_u32 s8, s24, 1
    s_add_u32 s27, s27, 22528
    s_cmp_eq_u32 s27, 67584
    s_cselect_b32 s27, 0, s27
    s_cmp_ge_u32 s8, 8
    s_cbranch_scc1 k2_kernel_ni21
    s_mul_i32 s6, s8, 22528
    s_lshl_b32 s7, s3, 10
    s_add_u32 s6, s6, s7
    s_add_u32 s7, s7, s27
    s_add_u32 m0, s7, 0
    s_add_u32 s28, s6, 0
    buffer_load_dwordx4 v21, s[20:23], s28 offen lds
    s_add_u32 m0, s7, 8192
    s_add_u32 s28, s6, 8192
    buffer_load_dwordx4 v21, s[20:23], s28 offen lds
    s_cmp_ge_u32 s3, 6
    s_cbranch_scc1 k2_kernel_sk22
    s_add_u32 m0, s7, 16384
    s_add_u32 s28, s6, 16384
    buffer_load_dwordx4 v21, s[20:23], s28 offen lds
k2_kernel_sk22:
k2_kernel_ni21:
    s_sub_u32 s24, s24, 1
k2_kernel_nb20:
    v_mfma_f32_32x32x16_bf16 v[40:55], v[96:99], v[8:11], 0
    v_mfma_f32_32x32x8_bf16 v[40:55], v[14:15], v[12:13], v[40:55]
    s_nop 15
    s_nop 3
    v_max_f32 v80, v80, v40
    v_max_f32 v80, v80, v41
    v_max_f32 v80, v80, v42
    v_max_f32 v80, v80, v43
    v_max_f32 v80, v80, v44
    v_max_f32 v80, v80, v45
    v_max_f32 v80, v80, v46
    v_max_f32 v80, v80, v47
    v_max_f32 v80, v80, v48
    v_max_f32 v80, v80, v49
    v_max_f32 v80, v80, v50
    v_max_f32 v80, v80, v51
    v_max_f32 v80, v80, v52
    v_max_f32 v80, v80, v53
    v_max_f32 v80, v80, v54
    v_max_f32 v80, v80, v55
    v_add_u32 v18, s26, v18
    v_add_u32 v19, s26, v19
    s_add_u32 s24, s24, 1
    s_add_u32 s6, s24, 1
    s_mul_i32 s7, s6, 0xaaab
    s_lshr_b32 s7, s7, 17
    s_mul_i32 s7, s7, 3
    s_cmp_eq_u32 s6, s7
    s_mov_b32 s26, 22528
    s_cselect_b32 s26, 4294922240, s26
    s_cmp_lt_u32 s24, 8
    s_cbranch_scc1 k2_kernel_mloop19
    v_mov_b32 v5, v80
    v_mov_b32 v6, v80
    s_nop 1
    v_permlane32_swap_b32 v5, v6
    s_nop 1
    v_max_f32 v5, v5, v6
    v_sub_f32 v5, 0, v5
    v_mov_b32 v24, v5
    v_mov_b32 v25, v5
    v_mov_b32 v26, v5
    v_mov_b32 v27, v5
    v_mov_b32 v28, v5
    v_mov_b32 v29, v5
    v_mov_b32 v30, v5
    v_mov_b32 v31, v5
    v_mov_b32 v32, v5
    v_mov_b32 v33, v5
    v_mov_b32 v34, v5
    v_mov_b32 v35, v5
    v_mov_b32 v36, v5
    v_mov_b32 v37, v5
    v_mov_b32 v38, v5
    v_mov_b32 v39, v5
    s_branch k2_kernel_next15
k2_kernel_cend5:
    s_cmp_lg_u32 s3, 0
    s_cbranch_scc1 k2_kernel_pub23
    s_lshl_b32 s6, s4, 7
    s_lshl_b32 s7, s5, 2
    s_add_u32 s6, s6, s7
    s_add_u32 s6, s6, 29778944
    v_mov_b32 v2, 0
    v_mov_b32 v3, 1
    s_mov_b64 exec, 1
    buffer_store_dword v3, v2, s[16:19], s6 offen sc1
    s_mov_b64 exec, -1
k2_kernel_pub23:
k2_kernel_aend:
    s_branch k2_kernel_x
k2_kernel_g:
    s_sub_u32 s2, s2, 256
    s_setprio 1
    s_load_dwordx2 s[10:11], s[0:1], 104
    s_load_dwordx2 s[12:13], s[0:1], 0
    s_load_dwordx2 s[14:15], s[0:1], 88
    v_lshrrev_b32 v4, 6, v0
    s_nop 0
    v_readfirstlane_b32 s3, v4
    v_and_b32 v0, 63, v0
    s_and_b32 s8, s2, 7
    s_lshl_b32 s4, s8, 2
    s_bfe_u32 s8, s2, 0x20006
    s_add_u32 s4, s4, s8
    s_bfe_u32 s5, s2, 0x30003
    s_and_b32 s8, s2, 7
    s_lshl_b32 s6, s8, 1
    s_bfe_u32 s7, s2, 0x10007
    s_add_u32 s6, s6, s7
    s_bfe_u32 s7, s2, 0x40003
    v_and_b32 v1, 15, v0
    v_lshrrev_b32 v2, 4, v0
    s_waitcnt lgkmcnt(0)
    s_mov_b32 s28, s10
    s_mov_b32 s29, s11
    s_mov_b32 s30, 29815808
    s_mov_b32 s31, 0x20000
    s_setprio 3
    s_cmp_ge_u32 s3, 4
    s_cbranch_scc1 k2_kernel_ldr24
    s_lshr_b32 s42, s3, 1
    s_and_b32 s43, s3, 1
    s_lshl_b32 s44, s4, 2
    s_lshl_b32 s8, s42, 1
    s_add_u32 s44, s44, s8
    s_mul_i32 s45, s5, 5
    v_lshlrev_b32 v4, 4, v0
    s_mul_i32 s8, s43, 10240
    v_add_u32 v3, s8, v4
    s_add_u32 s47, s44, s43
    s_waitcnt lgkmcnt(0)
    s_add_u32 s24, s10, 2810880
    s_addc_u32 s25, s11, 0
    s_mov_b32 s26, 2621440
    s_mov_b32 s27, 0x20000
    s_mov_b32 s28, s10
    s_mov_b32 s29, s11
    s_mov_b32 s30, 29815808
    s_mov_b32 s31, 0x20000
    s_lshl_b32 s8, s44, 4
    s_mov_b32 s18, 20480
    v_lshlrev_b32 v9, 8, v2
    v_add_u32 v6, s8, v1
    v_add_u32 v6, -1, v6
    v_ashrrev_i32 v7, 4, v6
    v_and_b32 v8, 15, v6
    v_mul_lo_u32 v7, v7, s18
    v_cmp_gt_i32 vcc, 0, v6
    v_lshl_add_u32 v8, v8, 4, v9
    v_add_u32 v7, v7, v8
    v_mov_b32 v8, 0x80000000
    v_add_u32 v105, 20480, v7
    v_cndmask_b32 v104, v7, v8, vcc
    v_add_u32 v6, s8, v1
    v_add_u32 v6, 1, v6
    v_ashrrev_i32 v7, 4, v6
    v_and_b32 v8, 15, v6
    v_mul_lo_u32 v7, v7, s18
    v_cmp_gt_i32 vcc, 0, v6
    v_lshl_add_u32 v8, v8, 4, v9
    v_add_u32 v7, v7, v8
    v_mov_b32 v8, 0x80000000
    v_add_u32 v107, 20480, v7
    v_cndmask_b32 v106, v7, v8, vcc
    v_add_u32 v6, s8, v1
    v_add_u32 v6, -2, v6
    v_ashrrev_i32 v7, 4, v6
    v_and_b32 v8, 15, v6
    v_mul_lo_u32 v7, v7, s18
    v_cmp_gt_i32 vcc, 0, v6
    v_lshl_add_u32 v8, v8, 4, v9
    v_add_u32 v7, v7, v8
    v_mov_b32 v8, 0x80000000
    v_add_u32 v109, 20480, v7
    v_cndmask_b32 v108, v7, v8, vcc
    v_add_u32 v6, s8, v1
    v_add_u32 v6, 2, v6
    v_ashrrev_i32 v7, 4, v6
    v_and_b32 v8, 15, v6
    v_mul_lo_u32 v7, v7, s18
    v_cmp_gt_i32 vcc, 0, v6
    v_lshl_add_u32 v8, v8, 4, v9
    v_add_u32 v7, v7, v8
    v_mov_b32 v8, 0x80000000
    v_add_u32 v111, 20480, v7
    v_cndmask_b32 v110, v7, v8, vcc
    s_cmp_eq_u32 s43, 0
    s_cbranch_scc1 k2_kernel_sw26
    v_swap_b32 v104, v105
    v_swap_b32 v106, v107
    v_swap_b32 v108, v109
    v_swap_b32 v110, v111
k2_kernel_sw26:
    s_mov_b32 s39, 0
    s_mul_i32 s39, s39, 4
    s_lshl_b32 s8, s43, 1
    s_add_u32 s39, s39, s8
    s_mov_b32 s46, 0
    s_mul_i32 s8, s39, 52
    s_lshr_b32 s8, s8, 8
    s_cmp_lg_u32 s8, 0
    s_cbranch_scc1 k2_kernel_sh27
    v_mov_b32 v10, v104
    v_mov_b32 v11, v105
    s_branch k2_kernel_sh31
k2_kernel_sh27:
    s_cmp_lg_u32 s8, 1
    s_cbranch_scc1 k2_kernel_sh28
    v_mov_b32 v10, v106
    v_mov_b32 v11, v107
    s_branch k2_kernel_sh31
k2_kernel_sh28:
    s_cmp_lg_u32 s8, 2
    s_cbranch_scc1 k2_kernel_sh29
    v_mov_b32 v10, v108
    v_mov_b32 v11, v109
    s_branch k2_kernel_sh31
k2_kernel_sh29:
    v_mov_b32 v10, v110
    v_mov_b32 v11, v111
k2_kernel_sh31:
    s_lshl_b32 s40, s39, 10
    s_cmp_lt_u32 s39, 20
    s_cselect_b32 s40, s40, 0x40000000
    s_cmp_lt_u32 s46, 10
    s_cselect_b32 s40, s40, 0x40000000
    s_add_u32 s46, s46, 1
    buffer_load_dwordx4 v[72:75], v10, s[24:27], s40 offen
    buffer_load_dwordx4 v[76:79], v11, s[24:27], s40 offen
    s_add_u32 s39, s39, 1
    s_mul_i32 s8, s39, 52
    s_lshr_b32 s8, s8, 8
    s_cmp_lg_u32 s8, 0
    s_cbranch_scc1 k2_kernel_sh32
    v_mov_b32 v10, v104
    v_mov_b32 v11, v105
    s_branch k2_kernel_sh36
k2_kernel_sh32:
    s_cmp_lg_u32 s8, 1
    s_cbranch_scc1 k2_kernel_sh33
    v_mov_b32 v10, v106
    v_mov_b32 v11, v107
    s_branch k2_kernel_sh36
k2_kernel_sh33:
    s_cmp_lg_u32 s8, 2
    s_cbranch_scc1 k2_kernel_sh34
    v_mov_b32 v10, v108
    v_mov_b32 v11, v109
    s_branch k2_kernel_sh36
k2_kernel_sh34:
    v_mov_b32 v10, v110
    v_mov_b32 v11, v111
k2_kernel_sh36:
    s_lshl_b32 s40, s39, 10
    s_cmp_lt_u32 s39, 20
    s_cselect_b32 s40, s40, 0x40000000
    s_cmp_lt_u32 s46, 10
    s_cselect_b32 s40, s40, 0x40000000
    s_add_u32 s46, s46, 1
    buffer_load_dwordx4 v[80:83], v10, s[24:27], s40 offen
    buffer_load_dwordx4 v[84:87], v11, s[24:27], s40 offen
    s_add_u32 s39, s39, 3
    s_sub_u32 s8, s39, 20
    s_cmp_ge_u32 s39, 20
    s_cselect_b32 s39, s8, s39
    s_barrier
    s_mul_i32 s8, s39, 52
    s_lshr_b32 s8, s8, 8
    s_cmp_lg_u32 s8, 0
    s_cbranch_scc1 k2_kernel_sh37
    v_mov_b32 v10, v104
    v_mov_b32 v11, v105
    s_branch k2_kernel_sh41
k2_kernel_sh37:
    s_cmp_lg_u32 s8, 1
    s_cbranch_scc1 k2_kernel_sh38
    v_mov_b32 v10, v106
    v_mov_b32 v11, v107
    s_branch k2_kernel_sh41
k2_kernel_sh38:
    s_cmp_lg_u32 s8, 2
    s_cbranch_scc1 k2_kernel_sh39
    v_mov_b32 v10, v108
    v_mov_b32 v11, v109
    s_branch k2_kernel_sh41
k2_kernel_sh39:
    v_mov_b32 v10, v110
    v_mov_b32 v11, v111
k2_kernel_sh41:
    s_lshl_b32 s40, s39, 10
    s_cmp_lt_u32 s39, 20
    s_cselect_b32 s40, s40, 0x40000000
    s_cmp_lt_u32 s46, 10
    s_cselect_b32 s40, s40, 0x40000000
    s_add_u32 s46, s46, 1
    buffer_load_dwordx4 v[88:91], v10, s[24:27], s40 offen
    buffer_load_dwordx4 v[92:95], v11, s[24:27], s40 offen
    s_add_u32 s39, s39, 1
    s_mul_i32 s8, s39, 52
    s_lshr_b32 s8, s8, 8
    s_cmp_lg_u32 s8, 0
    s_cbranch_scc1 k2_kernel_sh42
    v_mov_b32 v10, v104
    v_mov_b32 v11, v105
    s_branch k2_kernel_sh46
k2_kernel_sh42:
    s_cmp_lg_u32 s8, 1
    s_cbranch_scc1 k2_kernel_sh43
    v_mov_b32 v10, v106
    v_mov_b32 v11, v107
    s_branch k2_kernel_sh46
k2_kernel_sh43:
    s_cmp_lg_u32 s8, 2
    s_cbranch_scc1 k2_kernel_sh44
    v_mov_b32 v10, v108
    v_mov_b32 v11, v109
    s_branch k2_kernel_sh46
k2_kernel_sh44:
    v_mov_b32 v10, v110
    v_mov_b32 v11, v111
k2_kernel_sh46:
    s_lshl_b32 s40, s39, 10
    s_cmp_lt_u32 s39, 20
    s_cselect_b32 s40, s40, 0x40000000
    s_cmp_lt_u32 s46, 10
    s_cselect_b32 s40, s40, 0x40000000
    s_add_u32 s46, s46, 1
    buffer_load_dwordx4 v[96:99], v10, s[24:27], s40 offen
    buffer_load_dwordx4 v[100:103], v11, s[24:27], s40 offen
    s_add_u32 s39, s39, 3
    s_sub_u32 s8, s39, 20
    s_cmp_ge_u32 s39, 20
    s_cselect_b32 s39, s8, s39
    ds_read_b128 v[52:55], v3 offset:0
    ds_read_b128 v[56:59], v3 offset:1024
    ds_read_b128 v[60:63], v3 offset:2048
    ds_read_b128 v[64:67], v3 offset:3072
    ds_read_b128 v[68:71], v3 offset:4096
    s_mov_b32 s36, 0
    s_mov_b32 s37, 0
    s_waitcnt vmcnt(6) lgkmcnt(4)
    v_mfma_f32_16x16x32_bf16 v[12:15], v[52:55], v[72:75], 0
    v_mfma_f32_16x16x32_bf16 v[32:35], v[52:55], v[76:79], 0
    s_waitcnt lgkmcnt(3)
    v_mfma_f32_16x16x32_bf16 v[16:19], v[56:59], v[72:75], 0
    ds_read_b128 v[52:55], v3 offset:5120
    v_mfma_f32_16x16x32_bf16 v[36:39], v[56:59], v[76:79], 0
    s_waitcnt lgkmcnt(3)
    v_mfma_f32_16x16x32_bf16 v[20:23], v[60:63], v[72:75], 0
    ds_read_b128 v[56:59], v3 offset:6144
    v_mfma_f32_16x16x32_bf16 v[40:43], v[60:63], v[76:79], 0
    s_waitcnt lgkmcnt(3)
    v_mfma_f32_16x16x32_bf16 v[24:27], v[64:67], v[72:75], 0
    ds_read_b128 v[60:63], v3 offset:7168
    v_mfma_f32_16x16x32_bf16 v[44:47], v[64:67], v[76:79], 0
    s_waitcnt lgkmcnt(3)
    v_mfma_f32_16x16x32_bf16 v[28:31], v[68:71], v[72:75], 0
    ds_read_b128 v[64:67], v3 offset:8192
    v_mfma_f32_16x16x32_bf16 v[48:51], v[68:71], v[76:79], 0
    ds_read_b128 v[68:71], v3 offset:9216
    s_mul_i32 s8, s39, 52
    s_lshr_b32 s8, s8, 8
    s_cmp_lg_u32 s8, 0
    s_cbranch_scc1 k2_kernel_sh50
    v_mov_b32 v10, v104
    v_mov_b32 v11, v105
    s_branch k2_kernel_sh54
k2_kernel_sh50:
    s_cmp_lg_u32 s8, 1
    s_cbranch_scc1 k2_kernel_sh51
    v_mov_b32 v10, v106
    v_mov_b32 v11, v107
    s_branch k2_kernel_sh54
k2_kernel_sh51:
    s_cmp_lg_u32 s8, 2
    s_cbranch_scc1 k2_kernel_sh52
    v_mov_b32 v10, v108
    v_mov_b32 v11, v109
    s_branch k2_kernel_sh54
k2_kernel_sh52:
    v_mov_b32 v10, v110
    v_mov_b32 v11, v111
k2_kernel_sh54:
    s_lshl_b32 s40, s39, 10
    s_cmp_lt_u32 s39, 20
    s_cselect_b32 s40, s40, 0x40000000
    s_cmp_lt_u32 s46, 10
    s_cselect_b32 s40, s40, 0x40000000
    s_add_u32 s46, s46, 1
    buffer_load_dwordx4 v[72:75], v10, s[24:27], s40 offen
    buffer_load_dwordx4 v[76:79], v11, s[24:27], s40 offen
    s_add_u32 s39, s39, 1
    s_add_u32 s37, s37, 1
    s_cmp_eq_u32 s37, 4
    s_mov_b32 s16, 20480
    s_cselect_b32 s16, 4294905856, s16
    s_cselect_b32 s37, 0, s37
    v_add_u32 v3, s16, v3
    s_barrier
    s_waitcnt vmcnt(6) lgkmcnt(4)
    v_mfma_f32_16x16x32_bf16 v[12:15], v[52:55], v[80:83], v[12:15]
    v_mfma_f32_16x16x32_bf16 v[32:35], v[52:55], v[84:87], v[32:35]
    s_waitcnt lgkmcnt(3)
    v_mfma_f32_16x16x32_bf16 v[16:19], v[56:59], v[80:83], v[16:19]
    ds_read_b128 v[52:55], v3 offset:0
    v_mfma_f32_16x16x32_bf16 v[36:39], v[56:59], v[84:87], v[36:39]
    s_waitcnt lgkmcnt(3)
    v_mfma_f32_16x16x32_bf16 v[20:23], v[60:63], v[80:83], v[20:23]
    ds_read_b128 v[56:59], v3 offset:1024
    v_mfma_f32_16x16x32_bf16 v[40:43], v[60:63], v[84:87], v[40:43]
    s_waitcnt lgkmcnt(3)
    v_mfma_f32_16x16x32_bf16 v[24:27], v[64:67], v[80:83], v[24:27]
    ds_read_b128 v[60:63], v3 offset:2048
    v_mfma_f32_16x16x32_bf16 v[44:47], v[64:67], v[84:87], v[44:47]
    s_waitcnt lgkmcnt(3)
    v_mfma_f32_16x16x32_bf16 v[28:31], v[68:71], v[80:83], v[28:31]
    ds_read_b128 v[64:67], v3 offset:3072
    v_mfma_f32_16x16x32_bf16 v[48:51], v[68:71], v[84:87], v[48:51]
    ds_read_b128 v[68:71], v3 offset:4096
    s_mul_i32 s8, s39, 52
    s_lshr_b32 s8, s8, 8
    s_cmp_lg_u32 s8, 0
    s_cbranch_scc1 k2_kernel_sh55
    v_mov_b32 v10, v104
    v_mov_b32 v11, v105
    s_branch k2_kernel_sh59
k2_kernel_sh55:
    s_cmp_lg_u32 s8, 1
    s_cbranch_scc1 k2_kernel_sh56
    v_mov_b32 v10, v106
    v_mov_b32 v11, v107
    s_branch k2_kernel_sh59
k2_kernel_sh56:
    s_cmp_lg_u32 s8, 2
    s_cbranch_scc1 k2_kernel_sh57
    v_mov_b32 v10, v108
    v_mov_b32 v11, v109
    s_branch k2_kernel_sh59
k2_kernel_sh57:
    v_mov_b32 v10, v110
    v_mov_b32 v11, v111
k2_kernel_sh59:
    s_lshl_b32 s40, s39, 10
    s_cmp_lt_u32 s39, 20
    s_cselect_b32 s40, s40, 0x40000000
    s_cmp_lt_u32 s46, 10
    s_cselect_b32 s40, s40, 0x40000000
    s_add_u32 s46, s46, 1
    buffer_load_dwordx4 v[80:83], v10, s[24:27], s40 offen
    buffer_load_dwordx4 v[84:87], v11, s[24:27], s40 offen
    s_add_u32 s39, s39, 3
    s_sub_u32 s8, s39, 20
    s_cmp_ge_u32 s39, 20
    s_cselect_b32 s39, s8, s39
    s_mov_b32 s32, s12
    s_mov_b32 s33, s13
    s_mov_b32 s34, 2621440
    s_mov_b32 s35, 0x20000
    s_lshl_b32 s8, s47, 4
    v_add_u32 v4, s8, v1
    v_mul_u32_u24 v4, 1280, v4
    v_lshl_add_u32 v4, v2, 3, v4
    s_lshl_b32 s8, s45, 5
    buffer_load_dwordx2 v[112:113], v4, s[32:35], s8 offen offset:0
    buffer_load_dwordx2 v[114:115], v4, s[32:35], s8 offen offset:32
    buffer_load_dwordx2 v[116:117], v4, s[32:35], s8 offen offset:64
    buffer_load_dwordx2 v[118:119], v4, s[32:35], s8 offen offset:96
    buffer_load_dwordx2 v[120:121], v4, s[32:35], s8 offen offset:128
    s_add_u32 s36, s36, 1
.p2align 6
k2_kernel_gloop47:
    s_waitcnt vmcnt(6) lgkmcnt(4)
    v_mfma_f32_16x16x32_bf16 v[12:15], v[52:55], v[88:91], v[12:15]
    v_mfma_f32_16x16x32_bf16 v[32:35], v[52:55], v[92:95], v[32:35]
    s_waitcnt lgkmcnt(3)
    v_mfma_f32_16x16x32_bf16 v[16:19], v[56:59], v[88:91], v[16:19]
    ds_read_b128 v[52:55], v3 offset:5120
    v_mfma_f32_16x16x32_bf16 v[36:39], v[56:59], v[92:95], v[36:39]
    s_waitcnt lgkmcnt(3)
    v_mfma_f32_16x16x32_bf16 v[20:23], v[60:63], v[88:91], v[20:23]
    ds_read_b128 v[56:59], v3 offset:6144
    v_mfma_f32_16x16x32_bf16 v[40:43], v[60:63], v[92:95], v[40:43]
    s_waitcnt lgkmcnt(3)
    v_mfma_f32_16x16x32_bf16 v[24:27], v[64:67], v[88:91], v[24:27]
    ds_read_b128 v[60:63], v3 offset:7168
    v_mfma_f32_16x16x32_bf16 v[44:47], v[64:67], v[92:95], v[44:47]
    s_waitcnt lgkmcnt(3)
    v_mfma_f32_16x16x32_bf16 v[28:31], v[68:71], v[88:91], v[28:31]
    ds_read_b128 v[64:67], v3 offset:8192
    v_mfma_f32_16x16x32_bf16 v[48:51], v[68:71], v[92:95], v[48:51]
    ds_read_b128 v[68:71], v3 offset:9216
    s_mul_i32 s8, s39, 52
    s_lshr_b32 s8, s8, 8
    s_cmp_lg_u32 s8, 0
    s_cbranch_scc1 k2_kernel_sh60
    v_mov_b32 v10, v104
    v_mov_b32 v11, v105
    s_branch k2_kernel_sh64
k2_kernel_sh60:
    s_cmp_lg_u32 s8, 1
    s_cbranch_scc1 k2_kernel_sh61
    v_mov_b32 v10, v106
    v_mov_b32 v11, v107
    s_branch k2_kernel_sh64
k2_kernel_sh61:
    s_cmp_lg_u32 s8, 2
    s_cbranch_scc1 k2_kernel_sh62
    v_mov_b32 v10, v108
    v_mov_b32 v11, v109
    s_branch k2_kernel_sh64
k2_kernel_sh62:
    v_mov_b32 v10, v110
    v_mov_b32 v11, v111
k2_kernel_sh64:
    s_lshl_b32 s40, s39, 10
    s_cmp_lt_u32 s39, 20
    s_cselect_b32 s40, s40, 0x40000000
    s_cmp_lt_u32 s46, 10
    s_cselect_b32 s40, s40, 0x40000000
    s_add_u32 s46, s46, 1
    buffer_load_dwordx4 v[88:91], v10, s[24:27], s40 offen
    buffer_load_dwordx4 v[92:95], v11, s[24:27], s40 offen
    s_add_u32 s39, s39, 1
    s_add_u32 s37, s37, 1
    s_cmp_eq_u32 s37, 4
    s_mov_b32 s16, 20480
    s_cselect_b32 s16, 4294905856, s16
    s_cselect_b32 s37, 0, s37
    v_add_u32 v3, s16, v3
    s_barrier
    s_waitcnt vmcnt(6) lgkmcnt(4)
    v_mfma_f32_16x16x32_bf16 v[12:15], v[52:55], v[96:99], v[12:15]
    v_mfma_f32_16x16x32_bf16 v[32:35], v[52:55], v[100:103], v[32:35]
    s_waitcnt lgkmcnt(3)
    v_mfma_f32_16x16x32_bf16 v[16:19], v[56:59], v[96:99], v[16:19]
    ds_read_b128 v[52:55], v3 offset:0
    v_mfma_f32_16x16x32_bf16 v[36:39], v[56:59], v[100:103], v[36:39]
    s_waitcnt lgkmcnt(3)
    v_mfma_f32_16x16x32_bf16 v[20:23], v[60:63], v[96:99], v[20:23]
    ds_read_b128 v[56:59], v3 offset:1024
    v_mfma_f32_16x16x32_bf16 v[40:43], v[60:63], v[100:103], v[40:43]
    s_waitcnt lgkmcnt(3)
    v_mfma_f32_16x16x32_bf16 v[24:27], v[64:67], v[96:99], v[24:27]
    ds_read_b128 v[60:63], v3 offset:2048
    v_mfma_f32_16x16x32_bf16 v[44:47], v[64:67], v[100:103], v[44:47]
    s_waitcnt lgkmcnt(3)
    v_mfma_f32_16x16x32_bf16 v[28:31], v[68:71], v[96:99], v[28:31]
    ds_read_b128 v[64:67], v3 offset:3072
    v_mfma_f32_16x16x32_bf16 v[48:51], v[68:71], v[100:103], v[48:51]
    ds_read_b128 v[68:71], v3 offset:4096
    s_mul_i32 s8, s39, 52
    s_lshr_b32 s8, s8, 8
    s_cmp_lg_u32 s8, 0
    s_cbranch_scc1 k2_kernel_sh65
    v_mov_b32 v10, v104
    v_mov_b32 v11, v105
    s_branch k2_kernel_sh69
k2_kernel_sh65:
    s_cmp_lg_u32 s8, 1
    s_cbranch_scc1 k2_kernel_sh66
    v_mov_b32 v10, v106
    v_mov_b32 v11, v107
    s_branch k2_kernel_sh69
k2_kernel_sh66:
    s_cmp_lg_u32 s8, 2
    s_cbranch_scc1 k2_kernel_sh67
    v_mov_b32 v10, v108
    v_mov_b32 v11, v109
    s_branch k2_kernel_sh69
k2_kernel_sh67:
    v_mov_b32 v10, v110
    v_mov_b32 v11, v111
k2_kernel_sh69:
    s_lshl_b32 s40, s39, 10
    s_cmp_lt_u32 s39, 20
    s_cselect_b32 s40, s40, 0x40000000
    s_cmp_lt_u32 s46, 10
    s_cselect_b32 s40, s40, 0x40000000
    s_add_u32 s46, s46, 1
    buffer_load_dwordx4 v[96:99], v10, s[24:27], s40 offen
    buffer_load_dwordx4 v[100:103], v11, s[24:27], s40 offen
    s_add_u32 s39, s39, 3
    s_sub_u32 s8, s39, 20
    s_cmp_ge_u32 s39, 20
    s_cselect_b32 s39, s8, s39
    s_add_u32 s36, s36, 1
    s_cmp_lt_u32 s36, 4
    s_cbranch_scc0 k2_kernel_gexit48
    s_waitcnt vmcnt(6) lgkmcnt(4)
    v_mfma_f32_16x16x32_bf16 v[12:15], v[52:55], v[72:75], v[12:15]
    v_mfma_f32_16x16x32_bf16 v[32:35], v[52:55], v[76:79], v[32:35]
    s_waitcnt lgkmcnt(3)
    v_mfma_f32_16x16x32_bf16 v[16:19], v[56:59], v[72:75], v[16:19]
    ds_read_b128 v[52:55], v3 offset:5120
    v_mfma_f32_16x16x32_bf16 v[36:39], v[56:59], v[76:79], v[36:39]
    s_waitcnt lgkmcnt(3)
    v_mfma_f32_16x16x32_bf16 v[20:23], v[60:63], v[72:75], v[20:23]
    ds_read_b128 v[56:59], v3 offset:6144
    v_mfma_f32_16x16x32_bf16 v[40:43], v[60:63], v[76:79], v[40:43]
    s_waitcnt lgkmcnt(3)
    v_mfma_f32_16x16x32_bf16 v[24:27], v[64:67], v[72:75], v[24:27]
    ds_read_b128 v[60:63], v3 offset:7168
    v_mfma_f32_16x16x32_bf16 v[44:47], v[64:67], v[76:79], v[44:47]
    s_waitcnt lgkmcnt(3)
    v_mfma_f32_16x16x32_bf16 v[28:31], v[68:71], v[72:75], v[28:31]
    ds_read_b128 v[64:67], v3 offset:8192
    v_mfma_f32_16x16x32_bf16 v[48:51], v[68:71], v[76:79], v[48:51]
    ds_read_b128 v[68:71], v3 offset:9216
    s_mul_i32 s8, s39, 52
    s_lshr_b32 s8, s8, 8
    s_cmp_lg_u32 s8, 0
    s_cbranch_scc1 k2_kernel_sh70
    v_mov_b32 v10, v104
    v_mov_b32 v11, v105
    s_branch k2_kernel_sh74
k2_kernel_sh70:
    s_cmp_lg_u32 s8, 1
    s_cbranch_scc1 k2_kernel_sh71
    v_mov_b32 v10, v106
    v_mov_b32 v11, v107
    s_branch k2_kernel_sh74
k2_kernel_sh71:
    s_cmp_lg_u32 s8, 2
    s_cbranch_scc1 k2_kernel_sh72
    v_mov_b32 v10, v108
    v_mov_b32 v11, v109
    s_branch k2_kernel_sh74
k2_kernel_sh72:
    v_mov_b32 v10, v110
    v_mov_b32 v11, v111
k2_kernel_sh74:
    s_lshl_b32 s40, s39, 10
    s_cmp_lt_u32 s39, 20
    s_cselect_b32 s40, s40, 0x40000000
    s_cmp_lt_u32 s46, 10
    s_cselect_b32 s40, s40, 0x40000000
    s_add_u32 s46, s46, 1
    buffer_load_dwordx4 v[72:75], v10, s[24:27], s40 offen
    buffer_load_dwordx4 v[76:79], v11, s[24:27], s40 offen
    s_add_u32 s39, s39, 1
    s_add_u32 s37, s37, 1
    s_cmp_eq_u32 s37, 4
    s_mov_b32 s16, 20480
    s_cselect_b32 s16, 4294905856, s16
    s_cselect_b32 s37, 0, s37
    v_add_u32 v3, s16, v3
    s_barrier
    s_waitcnt vmcnt(6) lgkmcnt(4)
    v_mfma_f32_16x16x32_bf16 v[12:15], v[52:55], v[80:83], v[12:15]
    v_mfma_f32_16x16x32_bf16 v[32:35], v[52:55], v[84:87], v[32:35]
    s_waitcnt lgkmcnt(3)
    v_mfma_f32_16x16x32_bf16 v[16:19], v[56:59], v[80:83], v[16:19]
    ds_read_b128 v[52:55], v3 offset:0
    v_mfma_f32_16x16x32_bf16 v[36:39], v[56:59], v[84:87], v[36:39]
    s_waitcnt lgkmcnt(3)
    v_mfma_f32_16x16x32_bf16 v[20:23], v[60:63], v[80:83], v[20:23]
    ds_read_b128 v[56:59], v3 offset:1024
    v_mfma_f32_16x16x32_bf16 v[40:43], v[60:63], v[84:87], v[40:43]
    s_waitcnt lgkmcnt(3)
    v_mfma_f32_16x16x32_bf16 v[24:27], v[64:67], v[80:83], v[24:27]
    ds_read_b128 v[60:63], v3 offset:2048
    v_mfma_f32_16x16x32_bf16 v[44:47], v[64:67], v[84:87], v[44:47]
    s_waitcnt lgkmcnt(3)
    v_mfma_f32_16x16x32_bf16 v[28:31], v[68:71], v[80:83], v[28:31]
    ds_read_b128 v[64:67], v3 offset:3072
    v_mfma_f32_16x16x32_bf16 v[48:51], v[68:71], v[84:87], v[48:51]
    ds_read_b128 v[68:71], v3 offset:4096
    s_mul_i32 s8, s39, 52
    s_lshr_b32 s8, s8, 8
    s_cmp_lg_u32 s8, 0
    s_cbranch_scc1 k2_kernel_sh75
    v_mov_b32 v10, v104
    v_mov_b32 v11, v105
    s_branch k2_kernel_sh79
k2_kernel_sh75:
    s_cmp_lg_u32 s8, 1
    s_cbranch_scc1 k2_kernel_sh76
    v_mov_b32 v10, v106
    v_mov_b32 v11, v107
    s_branch k2_kernel_sh79
k2_kernel_sh76:
    s_cmp_lg_u32 s8, 2
    s_cbranch_scc1 k2_kernel_sh77
    v_mov_b32 v10, v108
    v_mov_b32 v11, v109
    s_branch k2_kernel_sh79
k2_kernel_sh77:
    v_mov_b32 v10, v110
    v_mov_b32 v11, v111
k2_kernel_sh79:
    s_lshl_b32 s40, s39, 10
    s_cmp_lt_u32 s39, 20
    s_cselect_b32 s40, s40, 0x40000000
    s_cmp_lt_u32 s46, 10
    s_cselect_b32 s40, s40, 0x40000000
    s_add_u32 s46, s46, 1
    buffer_load_dwordx4 v[80:83], v10, s[24:27], s40 offen
    buffer_load_dwordx4 v[84:87], v11, s[24:27], s40 offen
    s_add_u32 s39, s39, 3
    s_sub_u32 s8, s39, 20
    s_cmp_ge_u32 s39, 20
    s_cselect_b32 s39, s8, s39
    s_add_u32 s36, s36, 1
    s_cmp_lt_u32 s36, 4
    s_cbranch_scc1 k2_kernel_gloop47
k2_kernel_gexit48:
    s_waitcnt vmcnt(6) lgkmcnt(4)
    v_mfma_f32_16x16x32_bf16 v[12:15], v[52:55], v[72:75], v[12:15]
    v_mfma_f32_16x16x32_bf16 v[32:35], v[52:55], v[76:79], v[32:35]
    s_waitcnt lgkmcnt(3)
    v_mfma_f32_16x16x32_bf16 v[16:19], v[56:59], v[72:75], v[16:19]
    ds_read_b128 v[52:55], v3 offset:5120
    v_mfma_f32_16x16x32_bf16 v[36:39], v[56:59], v[76:79], v[36:39]
    s_waitcnt lgkmcnt(3)
    v_mfma_f32_16x16x32_bf16 v[20:23], v[60:63], v[72:75], v[20:23]
    ds_read_b128 v[56:59], v3 offset:6144
    v_mfma_f32_16x16x32_bf16 v[40:43], v[60:63], v[76:79], v[40:43]
    s_waitcnt lgkmcnt(3)
    v_mfma_f32_16x16x32_bf16 v[24:27], v[64:67], v[72:75], v[24:27]
    ds_read_b128 v[60:63], v3 offset:7168
    v_mfma_f32_16x16x32_bf16 v[44:47], v[64:67], v[76:79], v[44:47]
    s_waitcnt lgkmcnt(3)
    v_mfma_f32_16x16x32_bf16 v[28:31], v[68:71], v[72:75], v[28:31]
    ds_read_b128 v[64:67], v3 offset:8192
    v_mfma_f32_16x16x32_bf16 v[48:51], v[68:71], v[76:79], v[48:51]
    ds_read_b128 v[68:71], v3 offset:9216
    s_mul_i32 s8, s39, 52
    s_lshr_b32 s8, s8, 8
    s_cmp_lg_u32 s8, 0
    s_cbranch_scc1 k2_kernel_sh80
    v_mov_b32 v10, v104
    v_mov_b32 v11, v105
    s_branch k2_kernel_sh84
k2_kernel_sh80:
    s_cmp_lg_u32 s8, 1
    s_cbranch_scc1 k2_kernel_sh81
    v_mov_b32 v10, v106
    v_mov_b32 v11, v107
    s_branch k2_kernel_sh84
k2_kernel_sh81:
    s_cmp_lg_u32 s8, 2
    s_cbranch_scc1 k2_kernel_sh82
    v_mov_b32 v10, v108
    v_mov_b32 v11, v109
    s_branch k2_kernel_sh84
k2_kernel_sh82:
    v_mov_b32 v10, v110
    v_mov_b32 v11, v111
k2_kernel_sh84:
    s_lshl_b32 s40, s39, 10
    s_cmp_lt_u32 s39, 20
    s_cselect_b32 s40, s40, 0x40000000
    s_cmp_lt_u32 s46, 10
    s_cselect_b32 s40, s40, 0x40000000
    s_add_u32 s46, s46, 1
    buffer_load_dwordx4 v[72:75], v10, s[24:27], s40 offen
    buffer_load_dwordx4 v[76:79], v11, s[24:27], s40 offen
    s_add_u32 s39, s39, 1
    s_waitcnt vmcnt(6) lgkmcnt(4)
    v_mfma_f32_16x16x32_bf16 v[12:15], v[52:55], v[80:83], v[12:15]
    v_mfma_f32_16x16x32_bf16 v[32:35], v[52:55], v[84:87], v[32:35]
    s_waitcnt lgkmcnt(3)
    v_mfma_f32_16x16x32_bf16 v[16:19], v[56:59], v[80:83], v[16:19]
    v_mfma_f32_16x16x32_bf16 v[36:39], v[56:59], v[84:87], v[36:39]
    s_waitcnt lgkmcnt(2)
    v_mfma_f32_16x16x32_bf16 v[20:23], v[60:63], v[80:83], v[20:23]
    v_mfma_f32_16x16x32_bf16 v[40:43], v[60:63], v[84:87], v[40:43]
    s_waitcnt lgkmcnt(1)
    v_mfma_f32_16x16x32_bf16 v[24:27], v[64:67], v[80:83], v[24:27]
    v_mfma_f32_16x16x32_bf16 v[44:47], v[64:67], v[84:87], v[44:47]
    s_waitcnt lgkmcnt(0)
    v_mfma_f32_16x16x32_bf16 v[28:31], v[68:71], v[80:83], v[28:31]
    v_mfma_f32_16x16x32_bf16 v[48:51], v[68:71], v[84:87], v[48:51]
    s_nop 7
    s_xor_b32 s8, s3, 1
    s_mul_i32 s8, s8, 5120
    s_add_u32 s8, s8, 40960
    v_lshlrev_b32 v8, 4, v0
    v_add_u32 v9, s8, v8
    ds_write_b128 v9, v[32:35] offset:0
    ds_write_b128 v9, v[36:39] offset:1024
    ds_write_b128 v9, v[40:43] offset:2048
    ds_write_b128 v9, v[44:47] offset:3072
    ds_write_b128 v9, v[48:51] offset:4096
    s_mul_i32 s8, s3, 5120
    s_add_u32 s8, s8, 40960
    s_waitcnt lgkmcnt(0)
    s_barrier
    v_add_u32 v9, s8, v8
    ds_read_b128 v[32:35], v9 offset:0
    ds_read_b128 v[36:39], v9 offset:1024
    ds_read_b128 v[40:43], v9 offset:2048
    ds_read_b128 v[44:47], v9 offset:3072
    ds_read_b128 v[48:51], v9 offset:4096
    s_waitcnt vmcnt(0) lgkmcnt(0)
    v_pk_add_f32 v[12:13], v[12:13], v[32:33]
    v_pk_add_f32 v[14:15], v[14:15], v[34:35]
    v_pk_add_f32 v[16:17], v[16:17], v[36:37]
    v_pk_add_f32 v[18:19], v[18:19], v[38:39]
    v_pk_add_f32 v[20:21], v[20:21], v[40:41]
    v_pk_add_f32 v[22:23], v[22:23], v[42:43]
    v_pk_add_f32 v[24:25], v[24:25], v[44:45]
    v_pk_add_f32 v[26:27], v[26:27], v[46:47]
    v_pk_add_f32 v[28:29], v[28:29], v[48:49]
    v_pk_add_f32 v[30:31], v[30:31], v[50:51]
    v_cvt_pk_bf16_f32 v4, v12, v13
    v_cvt_pk_bf16_f32 v5, v14, v15
    v_lshlrev_b32 v12, 16, v4
    v_and_b32 v13, 0xffff0000, v4
    v_lshlrev_b32 v14, 16, v5
    v_and_b32 v15, 0xffff0000, v5
    v_lshlrev_b32 v64, 16, v112
    v_and_b32 v65, 0xffff0000, v112
    v_lshlrev_b32 v66, 16, v113
    v_and_b32 v67, 0xffff0000, v113
    v_pk_add_f32 v[12:13], v[12:13], v[64:65]
    v_pk_add_f32 v[14:15], v[14:15], v[66:67]
    v_cvt_pk_bf16_f32 v52, v12, v13
    v_cvt_pk_bf16_f32 v53, v14, v15
    v_cvt_pk_bf16_f32 v4, v16, v17
    v_cvt_pk_bf16_f32 v5, v18, v19
    v_lshlrev_b32 v16, 16, v4
    v_and_b32 v17, 0xffff0000, v4
    v_lshlrev_b32 v18, 16, v5
    v_and_b32 v19, 0xffff0000, v5
    v_lshlrev_b32 v64, 16, v114
    v_and_b32 v65, 0xffff0000, v114
    v_lshlrev_b32 v66, 16, v115
    v_and_b32 v67, 0xffff0000, v115
    v_pk_add_f32 v[16:17], v[16:17], v[64:65]
    v_pk_add_f32 v[18:19], v[18:19], v[66:67]
    v_cvt_pk_bf16_f32 v54, v16, v17
    v_cvt_pk_bf16_f32 v55, v18, v19
    v_cvt_pk_bf16_f32 v4, v20, v21
    v_cvt_pk_bf16_f32 v5, v22, v23
    v_lshlrev_b32 v20, 16, v4
    v_and_b32 v21, 0xffff0000, v4
    v_lshlrev_b32 v22, 16, v5
    v_and_b32 v23, 0xffff0000, v5
    v_lshlrev_b32 v64, 16, v116
    v_and_b32 v65, 0xffff0000, v116
    v_lshlrev_b32 v66, 16, v117
    v_and_b32 v67, 0xffff0000, v117
    v_pk_add_f32 v[20:21], v[20:21], v[64:65]
    v_pk_add_f32 v[22:23], v[22:23], v[66:67]
    v_cvt_pk_bf16_f32 v56, v20, v21
    v_cvt_pk_bf16_f32 v57, v22, v23
    v_cvt_pk_bf16_f32 v4, v24, v25
    v_cvt_pk_bf16_f32 v5, v26, v27
    v_lshlrev_b32 v24, 16, v4
    v_and_b32 v25, 0xffff0000, v4
    v_lshlrev_b32 v26, 16, v5
    v_and_b32 v27, 0xffff0000, v5
    v_lshlrev_b32 v64, 16, v118
    v_and_b32 v65, 0xffff0000, v118
    v_lshlrev_b32 v66, 16, v119
    v_and_b32 v67, 0xffff0000, v119
    v_pk_add_f32 v[24:25], v[24:25], v[64:65]
    v_pk_add_f32 v[26:27], v[26:27], v[66:67]
    v_cvt_pk_bf16_f32 v58, v24, v25
    v_cvt_pk_bf16_f32 v59, v26, v27
    v_cvt_pk_bf16_f32 v4, v28, v29
    v_cvt_pk_bf16_f32 v5, v30, v31
    v_lshlrev_b32 v28, 16, v4
    v_and_b32 v29, 0xffff0000, v4
    v_lshlrev_b32 v30, 16, v5
    v_and_b32 v31, 0xffff0000, v5
    v_lshlrev_b32 v64, 16, v120
    v_and_b32 v65, 0xffff0000, v120
    v_lshlrev_b32 v66, 16, v121
    v_and_b32 v67, 0xffff0000, v121
    v_pk_add_f32 v[28:29], v[28:29], v[64:65]
    v_pk_add_f32 v[30:31], v[30:31], v[66:67]
    v_cvt_pk_bf16_f32 v60, v28, v29
    v_cvt_pk_bf16_f32 v61, v30, v31
    v_mov_b32 v68, 0
    v_mov_b32 v69, 0
    v_mov_b32 v70, 0x3f803f80
    s_nop 0
    v_dot2c_f32_bf16 v68, v52, v70
    v_dot2c_f32_bf16 v69, v52, v52
    v_dot2c_f32_bf16 v68, v53, v70
    v_dot2c_f32_bf16 v69, v53, v53
    v_dot2c_f32_bf16 v68, v54, v70
    v_dot2c_f32_bf16 v69, v54, v54
    v_dot2c_f32_bf16 v68, v55, v70
    v_dot2c_f32_bf16 v69, v55, v55
    v_dot2c_f32_bf16 v68, v56, v70
    v_dot2c_f32_bf16 v69, v56, v56
    v_dot2c_f32_bf16 v68, v57, v70
    v_dot2c_f32_bf16 v69, v57, v57
    v_dot2c_f32_bf16 v68, v58, v70
    v_dot2c_f32_bf16 v69, v58, v58
    v_dot2c_f32_bf16 v68, v59, v70
    v_dot2c_f32_bf16 v69, v59, v59
    v_dot2c_f32_bf16 v68, v60, v70
    v_dot2c_f32_bf16 v69, v60, v60
    v_dot2c_f32_bf16 v68, v61, v70
    v_dot2c_f32_bf16 v69, v61, v61
    s_nop 3
    v_mov_b32 v4, v68
    v_mov_b32 v5, v68
    s_nop 1
    v_permlane32_swap_b32 v4, v5
    s_nop 1
    v_add_f32 v68, v4, v5
    v_mov_b32 v4, v68
    v_mov_b32 v5, v68
    s_nop 1
    v_permlane16_swap_b32 v4, v5
    s_nop 1
    v_add_f32 v68, v4, v5
    v_mov_b32 v4, v69
    v_mov_b32 v5, v69
    s_nop 1
    v_permlane32_swap_b32 v4, v5
    s_nop 1
    v_add_f32 v69, v4, v5
    v_mov_b32 v4, v69
    v_mov_b32 v5, v69
    s_nop 1
    v_permlane16_swap_b32 v4, v5
    s_nop 1
    v_add_f32 v69, v4, v5
    s_lshl_b32 s8, s47, 10
    s_lshl_b32 s16, s5, 3
    s_add_u32 s8, s8, s16
    s_add_u32 s8, s8, 8053760
    v_lshlrev_b32 v4, 6, v1
    s_mov_b64 exec, 0xffff
    buffer_store_dwordx2 v[68:69], v4, s[28:31], s8 offen sc1
    s_mov_b64 exec, -1
    s_mul_i32 s8, s47, 20480
    s_lshl_b32 s17, s45, 9
    s_add_u32 s8, s8, s17
    s_add_u32 s8, s8, 5432320
    s_nop 1
    v_lshrrev_b32 v4, 1, v2
    v_and_b32 v5, 1, v2
    v_lshlrev_b32 v4, 8, v4
    v_lshl_add_u32 v4, v1, 4, v4
    v_permlane16_swap_b32 v52, v54
    v_permlane16_swap_b32 v53, v55
    v_permlane16_swap_b32 v56, v58
    v_permlane16_swap_b32 v57, v59
    v_lshl_add_u32 v6, v5, 9, v4
    v_lshl_add_u32 v7, v5, 3, v4
    buffer_store_dwordx4 v[52:55], v6, s[28:31], s8 offen offset:0 sc1
    buffer_store_dwordx4 v[56:59], v6, s[28:31], s8 offen offset:1024 sc1
    buffer_store_dwordx2 v[60:61], v7, s[28:31], s8 offen offset:2048 sc1
    s_branch k2_kernel_join25
k2_kernel_ldr24:
    s_cmp_eq_u32 s3, 5
    s_cbranch_scc1 k2_kernel_l86
    s_cmp_eq_u32 s3, 6
    s_cbranch_scc1 k2_kernel_l87
    s_cmp_eq_u32 s3, 7
    s_cbranch_scc1 k2_kernel_l88
k2_kernel_l85:
    v_lshlrev_b32 v10, 4, v0
    s_waitcnt lgkmcnt(0)
    s_mov_b32 s39, 0
    s_mul_i32 s40, s5, 102400
    s_add_u32 s40, s40, 0
    s_mul_i32 s38, s39, 20480
    s_add_u32 s38, s38, s40
    s_add_u32 s20, s10, 20513792
    s_addc_u32 s21, s11, 0
    s_mov_b32 s22, 819200
    s_mov_b32 s23, 0x20000
    v_lshlrev_b32 v11, 7, v0
    s_mov_b32 s28, s10
    s_mov_b32 s29, s11
    s_mov_b32 s30, 29815808
    s_mov_b32 s31, 0x20000
    s_mov_b32 m0, 0
    s_nop 0
    buffer_load_dwordx4 v10, s[20:23], s38 offen offset:0 lds
    buffer_load_dwordx4 v10, s[20:23], s38 offen offset:1024 lds
    buffer_load_dwordx4 v10, s[20:23], s38 offen offset:2048 lds
    buffer_load_dwordx4 v10, s[20:23], s38 offen offset:3072 lds
    s_mov_b32 m0, 4096
    s_add_u32 s8, s38, 4096
    buffer_load_dwordx4 v10, s[20:23], s8 offen offset:0 lds
    s_add_u32 s38, s38, 20480
    s_add_u32 s39, s39, 1
    s_cmp_eq_u32 s39, 5
    s_cselect_b32 s38, s40, s38
    s_cselect_b32 s39, 0, s39
    s_mov_b32 m0, 20480
    s_nop 0
    buffer_load_dwordx4 v10, s[20:23], s38 offen offset:0 lds
    buffer_load_dwordx4 v10, s[20:23], s38 offen offset:1024 lds
    buffer_load_dwordx4 v10, s[20:23], s38 offen offset:2048 lds
    buffer_load_dwordx4 v10, s[20:23], s38 offen offset:3072 lds
    s_mov_b32 m0, 24576
    s_add_u32 s8, s38, 4096
    buffer_load_dwordx4 v10, s[20:23], s8 offen offset:0 lds
    s_add_u32 s38, s38, 20480
    s_add_u32 s39, s39, 1
    s_cmp_eq_u32 s39, 5
    s_cselect_b32 s38, s40, s38
    s_cselect_b32 s39, 0, s39
    s_waitcnt vmcnt(5)
    s_barrier
    s_mov_b32 m0, 40960
    s_nop 0
    buffer_load_dwordx4 v10, s[20:23], s38 offen offset:0 lds
    buffer_load_dwordx4 v10, s[20:23], s38 offen offset:1024 lds
    buffer_load_dwordx4 v10, s[20:23], s38 offen offset:2048 lds
    buffer_load_dwordx4 v10, s[20:23], s38 offen offset:3072 lds
    s_mov_b32 m0, 45056
    s_add_u32 s8, s38, 4096
    buffer_load_dwordx4 v10, s[20:23], s8 offen offset:0 lds
    s_add_u32 s38, s38, 20480
    s_add_u32 s39, s39, 1
    s_cmp_eq_u32 s39, 5
    s_cselect_b32 s38, s40, s38
    s_cselect_b32 s39, 0, s39
    s_mov_b32 m0, 61440
    s_nop 0
    buffer_load_dwordx4 v10, s[20:23], s38 offen offset:0 lds
    buffer_load_dwordx4 v10, s[20:23], s38 offen offset:1024 lds
    buffer_load_dwordx4 v10, s[20:23], s38 offen offset:2048 lds
    buffer_load_dwordx4 v10, s[20:23], s38 offen offset:3072 lds
    s_mov_b32 m0, 65536
    s_add_u32 s8, s38, 4096
    buffer_load_dwordx4 v10, s[20:23], s8 offen offset:0 lds
    s_add_u32 s38, s38, 20480
    s_add_u32 s39, s39, 1
    s_cmp_eq_u32 s39, 5
    s_cselect_b32 s38, s40, s38
    s_cselect_b32 s39, 0, s39
    s_waitcnt vmcnt(10)
    s_barrier
    s_mov_b32 s37, 0
    s_mov_b32 s46, 40960
    s_mov_b32 s36, 2
k2_kernel_ll90:
    s_waitcnt vmcnt(5)
    s_barrier
    s_add_u32 m0, s37, 0
    s_nop 0
    buffer_load_dwordx4 v10, s[20:23], s38 offen offset:0 lds
    buffer_load_dwordx4 v10, s[20:23], s38 offen offset:1024 lds
    buffer_load_dwordx4 v10, s[20:23], s38 offen offset:2048 lds
    buffer_load_dwordx4 v10, s[20:23], s38 offen offset:3072 lds
    s_add_u32 m0, s37, 4096
    s_add_u32 s8, s38, 4096
    buffer_load_dwordx4 v10, s[20:23], s8 offen offset:0 lds
    s_add_u32 s38, s38, 20480
    s_add_u32 s39, s39, 1
    s_cmp_eq_u32 s39, 5
    s_cselect_b32 s38, s40, s38
    s_cselect_b32 s39, 0, s39
    s_add_u32 s37, s37, 20480
    s_cmp_eq_u32 s37, 81920
    s_cselect_b32 s37, 0, s37
    s_add_u32 s36, s36, 1
    s_cmp_le_u32 s36, 2
    s_cbranch_scc1 k2_kernel_ll90
    s_waitcnt vmcnt(5)
    s_barrier
    s_waitcnt vmcnt(0)
    s_barrier
    s_branch k2_kernel_lfin89
k2_kernel_l86:
    v_lshlrev_b32 v10, 4, v0
    s_waitcnt lgkmcnt(0)
    s_mov_b32 s39, 0
    s_mul_i32 s40, s5, 102400
    s_add_u32 s40, s40, 5120
    s_mul_i32 s38, s39, 20480
    s_add_u32 s38, s38, s40
    s_add_u32 s20, s10, 20513792
    s_addc_u32 s21, s11, 0
    s_mov_b32 s22, 819200
    s_mov_b32 s23, 0x20000
    v_lshlrev_b32 v11, 7, v0
    s_mov_b32 s28, s10
    s_mov_b32 s29, s11
    s_mov_b32 s30, 29815808
    s_mov_b32 s31, 0x20000
    s_mov_b32 m0, 5120
    s_nop 0
    buffer_load_dwordx4 v10, s[20:23], s38 offen offset:0 lds
    buffer_load_dwordx4 v10, s[20:23], s38 offen offset:1024 lds
    buffer_load_dwordx4 v10, s[20:23], s38 offen offset:2048 lds
    buffer_load_dwordx4 v10, s[20:23], s38 offen offset:3072 lds
    s_mov_b32 m0, 9216
    s_add_u32 s8, s38, 4096
    buffer_load_dwordx4 v10, s[20:23], s8 offen offset:0 lds
    s_add_u32 s38, s38, 20480
    s_add_u32 s39, s39, 1
    s_cmp_eq_u32 s39, 5
    s_cselect_b32 s38, s40, s38
    s_cselect_b32 s39, 0, s39
    s_mov_b32 m0, 25600
    s_nop 0
    buffer_load_dwordx4 v10, s[20:23], s38 offen offset:0 lds
    buffer_load_dwordx4 v10, s[20:23], s38 offen offset:1024 lds
    buffer_load_dwordx4 v10, s[20:23], s38 offen offset:2048 lds
    buffer_load_dwordx4 v10, s[20:23], s38 offen offset:3072 lds
    s_mov_b32 m0, 29696
    s_add_u32 s8, s38, 4096
    buffer_load_dwordx4 v10, s[20:23], s8 offen offset:0 lds
    s_add_u32 s38, s38, 20480
    s_add_u32 s39, s39, 1
    s_cmp_eq_u32 s39, 5
    s_cselect_b32 s38, s40, s38
    s_cselect_b32 s39, 0, s39
    s_waitcnt vmcnt(5)
    s_barrier
    s_mov_b32 m0, 46080
    s_nop 0
    buffer_load_dwordx4 v10, s[20:23], s38 offen offset:0 lds
    buffer_load_dwordx4 v10, s[20:23], s38 offen offset:1024 lds
    buffer_load_dwordx4 v10, s[20:23], s38 offen offset:2048 lds
    buffer_load_dwordx4 v10, s[20:23], s38 offen offset:3072 lds
    s_mov_b32 m0, 50176
    s_add_u32 s8, s38, 4096
    buffer_load_dwordx4 v10, s[20:23], s8 offen offset:0 lds
    s_add_u32 s38, s38, 20480
    s_add_u32 s39, s39, 1
    s_cmp_eq_u32 s39, 5
    s_cselect_b32 s38, s40, s38
    s_cselect_b32 s39, 0, s39
    s_mov_b32 m0, 66560
    s_nop 0
    buffer_load_dwordx4 v10, s[20:23], s38 offen offset:0 lds
    buffer_load_dwordx4 v10, s[20:23], s38 offen offset:1024 lds
    buffer_load_dwordx4 v10, s[20:23], s38 offen offset:2048 lds
    buffer_load_dwordx4 v10, s[20:23], s38 offen offset:3072 lds
    s_mov_b32 m0, 70656
    s_add_u32 s8, s38, 4096
    buffer_load_dwordx4 v10, s[20:23], s8 offen offset:0 lds
    s_add_u32 s38, s38, 20480
    s_add_u32 s39, s39, 1
    s_cmp_eq_u32 s39, 5
    s_cselect_b32 s38, s40, s38
    s_cselect_b32 s39, 0, s39
    s_waitcnt vmcnt(10)
    s_barrier
    s_mov_b32 s37, 0
    s_mov_b32 s46, 40960
    s_mov_b32 s36, 2
k2_kernel_ll91:
    s_waitcnt vmcnt(5)
    s_barrier
    s_add_u32 m0, s37, 5120
    s_nop 0
    buffer_load_dwordx4 v10, s[20:23], s38 offen offset:0 lds
    buffer_load_dwordx4 v10, s[20:23], s38 offen offset:1024 lds
    buffer_load_dwordx4 v10, s[20:23], s38 offen offset:2048 lds
    buffer_load_dwordx4 v10, s[20:23], s38 offen offset:3072 lds
    s_add_u32 m0, s37, 9216
    s_add_u32 s8, s38, 4096
    buffer_load_dwordx4 v10, s[20:23], s8 offen offset:0 lds
    s_add_u32 s38, s38, 20480
    s_add_u32 s39, s39, 1
    s_cmp_eq_u32 s39, 5
    s_cselect_b32 s38, s40, s38
    s_cselect_b32 s39, 0, s39
    s_add_u32 s37, s37, 20480
    s_cmp_eq_u32 s37, 81920
    s_cselect_b32 s37, 0, s37
    s_add_u32 s36, s36, 1
    s_cmp_le_u32 s36, 2
    s_cbranch_scc1 k2_kernel_ll91
    s_waitcnt vmcnt(5)
    s_barrier
    s_waitcnt vmcnt(0)
    s_barrier
    s_branch k2_kernel_lfin89
k2_kernel_l87:
    v_lshlrev_b32 v10, 4, v0
    s_waitcnt lgkmcnt(0)
    s_mov_b32 s39, 0
    s_mul_i32 s40, s5, 102400
    s_add_u32 s40, s40, 10240
    s_mul_i32 s38, s39, 20480
    s_add_u32 s38, s38, s40
    s_add_u32 s20, s10, 20513792
    s_addc_u32 s21, s11, 0
    s_mov_b32 s22, 819200
    s_mov_b32 s23, 0x20000
    v_lshlrev_b32 v11, 7, v0
    s_mov_b32 s28, s10
    s_mov_b32 s29, s11
    s_mov_b32 s30, 29815808
    s_mov_b32 s31, 0x20000
    s_mov_b32 m0, 10240
    s_nop 0
    buffer_load_dwordx4 v10, s[20:23], s38 offen offset:0 lds
    buffer_load_dwordx4 v10, s[20:23], s38 offen offset:1024 lds
    buffer_load_dwordx4 v10, s[20:23], s38 offen offset:2048 lds
    buffer_load_dwordx4 v10, s[20:23], s38 offen offset:3072 lds
    s_mov_b32 m0, 14336
    s_add_u32 s8, s38, 4096
    buffer_load_dwordx4 v10, s[20:23], s8 offen offset:0 lds
    s_add_u32 s38, s38, 20480
    s_add_u32 s39, s39, 1
    s_cmp_eq_u32 s39, 5
    s_cselect_b32 s38, s40, s38
    s_cselect_b32 s39, 0, s39
    s_mov_b32 m0, 30720
    s_nop 0
    buffer_load_dwordx4 v10, s[20:23], s38 offen offset:0 lds
    buffer_load_dwordx4 v10, s[20:23], s38 offen offset:1024 lds
    buffer_load_dwordx4 v10, s[20:23], s38 offen offset:2048 lds
    buffer_load_dwordx4 v10, s[20:23], s38 offen offset:3072 lds
    s_mov_b32 m0, 34816
    s_add_u32 s8, s38, 4096
    buffer_load_dwordx4 v10, s[20:23], s8 offen offset:0 lds
    s_add_u32 s38, s38, 20480
    s_add_u32 s39, s39, 1
    s_cmp_eq_u32 s39, 5
    s_cselect_b32 s38, s40, s38
    s_cselect_b32 s39, 0, s39
    s_waitcnt vmcnt(5)
    s_barrier
    s_mov_b32 m0, 51200
    s_nop 0
    buffer_load_dwordx4 v10, s[20:23], s38 offen offset:0 lds
    buffer_load_dwordx4 v10, s[20:23], s38 offen offset:1024 lds
    buffer_load_dwordx4 v10, s[20:23], s38 offen offset:2048 lds
    buffer_load_dwordx4 v10, s[20:23], s38 offen offset:3072 lds
    s_mov_b32 m0, 55296
    s_add_u32 s8, s38, 4096
    buffer_load_dwordx4 v10, s[20:23], s8 offen offset:0 lds
    s_add_u32 s38, s38, 20480
    s_add_u32 s39, s39, 1
    s_cmp_eq_u32 s39, 5
    s_cselect_b32 s38, s40, s38
    s_cselect_b32 s39, 0, s39
    s_mov_b32 m0, 71680
    s_nop 0
    buffer_load_dwordx4 v10, s[20:23], s38 offen offset:0 lds
    buffer_load_dwordx4 v10, s[20:23], s38 offen offset:1024 lds
    buffer_load_dwordx4 v10, s[20:23], s38 offen offset:2048 lds
    buffer_load_dwordx4 v10, s[20:23], s38 offen offset:3072 lds
    s_mov_b32 m0, 75776
    s_add_u32 s8, s38, 4096
    buffer_load_dwordx4 v10, s[20:23], s8 offen offset:0 lds
    s_add_u32 s38, s38, 20480
    s_add_u32 s39, s39, 1
    s_cmp_eq_u32 s39, 5
    s_cselect_b32 s38, s40, s38
    s_cselect_b32 s39, 0, s39
    s_waitcnt vmcnt(10)
    s_barrier
    s_mov_b32 s37, 0
    s_mov_b32 s46, 40960
    s_mov_b32 s36, 2
k2_kernel_ll92:
    s_waitcnt vmcnt(5)
    s_barrier
    s_add_u32 m0, s37, 10240
    s_nop 0
    buffer_load_dwordx4 v10, s[20:23], s38 offen offset:0 lds
    buffer_load_dwordx4 v10, s[20:23], s38 offen offset:1024 lds
    buffer_load_dwordx4 v10, s[20:23], s38 offen offset:2048 lds
    buffer_load_dwordx4 v10, s[20:23], s38 offen offset:3072 lds
    s_add_u32 m0, s37, 14336
    s_add_u32 s8, s38, 4096
    buffer_load_dwordx4 v10, s[20:23], s8 offen offset:0 lds
    s_add_u32 s38, s38, 20480
    s_add_u32 s39, s39, 1
    s_cmp_eq_u32 s39, 5
    s_cselect_b32 s38, s40, s38
    s_cselect_b32 s39, 0, s39
    s_add_u32 s37, s37, 20480
    s_cmp_eq_u32 s37, 81920
    s_cselect_b32 s37, 0, s37
    s_add_u32 s36, s36, 1
    s_cmp_le_u32 s36, 2
    s_cbranch_scc1 k2_kernel_ll92
    s_waitcnt vmcnt(5)
    s_barrier
    s_waitcnt vmcnt(0)
    s_barrier
    s_branch k2_kernel_lfin89
k2_kernel_l88:
    v_lshlrev_b32 v10, 4, v0
    s_waitcnt lgkmcnt(0)
    s_mov_b32 s39, 0
    s_mul_i32 s40, s5, 102400
    s_add_u32 s40, s40, 15360
    s_mul_i32 s38, s39, 20480
    s_add_u32 s38, s38, s40
    s_add_u32 s20, s10, 20513792
    s_addc_u32 s21, s11, 0
    s_mov_b32 s22, 819200
    s_mov_b32 s23, 0x20000
    v_lshlrev_b32 v11, 7, v0
    s_mov_b32 s28, s10
    s_mov_b32 s29, s11
    s_mov_b32 s30, 29815808
    s_mov_b32 s31, 0x20000
    s_mov_b32 m0, 15360
    s_nop 0
    buffer_load_dwordx4 v10, s[20:23], s38 offen offset:0 lds
    buffer_load_dwordx4 v10, s[20:23], s38 offen offset:1024 lds
    buffer_load_dwordx4 v10, s[20:23], s38 offen offset:2048 lds
    buffer_load_dwordx4 v10, s[20:23], s38 offen offset:3072 lds
    s_mov_b32 m0, 19456
    s_add_u32 s8, s38, 4096
    buffer_load_dwordx4 v10, s[20:23], s8 offen offset:0 lds
    s_add_u32 s38, s38, 20480
    s_add_u32 s39, s39, 1
    s_cmp_eq_u32 s39, 5
    s_cselect_b32 s38, s40, s38
    s_cselect_b32 s39, 0, s39
    s_mov_b32 m0, 35840
    s_nop 0
    buffer_load_dwordx4 v10, s[20:23], s38 offen offset:0 lds
    buffer_load_dwordx4 v10, s[20:23], s38 offen offset:1024 lds
    buffer_load_dwordx4 v10, s[20:23], s38 offen offset:2048 lds
    buffer_load_dwordx4 v10, s[20:23], s38 offen offset:3072 lds
    s_mov_b32 m0, 39936
    s_add_u32 s8, s38, 4096
    buffer_load_dwordx4 v10, s[20:23], s8 offen offset:0 lds
    s_add_u32 s38, s38, 20480
    s_add_u32 s39, s39, 1
    s_cmp_eq_u32 s39, 5
    s_cselect_b32 s38, s40, s38
    s_cselect_b32 s39, 0, s39
    s_waitcnt vmcnt(5)
    s_barrier
    s_mov_b32 m0, 56320
    s_nop 0
    buffer_load_dwordx4 v10, s[20:23], s38 offen offset:0 lds
    buffer_load_dwordx4 v10, s[20:23], s38 offen offset:1024 lds
    buffer_load_dwordx4 v10, s[20:23], s38 offen offset:2048 lds
    buffer_load_dwordx4 v10, s[20:23], s38 offen offset:3072 lds
    s_mov_b32 m0, 60416
    s_add_u32 s8, s38, 4096
    buffer_load_dwordx4 v10, s[20:23], s8 offen offset:0 lds
    s_add_u32 s38, s38, 20480
    s_add_u32 s39, s39, 1
    s_cmp_eq_u32 s39, 5
    s_cselect_b32 s38, s40, s38
    s_cselect_b32 s39, 0, s39
    s_mov_b32 m0, 76800
    s_nop 0
    buffer_load_dwordx4 v10, s[20:23], s38 offen offset:0 lds
    buffer_load_dwordx4 v10, s[20:23], s38 offen offset:1024 lds
    buffer_load_dwordx4 v10, s[20:23], s38 offen offset:2048 lds
    buffer_load_dwordx4 v10, s[20:23], s38 offen offset:3072 lds
    s_mov_b32 m0, 80896
    s_add_u32 s8, s38, 4096
    buffer_load_dwordx4 v10, s[20:23], s8 offen offset:0 lds
    s_add_u32 s38, s38, 20480
    s_add_u32 s39, s39, 1
    s_cmp_eq_u32 s39, 5
    s_cselect_b32 s38, s40, s38
    s_cselect_b32 s39, 0, s39
    s_waitcnt vmcnt(10)
    s_barrier
    s_mov_b32 s37, 0
    s_mov_b32 s46, 40960
    s_mov_b32 s36, 2
k2_kernel_ll93:
    s_waitcnt vmcnt(5)
    s_barrier
    s_add_u32 m0, s37, 15360
    s_nop 0
    buffer_load_dwordx4 v10, s[20:23], s38 offen offset:0 lds
    buffer_load_dwordx4 v10, s[20:23], s38 offen offset:1024 lds
    buffer_load_dwordx4 v10, s[20:23], s38 offen offset:2048 lds
    buffer_load_dwordx4 v10, s[20:23], s38 offen offset:3072 lds
    s_add_u32 m0, s37, 19456
    s_add_u32 s8, s38, 4096
    buffer_load_dwordx4 v10, s[20:23], s8 offen offset:0 lds
    s_add_u32 s38, s38, 20480
    s_add_u32 s39, s39, 1
    s_cmp_eq_u32 s39, 5
    s_cselect_b32 s38, s40, s38
    s_cselect_b32 s39, 0, s39
    s_add_u32 s37, s37, 20480
    s_cmp_eq_u32 s37, 81920
    s_cselect_b32 s37, 0, s37
    s_add_u32 s36, s36, 1
    s_cmp_le_u32 s36, 2
    s_cbranch_scc1 k2_kernel_ll93
    s_waitcnt vmcnt(5)
    s_barrier
    s_waitcnt vmcnt(0)
    s_barrier
k2_kernel_lfin89:
    s_barrier
k2_kernel_join25:
    s_waitcnt vmcnt(0)
    s_barrier
    s_cmp_lg_u32 s3, 0
    s_cbranch_scc1 k2_kernel_pub94
    s_lshl_b32 s8, s4, 7
    s_lshl_b32 s16, s5, 2
    s_add_u32 s8, s8, s16
    s_add_u32 s8, s8, 29770752
    v_mov_b32 v4, 0
    v_mov_b32 v5, 1
    s_mov_b64 exec, 1
    buffer_store_dword v5, v4, s[28:31], s8 offen sc1
    s_mov_b64 exec, -1
k2_kernel_pub94:
    s_setprio 1
    s_cmp_ge_u32 s3, 4
    s_cbranch_scc1 k2_kernel_ldr95
    s_lshr_b32 s42, s3, 0
    s_and_b32 s43, s3, 0
    s_lshl_b32 s44, s6, 3
    s_lshl_b32 s8, s42, 1
    s_add_u32 s44, s44, s8
    s_mul_i32 s45, s7, 7
    s_mul_i32 s8, s44, 20480
    v_lshlrev_b32 v4, 8, v2
    v_lshl_add_u32 v4, v1, 4, v4
    v_add_u32 v10, s8, v4
    v_add_u32 v11, 20480, v10
    v_lshlrev_b32 v4, 4, v0
    s_mul_i32 s8, s43, 14336
    v_add_u32 v3, s8, v4
    s_add_u32 s47, s44, s43
    s_waitcnt lgkmcnt(0)
    s_add_u32 s24, s10, 5432320
    s_addc_u32 s25, s11, 0
    s_mov_b32 s26, 2621440
    s_mov_b32 s27, 0x20000
    s_mov_b32 s28, s10
    s_mov_b32 s29, s11
    s_mov_b32 s30, 29815808
    s_mov_b32 s31, 0x20000
    s_cmp_lg_u32 s3, 0
    s_cbranch_scc1 k2_kernel_ps99
    v_mov_b32 v6, 1
    v_and_b32 v4, 7, v0
    v_lshlrev_b32 v4, 2, v4
    v_lshrrev_b32 v5, 3, v0
    v_lshl_add_u32 v4, v5, 7, v4
    s_lshl_b32 s8, s6, 8
    s_add_u32 s8, s8, 29770752
    v_add_u32 v4, s8, v4
    s_mov_b32 s18, 0
    s_mov_b64 exec, 65535
k2_kernel_poll97:
    buffer_load_dword v5, v4, s[28:31], 0 offen sc1
    s_waitcnt vmcnt(0)
    v_cmp_ne_u32 vcc, v6, v5
    s_cmp_eq_u64 vcc, 0
    s_cbranch_scc1 k2_kernel_pd98
    s_add_u32 s18, s18, 1
    s_cmp_ge_u32 s18, 0x40000
    s_cbranch_scc1 k2_kernel_pd98
    s_sleep 1
    s_branch k2_kernel_poll97
k2_kernel_pd98:
    s_mov_b64 exec, -1
k2_kernel_ps99:
    s_barrier
    s_mov_b32 s39, 0
    s_mul_i32 s39, s39, 2
    s_lshl_b32 s8, s43, 1
    s_add_u32 s39, s39, s8
    s_mov_b32 s46, 0
    s_lshl_b32 s40, s39, 10
    s_cmp_lt_u32 s39, 20
    s_cselect_b32 s40, s40, 0x40000000
    s_cmp_lt_u32 s46, 20
    s_cselect_b32 s40, s40, 0x40000000
    s_add_u32 s46, s46, 1
    buffer_load_dwordx4 v[96:99], v10, s[24:27], s40 offen sc1
    buffer_load_dwordx4 v[100:103], v11, s[24:27], s40 offen sc1
    s_add_u32 s39, s39, 1
    s_sub_u32 s8, s39, 20
    s_cmp_ge_u32 s39, 20
    s_cselect_b32 s39, s8, s39
    s_lshl_b32 s40, s39, 10
    s_cmp_lt_u32 s39, 20
    s_cselect_b32 s40, s40, 0x40000000
    s_cmp_lt_u32 s46, 20
    s_cselect_b32 s40, s40, 0x40000000
    s_add_u32 s46, s46, 1
    buffer_load_dwordx4 v[104:107], v10, s[24:27], s40 offen sc1
    buffer_load_dwordx4 v[108:111], v11, s[24:27], s40 offen sc1
    s_add_u32 s39, s39, 1
    s_sub_u32 s8, s39, 20
    s_cmp_ge_u32 s39, 20
    s_cselect_b32 s39, s8, s39
    s_lshl_b32 s40, s39, 10
    s_cmp_lt_u32 s39, 20
    s_cselect_b32 s40, s40, 0x40000000
    s_cmp_lt_u32 s46, 20
    s_cselect_b32 s40, s40, 0x40000000
    s_add_u32 s46, s46, 1
    buffer_load_dwordx4 v[112:115], v10, s[24:27], s40 offen sc1
    buffer_load_dwordx4 v[116:119], v11, s[24:27], s40 offen sc1
    s_add_u32 s39, s39, 1
    s_sub_u32 s8, s39, 20
    s_cmp_ge_u32 s39, 20
    s_cselect_b32 s39, s8, s39
    s_lshl_b32 s40, s39, 10
    s_cmp_lt_u32 s39, 20
    s_cselect_b32 s40, s40, 0x40000000
    s_cmp_lt_u32 s46, 20
    s_cselect_b32 s40, s40, 0x40000000
    s_add_u32 s46, s46, 1
    buffer_load_dwordx4 v[120:123], v10, s[24:27], s40 offen sc1
    buffer_load_dwordx4 v[124:127], v11, s[24:27], s40 offen sc1
    s_add_u32 s39, s39, 1
    s_sub_u32 s8, s39, 20
    s_cmp_ge_u32 s39, 20
    s_cselect_b32 s39, s8, s39
    s_barrier
    ds_read_b128 v[68:71], v3 offset:0
    ds_read_b128 v[72:75], v3 offset:1024
    ds_read_b128 v[76:79], v3 offset:2048
    ds_read_b128 v[80:83], v3 offset:3072
    ds_read_b128 v[84:87], v3 offset:4096
    ds_read_b128 v[88:91], v3 offset:5120
    ds_read_b128 v[92:95], v3 offset:6144
    s_mov_b32 s36, 0
    s_mov_b32 s37, 0
    s_waitcnt vmcnt(6) lgkmcnt(6)
    v_mfma_f32_16x16x32_bf16 v[12:15], v[68:71], v[96:99], 0
    v_mfma_f32_16x16x32_bf16 v[40:43], v[68:71], v[100:103], 0
    s_waitcnt lgkmcnt(5)
    v_mfma_f32_16x16x32_bf16 v[16:19], v[72:75], v[96:99], 0
    ds_read_b128 v[68:71], v3 offset:7168
    v_mfma_f32_16x16x32_bf16 v[44:47], v[72:75], v[100:103], 0
    s_waitcnt lgkmcnt(5)
    v_mfma_f32_16x16x32_bf16 v[20:23], v[76:79], v[96:99], 0
    ds_read_b128 v[72:75], v3 offset:8192
    v_mfma_f32_16x16x32_bf16 v[48:51], v[76:79], v[100:103], 0
    s_waitcnt lgkmcnt(5)
    v_mfma_f32_16x16x32_bf16 v[24:27], v[80:83], v[96:99], 0
    ds_read_b128 v[76:79], v3 offset:9216
    v_mfma_f32_16x16x32_bf16 v[52:55], v[80:83], v[100:103], 0
    s_waitcnt lgkmcnt(5)
    v_mfma_f32_16x16x32_bf16 v[28:31], v[84:87], v[96:99], 0
    ds_read_b128 v[80:83], v3 offset:10240
    v_mfma_f32_16x16x32_bf16 v[56:59], v[84:87], v[100:103], 0
    s_waitcnt lgkmcnt(5)
    v_mfma_f32_16x16x32_bf16 v[32:35], v[88:91], v[96:99], 0
    ds_read_b128 v[84:87], v3 offset:11264
    v_mfma_f32_16x16x32_bf16 v[60:63], v[88:91], v[100:103], 0
    s_waitcnt lgkmcnt(5)
    v_mfma_f32_16x16x32_bf16 v[36:39], v[92:95], v[96:99], 0
    ds_read_b128 v[88:91], v3 offset:12288
    v_mfma_f32_16x16x32_bf16 v[64:67], v[92:95], v[100:103], 0
    ds_read_b128 v[92:95], v3 offset:13312
    s_lshl_b32 s40, s39, 10
    s_cmp_lt_u32 s39, 20
    s_cselect_b32 s40, s40, 0x40000000
    s_cmp_lt_u32 s46, 20
    s_cselect_b32 s40, s40, 0x40000000
    s_add_u32 s46, s46, 1
    buffer_load_dwordx4 v[96:99], v10, s[24:27], s40 offen sc1
    buffer_load_dwordx4 v[100:103], v11, s[24:27], s40 offen sc1
    s_add_u32 s39, s39, 1
    s_sub_u32 s8, s39, 20
    s_cmp_ge_u32 s39, 20
    s_cselect_b32 s39, s8, s39
    s_add_u32 s37, s37, 1
    s_cmp_eq_u32 s37, 4
    s_mov_b32 s16, 14336
    s_cselect_b32 s16, 4294924288, s16
    s_cselect_b32 s37, 0, s37
    v_add_u32 v3, s16, v3
    s_barrier
    s_waitcnt vmcnt(6) lgkmcnt(6)
    v_mfma_f32_16x16x32_bf16 v[12:15], v[68:71], v[104:107], v[12:15]
    v_mfma_f32_16x16x32_bf16 v[40:43], v[68:71], v[108:111], v[40:43]
    s_waitcnt lgkmcnt(5)
    v_mfma_f32_16x16x32_bf16 v[16:19], v[72:75], v[104:107], v[16:19]
    ds_read_b128 v[68:71], v3 offset:0
    v_mfma_f32_16x16x32_bf16 v[44:47], v[72:75], v[108:111], v[44:47]
    s_waitcnt lgkmcnt(5)
    v_mfma_f32_16x16x32_bf16 v[20:23], v[76:79], v[104:107], v[20:23]
    ds_read_b128 v[72:75], v3 offset:1024
    v_mfma_f32_16x16x32_bf16 v[48:51], v[76:79], v[108:111], v[48:51]
    s_waitcnt lgkmcnt(5)
    v_mfma_f32_16x16x32_bf16 v[24:27], v[80:83], v[104:107], v[24:27]
    ds_read_b128 v[76:79], v3 offset:2048
    v_mfma_f32_16x16x32_bf16 v[52:55], v[80:83], v[108:111], v[52:55]
    s_waitcnt lgkmcnt(5)
    v_mfma_f32_16x16x32_bf16 v[28:31], v[84:87], v[104:107], v[28:31]
    ds_read_b128 v[80:83], v3 offset:3072
    v_mfma_f32_16x16x32_bf16 v[56:59], v[84:87], v[108:111], v[56:59]
    s_waitcnt lgkmcnt(5)
    v_mfma_f32_16x16x32_bf16 v[32:35], v[88:91], v[104:107], v[32:35]
    ds_read_b128 v[84:87], v3 offset:4096
    v_mfma_f32_16x16x32_bf16 v[60:63], v[88:91], v[108:111], v[60:63]
    s_waitcnt lgkmcnt(5)
    v_mfma_f32_16x16x32_bf16 v[36:39], v[92:95], v[104:107], v[36:39]
    ds_read_b128 v[88:91], v3 offset:5120
    v_mfma_f32_16x16x32_bf16 v[64:67], v[92:95], v[108:111], v[64:67]
    ds_read_b128 v[92:95], v3 offset:6144
    s_lshl_b32 s40, s39, 10
    s_cmp_lt_u32 s39, 20
    s_cselect_b32 s40, s40, 0x40000000
    s_cmp_lt_u32 s46, 20
    s_cselect_b32 s40, s40, 0x40000000
    s_add_u32 s46, s46, 1
    buffer_load_dwordx4 v[104:107], v10, s[24:27], s40 offen sc1
    buffer_load_dwordx4 v[108:111], v11, s[24:27], s40 offen sc1
    s_add_u32 s39, s39, 1
    s_sub_u32 s8, s39, 20
    s_cmp_ge_u32 s39, 20
    s_cselect_b32 s39, s8, s39
    s_add_u32 s36, s36, 1
.p2align 6
k2_kernel_gloop100:
    s_waitcnt vmcnt(6) lgkmcnt(6)
    v_mfma_f32_16x16x32_bf16 v[12:15], v[68:71], v[112:115], v[12:15]
    v_mfma_f32_16x16x32_bf16 v[40:43], v[68:71], v[116:119], v[40:43]
    s_waitcnt lgkmcnt(5)
    v_mfma_f32_16x16x32_bf16 v[16:19], v[72:75], v[112:115], v[16:19]
    ds_read_b128 v[68:71], v3 offset:7168
    v_mfma_f32_16x16x32_bf16 v[44:47], v[72:75], v[116:119], v[44:47]
    s_waitcnt lgkmcnt(5)
    v_mfma_f32_16x16x32_bf16 v[20:23], v[76:79], v[112:115], v[20:23]
    ds_read_b128 v[72:75], v3 offset:8192
    v_mfma_f32_16x16x32_bf16 v[48:51], v[76:79], v[116:119], v[48:51]
    s_waitcnt lgkmcnt(5)
    v_mfma_f32_16x16x32_bf16 v[24:27], v[80:83], v[112:115], v[24:27]
    ds_read_b128 v[76:79], v3 offset:9216
    v_mfma_f32_16x16x32_bf16 v[52:55], v[80:83], v[116:119], v[52:55]
    s_waitcnt lgkmcnt(5)
    v_mfma_f32_16x16x32_bf16 v[28:31], v[84:87], v[112:115], v[28:31]
    ds_read_b128 v[80:83], v3 offset:10240
    v_mfma_f32_16x16x32_bf16 v[56:59], v[84:87], v[116:119], v[56:59]
    s_waitcnt lgkmcnt(5)
    v_mfma_f32_16x16x32_bf16 v[32:35], v[88:91], v[112:115], v[32:35]
    ds_read_b128 v[84:87], v3 offset:11264
    v_mfma_f32_16x16x32_bf16 v[60:63], v[88:91], v[116:119], v[60:63]
    s_waitcnt lgkmcnt(5)
    v_mfma_f32_16x16x32_bf16 v[36:39], v[92:95], v[112:115], v[36:39]
    ds_read_b128 v[88:91], v3 offset:12288
    v_mfma_f32_16x16x32_bf16 v[64:67], v[92:95], v[116:119], v[64:67]
    ds_read_b128 v[92:95], v3 offset:13312
    s_lshl_b32 s40, s39, 10
    s_cmp_lt_u32 s39, 20
    s_cselect_b32 s40, s40, 0x40000000
    s_cmp_lt_u32 s46, 20
    s_cselect_b32 s40, s40, 0x40000000
    s_add_u32 s46, s46, 1
    buffer_load_dwordx4 v[112:115], v10, s[24:27], s40 offen sc1
    buffer_load_dwordx4 v[116:119], v11, s[24:27], s40 offen sc1
    s_add_u32 s39, s39, 1
    s_sub_u32 s8, s39, 20
    s_cmp_ge_u32 s39, 20
    s_cselect_b32 s39, s8, s39
    s_add_u32 s37, s37, 1
    s_cmp_eq_u32 s37, 4
    s_mov_b32 s16, 14336
    s_cselect_b32 s16, 4294924288, s16
    s_cselect_b32 s37, 0, s37
    v_add_u32 v3, s16, v3
    s_barrier
    s_waitcnt vmcnt(6) lgkmcnt(6)
    v_mfma_f32_16x16x32_bf16 v[12:15], v[68:71], v[120:123], v[12:15]
    v_mfma_f32_16x16x32_bf16 v[40:43], v[68:71], v[124:127], v[40:43]
    s_waitcnt lgkmcnt(5)
    v_mfma_f32_16x16x32_bf16 v[16:19], v[72:75], v[120:123], v[16:19]
    ds_read_b128 v[68:71], v3 offset:0
    v_mfma_f32_16x16x32_bf16 v[44:47], v[72:75], v[124:127], v[44:47]
    s_waitcnt lgkmcnt(5)
    v_mfma_f32_16x16x32_bf16 v[20:23], v[76:79], v[120:123], v[20:23]
    ds_read_b128 v[72:75], v3 offset:1024
    v_mfma_f32_16x16x32_bf16 v[48:51], v[76:79], v[124:127], v[48:51]
    s_waitcnt lgkmcnt(5)
    v_mfma_f32_16x16x32_bf16 v[24:27], v[80:83], v[120:123], v[24:27]
    ds_read_b128 v[76:79], v3 offset:2048
    v_mfma_f32_16x16x32_bf16 v[52:55], v[80:83], v[124:127], v[52:55]
    s_waitcnt lgkmcnt(5)
    v_mfma_f32_16x16x32_bf16 v[28:31], v[84:87], v[120:123], v[28:31]
    ds_read_b128 v[80:83], v3 offset:3072
    v_mfma_f32_16x16x32_bf16 v[56:59], v[84:87], v[124:127], v[56:59]
    s_waitcnt lgkmcnt(5)
    v_mfma_f32_16x16x32_bf16 v[32:35], v[88:91], v[120:123], v[32:35]
    ds_read_b128 v[84:87], v3 offset:4096
    v_mfma_f32_16x16x32_bf16 v[60:63], v[88:91], v[124:127], v[60:63]
    s_waitcnt lgkmcnt(5)
    v_mfma_f32_16x16x32_bf16 v[36:39], v[92:95], v[120:123], v[36:39]
    ds_read_b128 v[88:91], v3 offset:5120
    v_mfma_f32_16x16x32_bf16 v[64:67], v[92:95], v[124:127], v[64:67]
    ds_read_b128 v[92:95], v3 offset:6144
    s_lshl_b32 s40, s39, 10
    s_cmp_lt_u32 s39, 20
    s_cselect_b32 s40, s40, 0x40000000
    s_cmp_lt_u32 s46, 20
    s_cselect_b32 s40, s40, 0x40000000
    s_add_u32 s46, s46, 1
    buffer_load_dwordx4 v[120:123], v10, s[24:27], s40 offen sc1
    buffer_load_dwordx4 v[124:127], v11, s[24:27], s40 offen sc1
    s_add_u32 s39, s39, 1
    s_sub_u32 s8, s39, 20
    s_cmp_ge_u32 s39, 20
    s_cselect_b32 s39, s8, s39
    s_add_u32 s36, s36, 1
    s_cmp_lt_u32 s36, 9
    s_waitcnt vmcnt(6) lgkmcnt(6)
    v_mfma_f32_16x16x32_bf16 v[12:15], v[68:71], v[96:99], v[12:15]
    v_mfma_f32_16x16x32_bf16 v[40:43], v[68:71], v[100:103], v[40:43]
    s_waitcnt lgkmcnt(5)
    v_mfma_f32_16x16x32_bf16 v[16:19], v[72:75], v[96:99], v[16:19]
    ds_read_b128 v[68:71], v3 offset:7168
    v_mfma_f32_16x16x32_bf16 v[44:47], v[72:75], v[100:103], v[44:47]
    s_waitcnt lgkmcnt(5)
    v_mfma_f32_16x16x32_bf16 v[20:23], v[76:79], v[96:99], v[20:23]
    ds_read_b128 v[72:75], v3 offset:8192
    v_mfma_f32_16x16x32_bf16 v[48:51], v[76:79], v[100:103], v[48:51]
    s_waitcnt lgkmcnt(5)
    v_mfma_f32_16x16x32_bf16 v[24:27], v[80:83], v[96:99], v[24:27]
    ds_read_b128 v[76:79], v3 offset:9216
    v_mfma_f32_16x16x32_bf16 v[52:55], v[80:83], v[100:103], v[52:55]
    s_waitcnt lgkmcnt(5)
    v_mfma_f32_16x16x32_bf16 v[28:31], v[84:87], v[96:99], v[28:31]
    ds_read_b128 v[80:83], v3 offset:10240
    v_mfma_f32_16x16x32_bf16 v[56:59], v[84:87], v[100:103], v[56:59]
    s_waitcnt lgkmcnt(5)
    v_mfma_f32_16x16x32_bf16 v[32:35], v[88:91], v[96:99], v[32:35]
    ds_read_b128 v[84:87], v3 offset:11264
    v_mfma_f32_16x16x32_bf16 v[60:63], v[88:91], v[100:103], v[60:63]
    s_waitcnt lgkmcnt(5)
    v_mfma_f32_16x16x32_bf16 v[36:39], v[92:95], v[96:99], v[36:39]
    ds_read_b128 v[88:91], v3 offset:12288
    v_mfma_f32_16x16x32_bf16 v[64:67], v[92:95], v[100:103], v[64:67]
    ds_read_b128 v[92:95], v3 offset:13312
    s_lshl_b32 s40, s39, 10
    s_cmp_lt_u32 s39, 20
    s_cselect_b32 s40, s40, 0x40000000
    s_cmp_lt_u32 s46, 20
    s_cselect_b32 s40, s40, 0x40000000
    s_add_u32 s46, s46, 1
    buffer_load_dwordx4 v[96:99], v10, s[24:27], s40 offen sc1
    buffer_load_dwordx4 v[100:103], v11, s[24:27], s40 offen sc1
    s_add_u32 s39, s39, 1
    s_sub_u32 s8, s39, 20
    s_cmp_ge_u32 s39, 20
    s_cselect_b32 s39, s8, s39
    s_add_u32 s37, s37, 1
    s_cmp_eq_u32 s37, 4
    s_mov_b32 s16, 14336
    s_cselect_b32 s16, 4294924288, s16
    s_cselect_b32 s37, 0, s37
    v_add_u32 v3, s16, v3
    s_barrier
    s_waitcnt vmcnt(6) lgkmcnt(6)
    v_mfma_f32_16x16x32_bf16 v[12:15], v[68:71], v[104:107], v[12:15]
    v_mfma_f32_16x16x32_bf16 v[40:43], v[68:71], v[108:111], v[40:43]
    s_waitcnt lgkmcnt(5)
    v_mfma_f32_16x16x32_bf16 v[16:19], v[72:75], v[104:107], v[16:19]
    ds_read_b128 v[68:71], v3 offset:0
    v_mfma_f32_16x16x32_bf16 v[44:47], v[72:75], v[108:111], v[44:47]
    s_waitcnt lgkmcnt(5)
    v_mfma_f32_16x16x32_bf16 v[20:23], v[76:79], v[104:107], v[20:23]
    ds_read_b128 v[72:75], v3 offset:1024
    v_mfma_f32_16x16x32_bf16 v[48:51], v[76:79], v[108:111], v[48:51]
    s_waitcnt lgkmcnt(5)
    v_mfma_f32_16x16x32_bf16 v[24:27], v[80:83], v[104:107], v[24:27]
    ds_read_b128 v[76:79], v3 offset:2048
    v_mfma_f32_16x16x32_bf16 v[52:55], v[80:83], v[108:111], v[52:55]
    s_waitcnt lgkmcnt(5)
    v_mfma_f32_16x16x32_bf16 v[28:31], v[84:87], v[104:107], v[28:31]
    ds_read_b128 v[80:83], v3 offset:3072
    v_mfma_f32_16x16x32_bf16 v[56:59], v[84:87], v[108:111], v[56:59]
    s_waitcnt lgkmcnt(5)
    v_mfma_f32_16x16x32_bf16 v[32:35], v[88:91], v[104:107], v[32:35]
    ds_read_b128 v[84:87], v3 offset:4096
    v_mfma_f32_16x16x32_bf16 v[60:63], v[88:91], v[108:111], v[60:63]
    s_waitcnt lgkmcnt(5)
    v_mfma_f32_16x16x32_bf16 v[36:39], v[92:95], v[104:107], v[36:39]
    ds_read_b128 v[88:91], v3 offset:5120
    v_mfma_f32_16x16x32_bf16 v[64:67], v[92:95], v[108:111], v[64:67]
    ds_read_b128 v[92:95], v3 offset:6144
    s_lshl_b32 s40, s39, 10
    s_cmp_lt_u32 s39, 20
    s_cselect_b32 s40, s40, 0x40000000
    s_cmp_lt_u32 s46, 20
    s_cselect_b32 s40, s40, 0x40000000
    s_add_u32 s46, s46, 1
    buffer_load_dwordx4 v[104:107], v10, s[24:27], s40 offen sc1
    buffer_load_dwordx4 v[108:111], v11, s[24:27], s40 offen sc1
    s_add_u32 s39, s39, 1
    s_sub_u32 s8, s39, 20
    s_cmp_ge_u32 s39, 20
    s_cselect_b32 s39, s8, s39
    s_add_u32 s36, s36, 1
    s_cmp_lt_u32 s36, 9
    s_cbranch_scc1 k2_kernel_gloop100
k2_kernel_gexit101:
    s_lshl_b32 s8, s47, 6
    s_add_u32 s8, s8, 2802688
    v_lshlrev_b32 v5, 2, v1
    buffer_load_dword v100, v5, s[28:31], s8 offen
    s_lshl_b32 s8, s47, 10
    s_add_u32 s8, s8, 8053760
    v_lshlrev_b32 v4, 6, v1
    v_lshl_add_u32 v4, v2, 4, v4
    buffer_load_dwordx4 v[96:99], v4, s[28:31], s8 offen sc1
    s_waitcnt vmcnt(8) lgkmcnt(6)
    v_mfma_f32_16x16x32_bf16 v[12:15], v[68:71], v[112:115], v[12:15]
    v_mfma_f32_16x16x32_bf16 v[40:43], v[68:71], v[116:119], v[40:43]
    s_waitcnt lgkmcnt(5)
    v_mfma_f32_16x16x32_bf16 v[16:19], v[72:75], v[112:115], v[16:19]
    ds_read_b128 v[68:71], v3 offset:7168
    v_mfma_f32_16x16x32_bf16 v[44:47], v[72:75], v[116:119], v[44:47]
    s_waitcnt lgkmcnt(5)
    v_mfma_f32_16x16x32_bf16 v[20:23], v[76:79], v[112:115], v[20:23]
    ds_read_b128 v[72:75], v3 offset:8192
    v_mfma_f32_16x16x32_bf16 v[48:51], v[76:79], v[116:119], v[48:51]
    s_waitcnt lgkmcnt(5)
    v_mfma_f32_16x16x32_bf16 v[24:27], v[80:83], v[112:115], v[24:27]
    ds_read_b128 v[76:79], v3 offset:9216
    v_mfma_f32_16x16x32_bf16 v[52:55], v[80:83], v[116:119], v[52:55]
    s_waitcnt lgkmcnt(5)
    v_mfma_f32_16x16x32_bf16 v[28:31], v[84:87], v[112:115], v[28:31]
    ds_read_b128 v[80:83], v3 offset:10240
    v_mfma_f32_16x16x32_bf16 v[56:59], v[84:87], v[116:119], v[56:59]
    s_waitcnt lgkmcnt(5)
    v_mfma_f32_16x16x32_bf16 v[32:35], v[88:91], v[112:115], v[32:35]
    ds_read_b128 v[84:87], v3 offset:11264
    v_mfma_f32_16x16x32_bf16 v[60:63], v[88:91], v[116:119], v[60:63]
    s_waitcnt lgkmcnt(5)
    v_mfma_f32_16x16x32_bf16 v[36:39], v[92:95], v[112:115], v[36:39]
    ds_read_b128 v[88:91], v3 offset:12288
    v_mfma_f32_16x16x32_bf16 v[64:67], v[92:95], v[116:119], v[64:67]
    ds_read_b128 v[92:95], v3 offset:13312
    s_lshl_b32 s40, s39, 10
    s_cmp_lt_u32 s39, 20
    s_cselect_b32 s40, s40, 0x40000000
    s_cmp_lt_u32 s46, 20
    s_cselect_b32 s40, s40, 0x40000000
    s_add_u32 s46, s46, 1
    buffer_load_dwordx4 v[112:115], v10, s[24:27], s40 offen sc1
    buffer_load_dwordx4 v[116:119], v11, s[24:27], s40 offen sc1
    s_add_u32 s39, s39, 1
    s_sub_u32 s8, s39, 20
    s_cmp_ge_u32 s39, 20
    s_cselect_b32 s39, s8, s39
    s_waitcnt vmcnt(8) lgkmcnt(6)
    v_mfma_f32_16x16x32_bf16 v[12:15], v[68:71], v[120:123], v[12:15]
    v_mfma_f32_16x16x32_bf16 v[40:43], v[68:71], v[124:127], v[40:43]
    s_waitcnt lgkmcnt(5)
    v_mfma_f32_16x16x32_bf16 v[16:19], v[72:75], v[120:123], v[16:19]
    v_mfma_f32_16x16x32_bf16 v[44:47], v[72:75], v[124:127], v[44:47]
    s_waitcnt lgkmcnt(4)
    v_mfma_f32_16x16x32_bf16 v[20:23], v[76:79], v[120:123], v[20:23]
    v_mfma_f32_16x16x32_bf16 v[48:51], v[76:79], v[124:127], v[48:51]
    s_waitcnt lgkmcnt(3)
    v_mfma_f32_16x16x32_bf16 v[24:27], v[80:83], v[120:123], v[24:27]
    v_mfma_f32_16x16x32_bf16 v[52:55], v[80:83], v[124:127], v[52:55]
    s_waitcnt lgkmcnt(2)
    v_mfma_f32_16x16x32_bf16 v[28:31], v[84:87], v[120:123], v[28:31]
    v_mfma_f32_16x16x32_bf16 v[56:59], v[84:87], v[124:127], v[56:59]
    s_waitcnt lgkmcnt(1)
    v_mfma_f32_16x16x32_bf16 v[32:35], v[88:91], v[120:123], v[32:35]
    v_mfma_f32_16x16x32_bf16 v[60:63], v[88:91], v[124:127], v[60:63]
    s_waitcnt lgkmcnt(0)
    v_mfma_f32_16x16x32_bf16 v[36:39], v[92:95], v[120:123], v[36:39]
    v_mfma_f32_16x16x32_bf16 v[64:67], v[92:95], v[124:127], v[64:67]
    s_nop 7
    s_mul_i32 s8, s3, 7168
    s_add_u32 s8, s8, 28672
    v_lshlrev_b32 v9, 4, v0
    v_add_u32 v9, s8, v9
    ds_write_b128 v9, v[40:43] offset:0
    ds_write_b128 v9, v[44:47] offset:1024
    ds_write_b128 v9, v[48:51] offset:2048
    ds_write_b128 v9, v[52:55] offset:3072
    ds_write_b128 v9, v[56:59] offset:4096
    ds_write_b128 v9, v[60:63] offset:5120
    ds_write_b128 v9, v[64:67] offset:6144
    s_waitcnt vmcnt(0) lgkmcnt(0)
    s_barrier
    v_lshlrev_b32 v4, 4, v2
    v_add_u32 v4, 57344, v4
    ds_read_b128 v[40:43], v4 offset:0
    ds_read_b128 v[44:47], v4 offset:64
    ds_read_b128 v[48:51], v4 offset:128
    ds_read_b128 v[52:55], v4 offset:192
    ds_read_b128 v[56:59], v4 offset:256
    ds_read_b128 v[60:63], v4 offset:320
    ds_read_b128 v[64:67], v4 offset:384
    v_mov_b32 v68, 0xc0135761
    v_mov_b32 v69, 0xbdd2d3e8
    v_add_f32 v96, v96, v98
    v_add_f32 v97, v97, v99
    v_mov_b32 v5, v96
    v_mov_b32 v6, v96
    s_nop 1
    v_permlane32_swap_b32 v5, v6
    s_nop 1
    v_add_f32 v96, v5, v6
    v_mov_b32 v5, v96
    v_mov_b32 v6, v96
    s_nop 1
    v_permlane16_swap_b32 v5, v6
    s_nop 1
    v_add_f32 v96, v5, v6
    v_mov_b32 v5, v97
    v_mov_b32 v6, v97
    s_nop 1
    v_permlane32_swap_b32 v5, v6
    s_nop 1
    v_add_f32 v97, v5, v6
    v_mov_b32 v5, v97
    v_mov_b32 v6, v97
    s_nop 1
    v_permlane16_swap_b32 v5, v6
    s_nop 1
    v_add_f32 v97, v5, v6
    v_mul_f32 v70, 0x3acccccd, v96
    v_mul_f32 v5, 0x3acccccd, v97
    v_fma_f32 v5, -v70, v70, v5
    v_max_f32 v5, 0, v5
    v_add_f32 v5, 0x3727c5ac, v5
    v_rsq_f32 v71, v5
    s_waitcnt lgkmcnt(0)
    v_mul_f32 v70, v70, v71
    v_sub_f32 v70, 0, v70
    v_sub_f32 v100, 1.0, v100
    v_pk_mul_f32 v[40:41], v[40:41], v[70:71] op_sel_hi:[1,0]
    v_pk_mul_f32 v[42:43], v[42:43], v[70:71] op_sel_hi:[1,0]
    v_pk_mul_f32 v[44:45], v[44:45], v[70:71] op_sel_hi:[1,0]
    v_pk_mul_f32 v[46:47], v[46:47], v[70:71] op_sel_hi:[1,0]
    v_pk_mul_f32 v[48:49], v[48:49], v[70:71] op_sel_hi:[1,0]
    v_pk_mul_f32 v[50:51], v[50:51], v[70:71] op_sel_hi:[1,0]
    v_pk_mul_f32 v[52:53], v[52:53], v[70:71] op_sel_hi:[1,0]
    v_pk_mul_f32 v[54:55], v[54:55], v[70:71] op_sel_hi:[1,0]
    v_pk_mul_f32 v[56:57], v[56:57], v[70:71] op_sel_hi:[1,0]
    v_pk_mul_f32 v[58:59], v[58:59], v[70:71] op_sel_hi:[1,0]
    v_pk_mul_f32 v[60:61], v[60:61], v[70:71] op_sel_hi:[1,0]
    v_pk_mul_f32 v[62:63], v[62:63], v[70:71] op_sel_hi:[1,0]
    v_pk_mul_f32 v[64:65], v[64:65], v[70:71] op_sel_hi:[1,0]
    v_pk_mul_f32 v[66:67], v[66:67], v[70:71] op_sel_hi:[1,0]
    v_pk_fma_f32 v[12:13], v[12:13], v[70:71], v[40:41] op_sel:[0,1,0] op_sel_hi:[1,1,1]
    v_pk_fma_f32 v[14:15], v[14:15], v[70:71], v[42:43] op_sel:[0,1,0] op_sel_hi:[1,1,1]
    v_pk_fma_f32 v[16:17], v[16:17], v[70:71], v[44:45] op_sel:[0,1,0] op_sel_hi:[1,1,1]
    v_pk_fma_f32 v[18:19], v[18:19], v[70:71], v[46:47] op_sel:[0,1,0] op_sel_hi:[1,1,1]
    v_pk_fma_f32 v[20:21], v[20:21], v[70:71], v[48:49] op_sel:[0,1,0] op_sel_hi:[1,1,1]
    v_pk_fma_f32 v[22:23], v[22:23], v[70:71], v[50:51] op_sel:[0,1,0] op_sel_hi:[1,1,1]
    v_pk_fma_f32 v[24:25], v[24:25], v[70:71], v[52:53] op_sel:[0,1,0] op_sel_hi:[1,1,1]
    v_pk_fma_f32 v[26:27], v[26:27], v[70:71], v[54:55] op_sel:[0,1,0] op_sel_hi:[1,1,1]
    v_pk_fma_f32 v[28:29], v[28:29], v[70:71], v[56:57] op_sel:[0,1,0] op_sel_hi:[1,1,1]
    v_pk_fma_f32 v[30:31], v[30:31], v[70:71], v[58:59] op_sel:[0,1,0] op_sel_hi:[1,1,1]
    v_pk_fma_f32 v[32:33], v[32:33], v[70:71], v[60:61] op_sel:[0,1,0] op_sel_hi:[1,1,1]
    v_pk_fma_f32 v[34:35], v[34:35], v[70:71], v[62:63] op_sel:[0,1,0] op_sel_hi:[1,1,1]
    v_pk_fma_f32 v[36:37], v[36:37], v[70:71], v[64:65] op_sel:[0,1,0] op_sel_hi:[1,1,1]
    v_pk_fma_f32 v[38:39], v[38:39], v[70:71], v[66:67] op_sel:[0,1,0] op_sel_hi:[1,1,1]
    v_pk_mul_f32 v[40:41], v[12:13], v[12:13]
    v_pk_mul_f32 v[42:43], v[14:15], v[14:15]
    v_pk_mul_f32 v[44:45], v[16:17], v[16:17]
    v_pk_mul_f32 v[46:47], v[18:19], v[18:19]
    v_pk_mul_f32 v[48:49], v[20:21], v[20:21]
    v_pk_mul_f32 v[50:51], v[22:23], v[22:23]
    v_pk_mul_f32 v[52:53], v[24:25], v[24:25]
    v_pk_mul_f32 v[54:55], v[26:27], v[26:27]
    v_pk_mul_f32 v[56:57], v[28:29], v[28:29]
    v_pk_mul_f32 v[58:59], v[30:31], v[30:31]
    v_pk_mul_f32 v[60:61], v[32:33], v[32:33]
    v_pk_mul_f32 v[62:63], v[34:35], v[34:35]
    v_pk_mul_f32 v[64:65], v[36:37], v[36:37]
    v_pk_mul_f32 v[66:67], v[38:39], v[38:39]
    v_pk_fma_f32 v[40:41], v[40:41], v[68:69], v[68:69] op_sel:[0,1,0] op_sel_hi:[1,1,0]
    v_pk_fma_f32 v[42:43], v[42:43], v[68:69], v[68:69] op_sel:[0,1,0] op_sel_hi:[1,1,0]
    v_pk_fma_f32 v[44:45], v[44:45], v[68:69], v[68:69] op_sel:[0,1,0] op_sel_hi:[1,1,0]
    v_pk_fma_f32 v[46:47], v[46:47], v[68:69], v[68:69] op_sel:[0,1,0] op_sel_hi:[1,1,0]
    v_pk_fma_f32 v[48:49], v[48:49], v[68:69], v[68:69] op_sel:[0,1,0] op_sel_hi:[1,1,0]
    v_pk_fma_f32 v[50:51], v[50:51], v[68:69], v[68:69] op_sel:[0,1,0] op_sel_hi:[1,1,0]
    v_pk_fma_f32 v[52:53], v[52:53], v[68:69], v[68:69] op_sel:[0,1,0] op_sel_hi:[1,1,0]
    v_pk_fma_f32 v[54:55], v[54:55], v[68:69], v[68:69] op_sel:[0,1,0] op_sel_hi:[1,1,0]
    v_pk_fma_f32 v[56:57], v[56:57], v[68:69], v[68:69] op_sel:[0,1,0] op_sel_hi:[1,1,0]
    v_pk_fma_f32 v[58:59], v[58:59], v[68:69], v[68:69] op_sel:[0,1,0] op_sel_hi:[1,1,0]
    v_pk_fma_f32 v[60:61], v[60:61], v[68:69], v[68:69] op_sel:[0,1,0] op_sel_hi:[1,1,0]
    v_pk_fma_f32 v[62:63], v[62:63], v[68:69], v[68:69] op_sel:[0,1,0] op_sel_hi:[1,1,0]
    v_pk_fma_f32 v[64:65], v[64:65], v[68:69], v[68:69] op_sel:[0,1,0] op_sel_hi:[1,1,0]
    v_pk_fma_f32 v[66:67], v[66:67], v[68:69], v[68:69] op_sel:[0,1,0] op_sel_hi:[1,1,0]
    v_pk_mul_f32 v[40:41], v[40:41], v[12:13]
    v_pk_mul_f32 v[42:43], v[42:43], v[14:15]
    v_pk_mul_f32 v[44:45], v[44:45], v[16:17]
    v_pk_mul_f32 v[46:47], v[46:47], v[18:19]
    v_pk_mul_f32 v[48:49], v[48:49], v[20:21]
    v_pk_mul_f32 v[50:51], v[50:51], v[22:23]
    v_pk_mul_f32 v[52:53], v[52:53], v[24:25]
    v_pk_mul_f32 v[54:55], v[54:55], v[26:27]
    v_pk_mul_f32 v[56:57], v[56:57], v[28:29]
    v_pk_mul_f32 v[58:59], v[58:59], v[30:31]
    v_pk_mul_f32 v[60:61], v[60:61], v[32:33]
    v_pk_mul_f32 v[62:63], v[62:63], v[34:35]
    v_pk_mul_f32 v[64:65], v[64:65], v[36:37]
    v_pk_mul_f32 v[66:67], v[66:67], v[38:39]
    v_exp_f32 v40, v40
    v_exp_f32 v41, v41
    v_exp_f32 v42, v42
    v_exp_f32 v43, v43
    v_exp_f32 v44, v44
    v_exp_f32 v45, v45
    v_exp_f32 v46, v46
    v_exp_f32 v47, v47
    v_exp_f32 v48, v48
    v_exp_f32 v49, v49
    v_exp_f32 v50, v50
    v_exp_f32 v51, v51
    v_exp_f32 v52, v52
    v_exp_f32 v53, v53
    v_exp_f32 v54, v54
    v_exp_f32 v55, v55
    v_exp_f32 v56, v56
    v_exp_f32 v57, v57
    v_exp_f32 v58, v58
    v_exp_f32 v59, v59
    v_exp_f32 v60, v60
    v_exp_f32 v61, v61
    v_exp_f32 v62, v62
    v_exp_f32 v63, v63
    v_exp_f32 v64, v64
    v_exp_f32 v65, v65
    v_exp_f32 v66, v66
    v_exp_f32 v67, v67
    v_pk_add_f32 v[40:41], v[40:41], 1.0 op_sel_hi:[1,0]
    v_pk_add_f32 v[42:43], v[42:43], 1.0 op_sel_hi:[1,0]
    v_pk_add_f32 v[44:45], v[44:45], 1.0 op_sel_hi:[1,0]
    v_pk_add_f32 v[46:47], v[46:47], 1.0 op_sel_hi:[1,0]
    v_pk_add_f32 v[48:49], v[48:49], 1.0 op_sel_hi:[1,0]
    v_pk_add_f32 v[50:51], v[50:51], 1.0 op_sel_hi:[1,0]
    v_pk_add_f32 v[52:53], v[52:53], 1.0 op_sel_hi:[1,0]
    v_pk_add_f32 v[54:55], v[54:55], 1.0 op_sel_hi:[1,0]
    v_pk_add_f32 v[56:57], v[56:57], 1.0 op_sel_hi:[1,0]
    v_pk_add_f32 v[58:59], v[58:59], 1.0 op_sel_hi:[1,0]
    v_pk_add_f32 v[60:61], v[60:61], 1.0 op_sel_hi:[1,0]
    v_pk_add_f32 v[62:63], v[62:63], 1.0 op_sel_hi:[1,0]
    v_pk_add_f32 v[64:65], v[64:65], 1.0 op_sel_hi:[1,0]
    v_pk_add_f32 v[66:67], v[66:67], 1.0 op_sel_hi:[1,0]
    v_rcp_f32 v40, v40
    v_rcp_f32 v41, v41
    v_rcp_f32 v42, v42
    v_rcp_f32 v43, v43
    v_rcp_f32 v44, v44
    v_rcp_f32 v45, v45
    v_rcp_f32 v46, v46
    v_rcp_f32 v47, v47
    v_rcp_f32 v48, v48
    v_rcp_f32 v49, v49
    v_rcp_f32 v50, v50
    v_rcp_f32 v51, v51
    v_rcp_f32 v52, v52
    v_rcp_f32 v53, v53
    v_rcp_f32 v54, v54
    v_rcp_f32 v55, v55
    v_rcp_f32 v56, v56
    v_rcp_f32 v57, v57
    v_rcp_f32 v58, v58
    v_rcp_f32 v59, v59
    v_rcp_f32 v60, v60
    v_rcp_f32 v61, v61
    v_rcp_f32 v62, v62
    v_rcp_f32 v63, v63
    v_rcp_f32 v64, v64
    v_rcp_f32 v65, v65
    v_rcp_f32 v66, v66
    v_rcp_f32 v67, v67
    v_pk_mul_f32 v[12:13], v[12:13], v[40:41]
    v_pk_mul_f32 v[14:15], v[14:15], v[42:43]
    v_pk_mul_f32 v[16:17], v[16:17], v[44:45]
    v_pk_mul_f32 v[18:19], v[18:19], v[46:47]
    v_pk_mul_f32 v[20:21], v[20:21], v[48:49]
    v_pk_mul_f32 v[22:23], v[22:23], v[50:51]
    v_pk_mul_f32 v[24:25], v[24:25], v[52:53]
    v_pk_mul_f32 v[26:27], v[26:27], v[54:55]
    v_pk_mul_f32 v[28:29], v[28:29], v[56:57]
    v_pk_mul_f32 v[30:31], v[30:31], v[58:59]
    v_pk_mul_f32 v[32:33], v[32:33], v[60:61]
    v_pk_mul_f32 v[34:35], v[34:35], v[62:63]
    v_pk_mul_f32 v[36:37], v[36:37], v[64:65]
    v_pk_mul_f32 v[38:39], v[38:39], v[66:67]
    v_pk_mul_f32 v[12:13], v[12:13], v[100:101] op_sel_hi:[1,0]
    v_pk_mul_f32 v[14:15], v[14:15], v[100:101] op_sel_hi:[1,0]
    v_pk_mul_f32 v[16:17], v[16:17], v[100:101] op_sel_hi:[1,0]
    v_pk_mul_f32 v[18:19], v[18:19], v[100:101] op_sel_hi:[1,0]
    v_pk_mul_f32 v[20:21], v[20:21], v[100:101] op_sel_hi:[1,0]
    v_pk_mul_f32 v[22:23], v[22:23], v[100:101] op_sel_hi:[1,0]
    v_pk_mul_f32 v[24:25], v[24:25], v[100:101] op_sel_hi:[1,0]
    v_pk_mul_f32 v[26:27], v[26:27], v[100:101] op_sel_hi:[1,0]
    v_pk_mul_f32 v[28:29], v[28:29], v[100:101] op_sel_hi:[1,0]
    v_pk_mul_f32 v[30:31], v[30:31], v[100:101] op_sel_hi:[1,0]
    v_pk_mul_f32 v[32:33], v[32:33], v[100:101] op_sel_hi:[1,0]
    v_pk_mul_f32 v[34:35], v[34:35], v[100:101] op_sel_hi:[1,0]
    v_pk_mul_f32 v[36:37], v[36:37], v[100:101] op_sel_hi:[1,0]
    v_pk_mul_f32 v[38:39], v[38:39], v[100:101] op_sel_hi:[1,0]
    v_cvt_pk_bf16_f32 v40, v12, v13
    v_cvt_pk_bf16_f32 v41, v14, v15
    v_cvt_pk_bf16_f32 v42, v16, v17
    v_cvt_pk_bf16_f32 v43, v18, v19
    v_cvt_pk_bf16_f32 v44, v20, v21
    v_cvt_pk_bf16_f32 v45, v22, v23
    v_cvt_pk_bf16_f32 v46, v24, v25
    v_cvt_pk_bf16_f32 v47, v26, v27
    v_cvt_pk_bf16_f32 v48, v28, v29
    v_cvt_pk_bf16_f32 v49, v30, v31
    v_cvt_pk_bf16_f32 v50, v32, v33
    v_cvt_pk_bf16_f32 v51, v34, v35
    v_cvt_pk_bf16_f32 v52, v36, v37
    v_cvt_pk_bf16_f32 v53, v38, v39
    s_mul_i32 s8, s47, 55296
    s_lshl_b32 s17, s45, 9
    s_add_u32 s8, s8, s17
    s_add_u32 s8, s8, 8184832
    s_cmp_ge_u32 s45, 105
    s_cbranch_scc1 k2_kernel_sk103
    v_lshrrev_b32 v4, 1, v2
    v_and_b32 v5, 1, v2
    v_lshlrev_b32 v4, 8, v4
    v_lshl_add_u32 v4, v1, 4, v4
    v_permlane16_swap_b32 v40, v42
    v_permlane16_swap_b32 v41, v43
    v_permlane16_swap_b32 v44, v46
    v_permlane16_swap_b32 v45, v47
    v_permlane16_swap_b32 v48, v50
    v_permlane16_swap_b32 v49, v51
    v_lshl_add_u32 v6, v5, 9, v4
    v_lshl_add_u32 v7, v5, 3, v4
    buffer_store_dwordx4 v[40:43], v6, s[28:31], s8 offen offset:0 sc1
    buffer_store_dwordx4 v[44:47], v6, s[28:31], s8 offen offset:1024 sc1
    buffer_store_dwordx4 v[48:51], v6, s[28:31], s8 offen offset:2048 sc1
    buffer_store_dwordx2 v[52:53], v7, s[28:31], s8 offen offset:3072 sc1
    s_branch k2_kernel_sd104
k2_kernel_sk103:
    v_lshrrev_b32 v4, 1, v2
    v_and_b32 v5, 1, v2
    v_lshlrev_b32 v4, 8, v4
    v_lshl_add_u32 v4, v1, 4, v4
    v_permlane16_swap_b32 v40, v42
    v_permlane16_swap_b32 v41, v43
    v_lshl_add_u32 v6, v5, 9, v4
    v_lshl_add_u32 v7, v5, 3, v4
    buffer_store_dwordx4 v[40:43], v6, s[28:31], s8 offen offset:0 sc1
    buffer_store_dwordx2 v[44:45], v7, s[28:31], s8 offen offset:1024 sc1
k2_kernel_sd104:
    s_branch k2_kernel_join96
k2_kernel_ldr95:
    s_cmp_eq_u32 s3, 5
    s_cbranch_scc1 k2_kernel_l106
    s_cmp_eq_u32 s3, 6
    s_cbranch_scc1 k2_kernel_l107
    s_cmp_eq_u32 s3, 7
    s_cbranch_scc1 k2_kernel_l108
k2_kernel_l105:
    v_lshlrev_b32 v10, 4, v0
    s_waitcnt lgkmcnt(0)
    s_mov_b32 s39, 0
    s_mul_i32 s40, s7, 143360
    s_add_u32 s40, s40, 0
    s_mul_i32 s38, s39, 14336
    s_add_u32 s38, s38, s40
    s_add_u32 s20, s10, 24364032
    s_addc_u32 s21, s11, 0
    s_mov_b32 s22, 2293760
    s_mov_b32 s23, 0x20000
    v_lshlrev_b32 v11, 7, v0
    s_mov_b32 s28, s10
    s_mov_b32 s29, s11
    s_mov_b32 s30, 29815808
    s_mov_b32 s31, 0x20000
    s_mov_b32 m0, 0
    s_nop 0
    buffer_load_dwordx4 v10, s[20:23], s38 offen offset:0 lds
    buffer_load_dwordx4 v10, s[20:23], s38 offen offset:1024 lds
    buffer_load_dwordx4 v10, s[20:23], s38 offen offset:2048 lds
    buffer_load_dwordx4 v10, s[20:23], s38 offen offset:3072 lds
    s_add_u32 s38, s38, 14336
    s_add_u32 s39, s39, 1
    s_cmp_eq_u32 s39, 10
    s_cselect_b32 s38, s40, s38
    s_cselect_b32 s39, 0, s39
    s_mov_b32 m0, 14336
    s_nop 0
    buffer_load_dwordx4 v10, s[20:23], s38 offen offset:0 lds
    buffer_load_dwordx4 v10, s[20:23], s38 offen offset:1024 lds
    buffer_load_dwordx4 v10, s[20:23], s38 offen offset:2048 lds
    buffer_load_dwordx4 v10, s[20:23], s38 offen offset:3072 lds
    s_add_u32 s38, s38, 14336
    s_add_u32 s39, s39, 1
    s_cmp_eq_u32 s39, 10
    s_cselect_b32 s38, s40, s38
    s_cselect_b32 s39, 0, s39
    s_mov_b32 m0, 28672
    s_nop 0
    buffer_load_dwordx4 v10, s[20:23], s38 offen offset:0 lds
    buffer_load_dwordx4 v10, s[20:23], s38 offen offset:1024 lds
    buffer_load_dwordx4 v10, s[20:23], s38 offen offset:2048 lds
    buffer_load_dwordx4 v10, s[20:23], s38 offen offset:3072 lds
    s_add_u32 s38, s38, 14336
    s_add_u32 s39, s39, 1
    s_cmp_eq_u32 s39, 10
    s_cselect_b32 s38, s40, s38
    s_cselect_b32 s39, 0, s39
    s_mov_b32 m0, 43008
    s_nop 0
    buffer_load_dwordx4 v10, s[20:23], s38 offen offset:0 lds
    buffer_load_dwordx4 v10, s[20:23], s38 offen offset:1024 lds
    buffer_load_dwordx4 v10, s[20:23], s38 offen offset:2048 lds
    buffer_load_dwordx4 v10, s[20:23], s38 offen offset:3072 lds
    s_add_u32 s38, s38, 14336
    s_add_u32 s39, s39, 1
    s_cmp_eq_u32 s39, 10
    s_cselect_b32 s38, s40, s38
    s_cselect_b32 s39, 0, s39
    v_mov_b32 v40, 0x3f803f80
    v_mov_b32 v41, 0x3f803f80
    v_mov_b32 v42, 0x3f803f80
    v_mov_b32 v43, 0x3f803f80
    v_mov_b32 v32, 0
    v_mov_b32 v33, 0
    v_mov_b32 v34, 0
    v_mov_b32 v35, 0
    v_mov_b32 v36, 0
    v_mov_b32 v37, 0
    v_mov_b32 v38, 0
    v_mov_b32 v39, 0
    s_barrier
    s_waitcnt vmcnt(12)
    s_barrier
    v_add_u32 v44, 0, v10
    ds_read_b128 v[16:19], v44 offset:0
    ds_read_b128 v[20:23], v44 offset:7168
    ds_read_b128 v[24:27], v44 offset:4096
    ds_read_b128 v[28:31], v44 offset:11264
    s_waitcnt lgkmcnt(0)
    v_mfma_f32_16x16x32_bf16 v[32:35], v[16:19], v[40:43], v[32:35]
    v_mfma_f32_16x16x32_bf16 v[36:39], v[24:27], v[40:43], v[36:39]
    v_mfma_f32_16x16x32_bf16 v[32:35], v[20:23], v[40:43], v[32:35]
    v_mfma_f32_16x16x32_bf16 v[36:39], v[28:31], v[40:43], v[36:39]
    s_waitcnt vmcnt(8)
    s_barrier
    v_add_u32 v44, 14336, v10
    ds_read_b128 v[16:19], v44 offset:0
    ds_read_b128 v[20:23], v44 offset:7168
    ds_read_b128 v[24:27], v44 offset:4096
    ds_read_b128 v[28:31], v44 offset:11264
    s_waitcnt lgkmcnt(0)
    v_mfma_f32_16x16x32_bf16 v[32:35], v[16:19], v[40:43], v[32:35]
    v_mfma_f32_16x16x32_bf16 v[36:39], v[24:27], v[40:43], v[36:39]
    v_mfma_f32_16x16x32_bf16 v[32:35], v[20:23], v[40:43], v[32:35]
    v_mfma_f32_16x16x32_bf16 v[36:39], v[28:31], v[40:43], v[36:39]
    s_mov_b32 s37, 0
    s_mov_b32 s46, 28672
    s_mov_b32 s36, 2
k2_kernel_ll110:
    s_waitcnt vmcnt(4)
    s_barrier
    s_add_u32 m0, s37, 0
    s_nop 0
    buffer_load_dwordx4 v10, s[20:23], s38 offen offset:0 lds
    buffer_load_dwordx4 v10, s[20:23], s38 offen offset:1024 lds
    buffer_load_dwordx4 v10, s[20:23], s38 offen offset:2048 lds
    buffer_load_dwordx4 v10, s[20:23], s38 offen offset:3072 lds
    s_add_u32 s38, s38, 14336
    s_add_u32 s39, s39, 1
    s_cmp_eq_u32 s39, 10
    s_cselect_b32 s38, s40, s38
    s_cselect_b32 s39, 0, s39
    v_add_u32 v44, s46, v10
    ds_read_b128 v[16:19], v44 offset:0
    ds_read_b128 v[20:23], v44 offset:7168
    ds_read_b128 v[24:27], v44 offset:4096
    ds_read_b128 v[28:31], v44 offset:11264
    s_waitcnt lgkmcnt(0)
    v_mfma_f32_16x16x32_bf16 v[32:35], v[16:19], v[40:43], v[32:35]
    v_mfma_f32_16x16x32_bf16 v[36:39], v[24:27], v[40:43], v[36:39]
    v_mfma_f32_16x16x32_bf16 v[32:35], v[20:23], v[40:43], v[32:35]
    v_mfma_f32_16x16x32_bf16 v[36:39], v[28:31], v[40:43], v[36:39]
    s_add_u32 s37, s37, 14336
    s_cmp_eq_u32 s37, 57344
    s_cselect_b32 s37, 0, s37
    s_add_u32 s46, s46, 14336
    s_cmp_eq_u32 s46, 57344
    s_cselect_b32 s46, 0, s46
    s_add_u32 s36, s36, 1
    s_cmp_le_u32 s36, 7
    s_cbranch_scc1 k2_kernel_ll110
    s_waitcnt vmcnt(4)
    s_barrier
    v_add_u32 v44, s46, v10
    ds_read_b128 v[16:19], v44 offset:0
    ds_read_b128 v[20:23], v44 offset:7168
    ds_read_b128 v[24:27], v44 offset:4096
    ds_read_b128 v[28:31], v44 offset:11264
    s_waitcnt lgkmcnt(0)
    v_mfma_f32_16x16x32_bf16 v[32:35], v[16:19], v[40:43], v[32:35]
    v_mfma_f32_16x16x32_bf16 v[36:39], v[24:27], v[40:43], v[36:39]
    v_mfma_f32_16x16x32_bf16 v[32:35], v[20:23], v[40:43], v[32:35]
    v_mfma_f32_16x16x32_bf16 v[36:39], v[28:31], v[40:43], v[36:39]
    s_add_u32 s46, s46, 14336
    s_cmp_eq_u32 s46, 57344
    s_cselect_b32 s46, 0, s46
    s_waitcnt vmcnt(0)
    s_barrier
    v_add_u32 v44, s46, v10
    ds_read_b128 v[16:19], v44 offset:0
    ds_read_b128 v[20:23], v44 offset:7168
    ds_read_b128 v[24:27], v44 offset:4096
    ds_read_b128 v[28:31], v44 offset:11264
    s_waitcnt lgkmcnt(0)
    v_mfma_f32_16x16x32_bf16 v[32:35], v[16:19], v[40:43], v[32:35]
    v_mfma_f32_16x16x32_bf16 v[36:39], v[24:27], v[40:43], v[36:39]
    v_mfma_f32_16x16x32_bf16 v[32:35], v[20:23], v[40:43], v[32:35]
    v_mfma_f32_16x16x32_bf16 v[36:39], v[28:31], v[40:43], v[36:39]
    s_nop 7
    v_lshlrev_b32 v4, 4, v2
    v_add_u32 v4, 57344, v4
    s_mov_b32 s50, 0x00010001
    s_mov_b32 s51, 0x00010001
    s_mov_b64 exec, s[50:51]
    ds_write_b128 v4, v[32:35] offset:0
    ds_write_b128 v4, v[36:39] offset:256
    s_mov_b64 exec, -1
    s_waitcnt lgkmcnt(0)
    s_branch k2_kernel_lfin109
k2_kernel_l106:
    v_lshlrev_b32 v10, 4, v0
    s_waitcnt lgkmcnt(0)
    s_mov_b32 s39, 0
    s_mul_i32 s40, s7, 143360
    s_add_u32 s40, s40, 4096
    s_mul_i32 s38, s39, 14336
    s_add_u32 s38, s38, s40
    s_add_u32 s20, s10, 24364032
    s_addc_u32 s21, s11, 0
    s_mov_b32 s22, 2293760
    s_mov_b32 s23, 0x20000
    v_lshlrev_b32 v11, 7, v0
    s_mov_b32 s28, s10
    s_mov_b32 s29, s11
    s_mov_b32 s30, 29815808
    s_mov_b32 s31, 0x20000
    s_mov_b32 m0, 4096
    s_nop 0
    buffer_load_dwordx4 v10, s[20:23], s38 offen offset:0 lds
    buffer_load_dwordx4 v10, s[20:23], s38 offen offset:1024 lds
    buffer_load_dwordx4 v10, s[20:23], s38 offen offset:2048 lds
    buffer_load_dwordx4 v10, s[20:23], s38 offen offset:3072 lds
    s_add_u32 s38, s38, 14336
    s_add_u32 s39, s39, 1
    s_cmp_eq_u32 s39, 10
    s_cselect_b32 s38, s40, s38
    s_cselect_b32 s39, 0, s39
    s_mov_b32 m0, 18432
    s_nop 0
    buffer_load_dwordx4 v10, s[20:23], s38 offen offset:0 lds
    buffer_load_dwordx4 v10, s[20:23], s38 offen offset:1024 lds
    buffer_load_dwordx4 v10, s[20:23], s38 offen offset:2048 lds
    buffer_load_dwordx4 v10, s[20:23], s38 offen offset:3072 lds
    s_add_u32 s38, s38, 14336
    s_add_u32 s39, s39, 1
    s_cmp_eq_u32 s39, 10
    s_cselect_b32 s38, s40, s38
    s_cselect_b32 s39, 0, s39
    s_mov_b32 m0, 32768
    s_nop 0
    buffer_load_dwordx4 v10, s[20:23], s38 offen offset:0 lds
    buffer_load_dwordx4 v10, s[20:23], s38 offen offset:1024 lds
    buffer_load_dwordx4 v10, s[20:23], s38 offen offset:2048 lds
    buffer_load_dwordx4 v10, s[20:23], s38 offen offset:3072 lds
    s_add_u32 s38, s38, 14336
    s_add_u32 s39, s39, 1
    s_cmp_eq_u32 s39, 10
    s_cselect_b32 s38, s40, s38
    s_cselect_b32 s39, 0, s39
    s_mov_b32 m0, 47104
    s_nop 0
    buffer_load_dwordx4 v10, s[20:23], s38 offen offset:0 lds
    buffer_load_dwordx4 v10, s[20:23], s38 offen offset:1024 lds
    buffer_load_dwordx4 v10, s[20:23], s38 offen offset:2048 lds
    buffer_load_dwordx4 v10, s[20:23], s38 offen offset:3072 lds
    s_add_u32 s38, s38, 14336
    s_add_u32 s39, s39, 1
    s_cmp_eq_u32 s39, 10
    s_cselect_b32 s38, s40, s38
    s_cselect_b32 s39, 0, s39
    v_mov_b32 v40, 0x3f803f80
    v_mov_b32 v41, 0x3f803f80
    v_mov_b32 v42, 0x3f803f80
    v_mov_b32 v43, 0x3f803f80
    v_mov_b32 v32, 0
    v_mov_b32 v33, 0
    v_mov_b32 v34, 0
    v_mov_b32 v35, 0
    v_mov_b32 v36, 0
    v_mov_b32 v37, 0
    v_mov_b32 v38, 0
    v_mov_b32 v39, 0
    s_barrier
    s_waitcnt vmcnt(12)
    s_barrier
    v_add_u32 v44, 0, v10
    ds_read_b128 v[16:19], v44 offset:1024
    ds_read_b128 v[20:23], v44 offset:8192
    ds_read_b128 v[24:27], v44 offset:5120
    ds_read_b128 v[28:31], v44 offset:12288
    s_waitcnt lgkmcnt(0)
    v_mfma_f32_16x16x32_bf16 v[32:35], v[16:19], v[40:43], v[32:35]
    v_mfma_f32_16x16x32_bf16 v[36:39], v[24:27], v[40:43], v[36:39]
    v_mfma_f32_16x16x32_bf16 v[32:35], v[20:23], v[40:43], v[32:35]
    v_mfma_f32_16x16x32_bf16 v[36:39], v[28:31], v[40:43], v[36:39]
    s_waitcnt vmcnt(8)
    s_barrier
    v_add_u32 v44, 14336, v10
    ds_read_b128 v[16:19], v44 offset:1024
    ds_read_b128 v[20:23], v44 offset:8192
    ds_read_b128 v[24:27], v44 offset:5120
    ds_read_b128 v[28:31], v44 offset:12288
    s_waitcnt lgkmcnt(0)
    v_mfma_f32_16x16x32_bf16 v[32:35], v[16:19], v[40:43], v[32:35]
    v_mfma_f32_16x16x32_bf16 v[36:39], v[24:27], v[40:43], v[36:39]
    v_mfma_f32_16x16x32_bf16 v[32:35], v[20:23], v[40:43], v[32:35]
    v_mfma_f32_16x16x32_bf16 v[36:39], v[28:31], v[40:43], v[36:39]
    s_mov_b32 s37, 0
    s_mov_b32 s46, 28672
    s_mov_b32 s36, 2
k2_kernel_ll111:
    s_waitcnt vmcnt(4)
    s_barrier
    s_add_u32 m0, s37, 4096
    s_nop 0
    buffer_load_dwordx4 v10, s[20:23], s38 offen offset:0 lds
    buffer_load_dwordx4 v10, s[20:23], s38 offen offset:1024 lds
    buffer_load_dwordx4 v10, s[20:23], s38 offen offset:2048 lds
    buffer_load_dwordx4 v10, s[20:23], s38 offen offset:3072 lds
    s_add_u32 s38, s38, 14336
    s_add_u32 s39, s39, 1
    s_cmp_eq_u32 s39, 10
    s_cselect_b32 s38, s40, s38
    s_cselect_b32 s39, 0, s39
    v_add_u32 v44, s46, v10
    ds_read_b128 v[16:19], v44 offset:1024
    ds_read_b128 v[20:23], v44 offset:8192
    ds_read_b128 v[24:27], v44 offset:5120
    ds_read_b128 v[28:31], v44 offset:12288
    s_waitcnt lgkmcnt(0)
    v_mfma_f32_16x16x32_bf16 v[32:35], v[16:19], v[40:43], v[32:35]
    v_mfma_f32_16x16x32_bf16 v[36:39], v[24:27], v[40:43], v[36:39]
    v_mfma_f32_16x16x32_bf16 v[32:35], v[20:23], v[40:43], v[32:35]
    v_mfma_f32_16x16x32_bf16 v[36:39], v[28:31], v[40:43], v[36:39]
    s_add_u32 s37, s37, 14336
    s_cmp_eq_u32 s37, 57344
    s_cselect_b32 s37, 0, s37
    s_add_u32 s46, s46, 14336
    s_cmp_eq_u32 s46, 57344
    s_cselect_b32 s46, 0, s46
    s_add_u32 s36, s36, 1
    s_cmp_le_u32 s36, 7
    s_cbranch_scc1 k2_kernel_ll111
    s_waitcnt vmcnt(4)
    s_barrier
    v_add_u32 v44, s46, v10
    ds_read_b128 v[16:19], v44 offset:1024
    ds_read_b128 v[20:23], v44 offset:8192
    ds_read_b128 v[24:27], v44 offset:5120
    ds_read_b128 v[28:31], v44 offset:12288
    s_waitcnt lgkmcnt(0)
    v_mfma_f32_16x16x32_bf16 v[32:35], v[16:19], v[40:43], v[32:35]
    v_mfma_f32_16x16x32_bf16 v[36:39], v[24:27], v[40:43], v[36:39]
    v_mfma_f32_16x16x32_bf16 v[32:35], v[20:23], v[40:43], v[32:35]
    v_mfma_f32_16x16x32_bf16 v[36:39], v[28:31], v[40:43], v[36:39]
    s_add_u32 s46, s46, 14336
    s_cmp_eq_u32 s46, 57344
    s_cselect_b32 s46, 0, s46
    s_waitcnt vmcnt(0)
    s_barrier
    v_add_u32 v44, s46, v10
    ds_read_b128 v[16:19], v44 offset:1024
    ds_read_b128 v[20:23], v44 offset:8192
    ds_read_b128 v[24:27], v44 offset:5120
    ds_read_b128 v[28:31], v44 offset:12288
    s_waitcnt lgkmcnt(0)
    v_mfma_f32_16x16x32_bf16 v[32:35], v[16:19], v[40:43], v[32:35]
    v_mfma_f32_16x16x32_bf16 v[36:39], v[24:27], v[40:43], v[36:39]
    v_mfma_f32_16x16x32_bf16 v[32:35], v[20:23], v[40:43], v[32:35]
    v_mfma_f32_16x16x32_bf16 v[36:39], v[28:31], v[40:43], v[36:39]
    s_nop 7
    v_lshlrev_b32 v4, 4, v2
    v_add_u32 v4, 57344, v4
    s_mov_b32 s50, 0x00010001
    s_mov_b32 s51, 0x00010001
    s_mov_b64 exec, s[50:51]
    ds_write_b128 v4, v[32:35] offset:64
    ds_write_b128 v4, v[36:39] offset:320
    s_mov_b64 exec, -1
    s_waitcnt lgkmcnt(0)
    s_branch k2_kernel_lfin109
k2_kernel_l107:
    v_lshlrev_b32 v10, 4, v0
    s_waitcnt lgkmcnt(0)
    s_mov_b32 s39, 0
    s_mul_i32 s40, s7, 143360
    s_add_u32 s40, s40, 8192
    s_mul_i32 s38, s39, 14336
    s_add_u32 s38, s38, s40
    s_add_u32 s20, s10, 24364032
    s_addc_u32 s21, s11, 0
    s_mov_b32 s22, 2293760
    s_mov_b32 s23, 0x20000
    v_lshlrev_b32 v11, 7, v0
    s_mov_b32 s28, s10
    s_mov_b32 s29, s11
    s_mov_b32 s30, 29815808
    s_mov_b32 s31, 0x20000
    s_mov_b32 m0, 8192
    s_nop 0
    buffer_load_dwordx4 v10, s[20:23], s38 offen offset:0 lds
    buffer_load_dwordx4 v10, s[20:23], s38 offen offset:1024 lds
    buffer_load_dwordx4 v10, s[20:23], s38 offen offset:2048 lds
    s_add_u32 s38, s38, 14336
    s_add_u32 s39, s39, 1
    s_cmp_eq_u32 s39, 10
    s_cselect_b32 s38, s40, s38
    s_cselect_b32 s39, 0, s39
    s_mov_b32 m0, 22528
    s_nop 0
    buffer_load_dwordx4 v10, s[20:23], s38 offen offset:0 lds
    buffer_load_dwordx4 v10, s[20:23], s38 offen offset:1024 lds
    buffer_load_dwordx4 v10, s[20:23], s38 offen offset:2048 lds
    s_add_u32 s38, s38, 14336
    s_add_u32 s39, s39, 1
    s_cmp_eq_u32 s39, 10
    s_cselect_b32 s38, s40, s38
    s_cselect_b32 s39, 0, s39
    s_mov_b32 m0, 36864
    s_nop 0
    buffer_load_dwordx4 v10, s[20:23], s38 offen offset:0 lds
    buffer_load_dwordx4 v10, s[20:23], s38 offen offset:1024 lds
    buffer_load_dwordx4 v10, s[20:23], s38 offen offset:2048 lds
    s_add_u32 s38, s38, 14336
    s_add_u32 s39, s39, 1
    s_cmp_eq_u32 s39, 10
    s_cselect_b32 s38, s40, s38
    s_cselect_b32 s39, 0, s39
    s_mov_b32 m0, 51200
    s_nop 0
    buffer_load_dwordx4 v10, s[20:23], s38 offen offset:0 lds
    buffer_load_dwordx4 v10, s[20:23], s38 offen offset:1024 lds
    buffer_load_dwordx4 v10, s[20:23], s38 offen offset:2048 lds
    s_add_u32 s38, s38, 14336
    s_add_u32 s39, s39, 1
    s_cmp_eq_u32 s39, 10
    s_cselect_b32 s38, s40, s38
    s_cselect_b32 s39, 0, s39
    v_mov_b32 v40, 0x3f803f80
    v_mov_b32 v41, 0x3f803f80
    v_mov_b32 v42, 0x3f803f80
    v_mov_b32 v43, 0x3f803f80
    v_mov_b32 v32, 0
    v_mov_b32 v33, 0
    v_mov_b32 v34, 0
    v_mov_b32 v35, 0
    v_mov_b32 v36, 0
    v_mov_b32 v37, 0
    v_mov_b32 v38, 0
    v_mov_b32 v39, 0
    s_barrier
    s_waitcnt vmcnt(9)
    s_barrier
    v_add_u32 v44, 0, v10
    ds_read_b128 v[16:19], v44 offset:2048
    ds_read_b128 v[20:23], v44 offset:9216
    ds_read_b128 v[24:27], v44 offset:6144
    ds_read_b128 v[28:31], v44 offset:13312
    s_waitcnt lgkmcnt(0)
    v_mfma_f32_16x16x32_bf16 v[32:35], v[16:19], v[40:43], v[32:35]
    v_mfma_f32_16x16x32_bf16 v[36:39], v[24:27], v[40:43], v[36:39]
    v_mfma_f32_16x16x32_bf16 v[32:35], v[20:23], v[40:43], v[32:35]
    v_mfma_f32_16x16x32_bf16 v[36:39], v[28:31], v[40:43], v[36:39]
    s_waitcnt vmcnt(6)
    s_barrier
    v_add_u32 v44, 14336, v10
    ds_read_b128 v[16:19], v44 offset:2048
    ds_read_b128 v[20:23], v44 offset:9216
    ds_read_b128 v[24:27], v44 offset:6144
    ds_read_b128 v[28:31], v44 offset:13312
    s_waitcnt lgkmcnt(0)
    v_mfma_f32_16x16x32_bf16 v[32:35], v[16:19], v[40:43], v[32:35]
    v_mfma_f32_16x16x32_bf16 v[36:39], v[24:27], v[40:43], v[36:39]
    v_mfma_f32_16x16x32_bf16 v[32:35], v[20:23], v[40:43], v[32:35]
    v_mfma_f32_16x16x32_bf16 v[36:39], v[28:31], v[40:43], v[36:39]
    s_mov_b32 s37, 0
    s_mov_b32 s46, 28672
    s_mov_b32 s36, 2
k2_kernel_ll112:
    s_waitcnt vmcnt(3)
    s_barrier
    s_add_u32 m0, s37, 8192
    s_nop 0
    buffer_load_dwordx4 v10, s[20:23], s38 offen offset:0 lds
    buffer_load_dwordx4 v10, s[20:23], s38 offen offset:1024 lds
    buffer_load_dwordx4 v10, s[20:23], s38 offen offset:2048 lds
    s_add_u32 s38, s38, 14336
    s_add_u32 s39, s39, 1
    s_cmp_eq_u32 s39, 10
    s_cselect_b32 s38, s40, s38
    s_cselect_b32 s39, 0, s39
    v_add_u32 v44, s46, v10
    ds_read_b128 v[16:19], v44 offset:2048
    ds_read_b128 v[20:23], v44 offset:9216
    ds_read_b128 v[24:27], v44 offset:6144
    ds_read_b128 v[28:31], v44 offset:13312
    s_waitcnt lgkmcnt(0)
    v_mfma_f32_16x16x32_bf16 v[32:35], v[16:19], v[40:43], v[32:35]
    v_mfma_f32_16x16x32_bf16 v[36:39], v[24:27], v[40:43], v[36:39]
    v_mfma_f32_16x16x32_bf16 v[32:35], v[20:23], v[40:43], v[32:35]
    v_mfma_f32_16x16x32_bf16 v[36:39], v[28:31], v[40:43], v[36:39]
    s_add_u32 s37, s37, 14336
    s_cmp_eq_u32 s37, 57344
    s_cselect_b32 s37, 0, s37
    s_add_u32 s46, s46, 14336
    s_cmp_eq_u32 s46, 57344
    s_cselect_b32 s46, 0, s46
    s_add_u32 s36, s36, 1
    s_cmp_le_u32 s36, 7
    s_cbranch_scc1 k2_kernel_ll112
    s_waitcnt vmcnt(3)
    s_barrier
    v_add_u32 v44, s46, v10
    ds_read_b128 v[16:19], v44 offset:2048
    ds_read_b128 v[20:23], v44 offset:9216
    ds_read_b128 v[24:27], v44 offset:6144
    ds_read_b128 v[28:31], v44 offset:13312
    s_waitcnt lgkmcnt(0)
    v_mfma_f32_16x16x32_bf16 v[32:35], v[16:19], v[40:43], v[32:35]
    v_mfma_f32_16x16x32_bf16 v[36:39], v[24:27], v[40:43], v[36:39]
    v_mfma_f32_16x16x32_bf16 v[32:35], v[20:23], v[40:43], v[32:35]
    v_mfma_f32_16x16x32_bf16 v[36:39], v[28:31], v[40:43], v[36:39]
    s_add_u32 s46, s46, 14336
    s_cmp_eq_u32 s46, 57344
    s_cselect_b32 s46, 0, s46
    s_waitcnt vmcnt(0)
    s_barrier
    v_add_u32 v44, s46, v10
    ds_read_b128 v[16:19], v44 offset:2048
    ds_read_b128 v[20:23], v44 offset:9216
    ds_read_b128 v[24:27], v44 offset:6144
    ds_read_b128 v[28:31], v44 offset:13312
    s_waitcnt lgkmcnt(0)
    v_mfma_f32_16x16x32_bf16 v[32:35], v[16:19], v[40:43], v[32:35]
    v_mfma_f32_16x16x32_bf16 v[36:39], v[24:27], v[40:43], v[36:39]
    v_mfma_f32_16x16x32_bf16 v[32:35], v[20:23], v[40:43], v[32:35]
    v_mfma_f32_16x16x32_bf16 v[36:39], v[28:31], v[40:43], v[36:39]
    s_nop 7
    v_lshlrev_b32 v4, 4, v2
    v_add_u32 v4, 57344, v4
    s_mov_b32 s50, 0x00010001
    s_mov_b32 s51, 0x00010001
    s_mov_b64 exec, s[50:51]
    ds_write_b128 v4, v[32:35] offset:128
    ds_write_b128 v4, v[36:39] offset:384
    s_mov_b64 exec, -1
    s_waitcnt lgkmcnt(0)
    s_branch k2_kernel_lfin109
k2_kernel_l108:
    v_lshlrev_b32 v10, 4, v0
    s_waitcnt lgkmcnt(0)
    s_mov_b32 s39, 0
    s_mul_i32 s40, s7, 143360
    s_add_u32 s40, s40, 11264
    s_mul_i32 s38, s39, 14336
    s_add_u32 s38, s38, s40
    s_add_u32 s20, s10, 24364032
    s_addc_u32 s21, s11, 0
    s_mov_b32 s22, 2293760
    s_mov_b32 s23, 0x20000
    v_lshlrev_b32 v11, 7, v0
    s_mov_b32 s28, s10
    s_mov_b32 s29, s11
    s_mov_b32 s30, 29815808
    s_mov_b32 s31, 0x20000
    s_mov_b32 m0, 11264
    s_nop 0
    buffer_load_dwordx4 v10, s[20:23], s38 offen offset:0 lds
    buffer_load_dwordx4 v10, s[20:23], s38 offen offset:1024 lds
    buffer_load_dwordx4 v10, s[20:23], s38 offen offset:2048 lds
    s_add_u32 s38, s38, 14336
    s_add_u32 s39, s39, 1
    s_cmp_eq_u32 s39, 10
    s_cselect_b32 s38, s40, s38
    s_cselect_b32 s39, 0, s39
    s_mov_b32 m0, 25600
    s_nop 0
    buffer_load_dwordx4 v10, s[20:23], s38 offen offset:0 lds
    buffer_load_dwordx4 v10, s[20:23], s38 offen offset:1024 lds
    buffer_load_dwordx4 v10, s[20:23], s38 offen offset:2048 lds
    s_add_u32 s38, s38, 14336
    s_add_u32 s39, s39, 1
    s_cmp_eq_u32 s39, 10
    s_cselect_b32 s38, s40, s38
    s_cselect_b32 s39, 0, s39
    s_mov_b32 m0, 39936
    s_nop 0
    buffer_load_dwordx4 v10, s[20:23], s38 offen offset:0 lds
    buffer_load_dwordx4 v10, s[20:23], s38 offen offset:1024 lds
    buffer_load_dwordx4 v10, s[20:23], s38 offen offset:2048 lds
    s_add_u32 s38, s38, 14336
    s_add_u32 s39, s39, 1
    s_cmp_eq_u32 s39, 10
    s_cselect_b32 s38, s40, s38
    s_cselect_b32 s39, 0, s39
    s_mov_b32 m0, 54272
    s_nop 0
    buffer_load_dwordx4 v10, s[20:23], s38 offen offset:0 lds
    buffer_load_dwordx4 v10, s[20:23], s38 offen offset:1024 lds
    buffer_load_dwordx4 v10, s[20:23], s38 offen offset:2048 lds
    s_add_u32 s38, s38, 14336
    s_add_u32 s39, s39, 1
    s_cmp_eq_u32 s39, 10
    s_cselect_b32 s38, s40, s38
    s_cselect_b32 s39, 0, s39
    v_mov_b32 v28, 0x3f803f80
    v_mov_b32 v29, 0x3f803f80
    v_mov_b32 v30, 0x3f803f80
    v_mov_b32 v31, 0x3f803f80
    v_mov_b32 v24, 0
    v_mov_b32 v25, 0
    v_mov_b32 v26, 0
    v_mov_b32 v27, 0
    s_barrier
    s_waitcnt vmcnt(9)
    s_barrier
    v_add_u32 v32, 0, v10
    ds_read_b128 v[16:19], v32 offset:3072
    ds_read_b128 v[20:23], v32 offset:10240
    s_waitcnt lgkmcnt(0)
    v_mfma_f32_16x16x32_bf16 v[24:27], v[16:19], v[28:31], v[24:27]
    v_mfma_f32_16x16x32_bf16 v[24:27], v[20:23], v[28:31], v[24:27]
    s_waitcnt vmcnt(6)
    s_barrier
    v_add_u32 v32, 14336, v10
    ds_read_b128 v[16:19], v32 offset:3072
    ds_read_b128 v[20:23], v32 offset:10240
    s_waitcnt lgkmcnt(0)
    v_mfma_f32_16x16x32_bf16 v[24:27], v[16:19], v[28:31], v[24:27]
    v_mfma_f32_16x16x32_bf16 v[24:27], v[20:23], v[28:31], v[24:27]
    s_mov_b32 s37, 0
    s_mov_b32 s46, 28672
    s_mov_b32 s36, 2
k2_kernel_ll113:
    s_waitcnt vmcnt(3)
    s_barrier
    s_add_u32 m0, s37, 11264
    s_nop 0
    buffer_load_dwordx4 v10, s[20:23], s38 offen offset:0 lds
    buffer_load_dwordx4 v10, s[20:23], s38 offen offset:1024 lds
    buffer_load_dwordx4 v10, s[20:23], s38 offen offset:2048 lds
    s_add_u32 s38, s38, 14336
    s_add_u32 s39, s39, 1
    s_cmp_eq_u32 s39, 10
    s_cselect_b32 s38, s40, s38
    s_cselect_b32 s39, 0, s39
    v_add_u32 v32, s46, v10
    ds_read_b128 v[16:19], v32 offset:3072
    ds_read_b128 v[20:23], v32 offset:10240
    s_waitcnt lgkmcnt(0)
    v_mfma_f32_16x16x32_bf16 v[24:27], v[16:19], v[28:31], v[24:27]
    v_mfma_f32_16x16x32_bf16 v[24:27], v[20:23], v[28:31], v[24:27]
    s_add_u32 s37, s37, 14336
    s_cmp_eq_u32 s37, 57344
    s_cselect_b32 s37, 0, s37
    s_add_u32 s46, s46, 14336
    s_cmp_eq_u32 s46, 57344
    s_cselect_b32 s46, 0, s46
    s_add_u32 s36, s36, 1
    s_cmp_le_u32 s36, 7
    s_cbranch_scc1 k2_kernel_ll113
    s_waitcnt vmcnt(3)
    s_barrier
    v_add_u32 v32, s46, v10
    ds_read_b128 v[16:19], v32 offset:3072
    ds_read_b128 v[20:23], v32 offset:10240
    s_waitcnt lgkmcnt(0)
    v_mfma_f32_16x16x32_bf16 v[24:27], v[16:19], v[28:31], v[24:27]
    v_mfma_f32_16x16x32_bf16 v[24:27], v[20:23], v[28:31], v[24:27]
    s_add_u32 s46, s46, 14336
    s_cmp_eq_u32 s46, 57344
    s_cselect_b32 s46, 0, s46
    s_waitcnt vmcnt(0)
    s_barrier
    v_add_u32 v32, s46, v10
    ds_read_b128 v[16:19], v32 offset:3072
    ds_read_b128 v[20:23], v32 offset:10240
    s_waitcnt lgkmcnt(0)
    v_mfma_f32_16x16x32_bf16 v[24:27], v[16:19], v[28:31], v[24:27]
    v_mfma_f32_16x16x32_bf16 v[24:27], v[20:23], v[28:31], v[24:27]
    s_nop 7
    v_lshlrev_b32 v4, 4, v2
    v_add_u32 v4, 57344, v4
    s_mov_b32 s50, 0x00010001
    s_mov_b32 s51, 0x00010001
    s_mov_b64 exec, s[50:51]
    ds_write_b128 v4, v[24:27] offset:192
    s_mov_b64 exec, -1
    s_waitcnt lgkmcnt(0)
k2_kernel_lfin109:
    s_sub_u32 s8, s3, 4
    s_lshl_b32 s16, s8, 1
    s_lshl_b32 s47, s6, 3
    s_add_u32 s47, s47, s16
    s_add_u32 s47, s47, 1
    s_mul_i32 s45, s7, 7
    s_mov_b32 s28, s10
    s_mov_b32 s29, s11
    s_mov_b32 s30, 29815808
    s_mov_b32 s31, 0x20000
    s_lshl_b32 s8, s47, 6
    s_add_u32 s8, s8, 2802688
    v_lshlrev_b32 v5, 2, v1
    buffer_load_dword v76, v5, s[28:31], s8 offen
    s_lshl_b32 s8, s47, 10
    s_add_u32 s8, s8, 8053760
    v_lshlrev_b32 v4, 6, v1
    v_lshl_add_u32 v4, v2, 4, v4
    buffer_load_dwordx4 v[72:75], v4, s[28:31], s8 offen sc1
    s_sub_u32 s8, s3, 4
    s_mul_i32 s8, s8, 7168
    s_add_u32 s8, s8, 28672
    v_lshlrev_b32 v9, 4, v0
    v_add_u32 v9, s8, v9
    s_barrier
    ds_read_b128 v[12:15], v9 offset:0
    ds_read_b128 v[16:19], v9 offset:1024
    ds_read_b128 v[20:23], v9 offset:2048
    ds_read_b128 v[24:27], v9 offset:3072
    ds_read_b128 v[28:31], v9 offset:4096
    ds_read_b128 v[32:35], v9 offset:5120
    ds_read_b128 v[36:39], v9 offset:6144
    s_waitcnt vmcnt(0) lgkmcnt(0)
    v_lshlrev_b32 v4, 4, v2
    v_add_u32 v4, 57344, v4
    ds_read_b128 v[40:43], v4 offset:0
    ds_read_b128 v[44:47], v4 offset:64
    ds_read_b128 v[48:51], v4 offset:128
    ds_read_b128 v[52:55], v4 offset:192
    ds_read_b128 v[56:59], v4 offset:256
    ds_read_b128 v[60:63], v4 offset:320
    ds_read_b128 v[64:67], v4 offset:384
    v_mov_b32 v68, 0xc0135761
    v_mov_b32 v69, 0xbdd2d3e8
    v_add_f32 v72, v72, v74
    v_add_f32 v73, v73, v75
    v_mov_b32 v5, v72
    v_mov_b32 v6, v72
    s_nop 1
    v_permlane32_swap_b32 v5, v6
    s_nop 1
    v_add_f32 v72, v5, v6
    v_mov_b32 v5, v72
    v_mov_b32 v6, v72
    s_nop 1
    v_permlane16_swap_b32 v5, v6
    s_nop 1
    v_add_f32 v72, v5, v6
    v_mov_b32 v5, v73
    v_mov_b32 v6, v73
    s_nop 1
    v_permlane32_swap_b32 v5, v6
    s_nop 1
    v_add_f32 v73, v5, v6
    v_mov_b32 v5, v73
    v_mov_b32 v6, v73
    s_nop 1
    v_permlane16_swap_b32 v5, v6
    s_nop 1
    v_add_f32 v73, v5, v6
    v_mul_f32 v70, 0x3acccccd, v72
    v_mul_f32 v5, 0x3acccccd, v73
    v_fma_f32 v5, -v70, v70, v5
    v_max_f32 v5, 0, v5
    v_add_f32 v5, 0x3727c5ac, v5
    v_rsq_f32 v71, v5
    s_waitcnt lgkmcnt(0)
    v_mul_f32 v70, v70, v71
    v_sub_f32 v70, 0, v70
    v_sub_f32 v76, 1.0, v76
    v_pk_mul_f32 v[40:41], v[40:41], v[70:71] op_sel_hi:[1,0]
    v_pk_mul_f32 v[42:43], v[42:43], v[70:71] op_sel_hi:[1,0]
    v_pk_mul_f32 v[44:45], v[44:45], v[70:71] op_sel_hi:[1,0]
    v_pk_mul_f32 v[46:47], v[46:47], v[70:71] op_sel_hi:[1,0]
    v_pk_mul_f32 v[48:49], v[48:49], v[70:71] op_sel_hi:[1,0]
    v_pk_mul_f32 v[50:51], v[50:51], v[70:71] op_sel_hi:[1,0]
    v_pk_mul_f32 v[52:53], v[52:53], v[70:71] op_sel_hi:[1,0]
    v_pk_mul_f32 v[54:55], v[54:55], v[70:71] op_sel_hi:[1,0]
    v_pk_mul_f32 v[56:57], v[56:57], v[70:71] op_sel_hi:[1,0]
    v_pk_mul_f32 v[58:59], v[58:59], v[70:71] op_sel_hi:[1,0]
    v_pk_mul_f32 v[60:61], v[60:61], v[70:71] op_sel_hi:[1,0]
    v_pk_mul_f32 v[62:63], v[62:63], v[70:71] op_sel_hi:[1,0]
    v_pk_mul_f32 v[64:65], v[64:65], v[70:71] op_sel_hi:[1,0]
    v_pk_mul_f32 v[66:67], v[66:67], v[70:71] op_sel_hi:[1,0]
    v_pk_fma_f32 v[12:13], v[12:13], v[70:71], v[40:41] op_sel:[0,1,0] op_sel_hi:[1,1,1]
    v_pk_fma_f32 v[14:15], v[14:15], v[70:71], v[42:43] op_sel:[0,1,0] op_sel_hi:[1,1,1]
    v_pk_fma_f32 v[16:17], v[16:17], v[70:71], v[44:45] op_sel:[0,1,0] op_sel_hi:[1,1,1]
    v_pk_fma_f32 v[18:19], v[18:19], v[70:71], v[46:47] op_sel:[0,1,0] op_sel_hi:[1,1,1]
    v_pk_fma_f32 v[20:21], v[20:21], v[70:71], v[48:49] op_sel:[0,1,0] op_sel_hi:[1,1,1]
    v_pk_fma_f32 v[22:23], v[22:23], v[70:71], v[50:51] op_sel:[0,1,0] op_sel_hi:[1,1,1]
    v_pk_fma_f32 v[24:25], v[24:25], v[70:71], v[52:53] op_sel:[0,1,0] op_sel_hi:[1,1,1]
    v_pk_fma_f32 v[26:27], v[26:27], v[70:71], v[54:55] op_sel:[0,1,0] op_sel_hi:[1,1,1]
    v_pk_fma_f32 v[28:29], v[28:29], v[70:71], v[56:57] op_sel:[0,1,0] op_sel_hi:[1,1,1]
    v_pk_fma_f32 v[30:31], v[30:31], v[70:71], v[58:59] op_sel:[0,1,0] op_sel_hi:[1,1,1]
    v_pk_fma_f32 v[32:33], v[32:33], v[70:71], v[60:61] op_sel:[0,1,0] op_sel_hi:[1,1,1]
    v_pk_fma_f32 v[34:35], v[34:35], v[70:71], v[62:63] op_sel:[0,1,0] op_sel_hi:[1,1,1]
    v_pk_fma_f32 v[36:37], v[36:37], v[70:71], v[64:65] op_sel:[0,1,0] op_sel_hi:[1,1,1]
    v_pk_fma_f32 v[38:39], v[38:39], v[70:71], v[66:67] op_sel:[0,1,0] op_sel_hi:[1,1,1]
    v_pk_mul_f32 v[40:41], v[12:13], v[12:13]
    v_pk_mul_f32 v[42:43], v[14:15], v[14:15]
    v_pk_mul_f32 v[44:45], v[16:17], v[16:17]
    v_pk_mul_f32 v[46:47], v[18:19], v[18:19]
    v_pk_mul_f32 v[48:49], v[20:21], v[20:21]
    v_pk_mul_f32 v[50:51], v[22:23], v[22:23]
    v_pk_mul_f32 v[52:53], v[24:25], v[24:25]
    v_pk_mul_f32 v[54:55], v[26:27], v[26:27]
    v_pk_mul_f32 v[56:57], v[28:29], v[28:29]
    v_pk_mul_f32 v[58:59], v[30:31], v[30:31]
    v_pk_mul_f32 v[60:61], v[32:33], v[32:33]
    v_pk_mul_f32 v[62:63], v[34:35], v[34:35]
    v_pk_mul_f32 v[64:65], v[36:37], v[36:37]
    v_pk_mul_f32 v[66:67], v[38:39], v[38:39]
    v_pk_fma_f32 v[40:41], v[40:41], v[68:69], v[68:69] op_sel:[0,1,0] op_sel_hi:[1,1,0]
    v_pk_fma_f32 v[42:43], v[42:43], v[68:69], v[68:69] op_sel:[0,1,0] op_sel_hi:[1,1,0]
    v_pk_fma_f32 v[44:45], v[44:45], v[68:69], v[68:69] op_sel:[0,1,0] op_sel_hi:[1,1,0]
    v_pk_fma_f32 v[46:47], v[46:47], v[68:69], v[68:69] op_sel:[0,1,0] op_sel_hi:[1,1,0]
    v_pk_fma_f32 v[48:49], v[48:49], v[68:69], v[68:69] op_sel:[0,1,0] op_sel_hi:[1,1,0]
    v_pk_fma_f32 v[50:51], v[50:51], v[68:69], v[68:69] op_sel:[0,1,0] op_sel_hi:[1,1,0]
    v_pk_fma_f32 v[52:53], v[52:53], v[68:69], v[68:69] op_sel:[0,1,0] op_sel_hi:[1,1,0]
    v_pk_fma_f32 v[54:55], v[54:55], v[68:69], v[68:69] op_sel:[0,1,0] op_sel_hi:[1,1,0]
    v_pk_fma_f32 v[56:57], v[56:57], v[68:69], v[68:69] op_sel:[0,1,0] op_sel_hi:[1,1,0]
    v_pk_fma_f32 v[58:59], v[58:59], v[68:69], v[68:69] op_sel:[0,1,0] op_sel_hi:[1,1,0]
    v_pk_fma_f32 v[60:61], v[60:61], v[68:69], v[68:69] op_sel:[0,1,0] op_sel_hi:[1,1,0]
    v_pk_fma_f32 v[62:63], v[62:63], v[68:69], v[68:69] op_sel:[0,1,0] op_sel_hi:[1,1,0]
    v_pk_fma_f32 v[64:65], v[64:65], v[68:69], v[68:69] op_sel:[0,1,0] op_sel_hi:[1,1,0]
    v_pk_fma_f32 v[66:67], v[66:67], v[68:69], v[68:69] op_sel:[0,1,0] op_sel_hi:[1,1,0]
    v_pk_mul_f32 v[40:41], v[40:41], v[12:13]
    v_pk_mul_f32 v[42:43], v[42:43], v[14:15]
    v_pk_mul_f32 v[44:45], v[44:45], v[16:17]
    v_pk_mul_f32 v[46:47], v[46:47], v[18:19]
    v_pk_mul_f32 v[48:49], v[48:49], v[20:21]
    v_pk_mul_f32 v[50:51], v[50:51], v[22:23]
    v_pk_mul_f32 v[52:53], v[52:53], v[24:25]
    v_pk_mul_f32 v[54:55], v[54:55], v[26:27]
    v_pk_mul_f32 v[56:57], v[56:57], v[28:29]
    v_pk_mul_f32 v[58:59], v[58:59], v[30:31]
    v_pk_mul_f32 v[60:61], v[60:61], v[32:33]
    v_pk_mul_f32 v[62:63], v[62:63], v[34:35]
    v_pk_mul_f32 v[64:65], v[64:65], v[36:37]
    v_pk_mul_f32 v[66:67], v[66:67], v[38:39]
    v_exp_f32 v40, v40
    v_exp_f32 v41, v41
    v_exp_f32 v42, v42
    v_exp_f32 v43, v43
    v_exp_f32 v44, v44
    v_exp_f32 v45, v45
    v_exp_f32 v46, v46
    v_exp_f32 v47, v47
    v_exp_f32 v48, v48
    v_exp_f32 v49, v49
    v_exp_f32 v50, v50
    v_exp_f32 v51, v51
    v_exp_f32 v52, v52
    v_exp_f32 v53, v53
    v_exp_f32 v54, v54
    v_exp_f32 v55, v55
    v_exp_f32 v56, v56
    v_exp_f32 v57, v57
    v_exp_f32 v58, v58
    v_exp_f32 v59, v59
    v_exp_f32 v60, v60
    v_exp_f32 v61, v61
    v_exp_f32 v62, v62
    v_exp_f32 v63, v63
    v_exp_f32 v64, v64
    v_exp_f32 v65, v65
    v_exp_f32 v66, v66
    v_exp_f32 v67, v67
    v_pk_add_f32 v[40:41], v[40:41], 1.0 op_sel_hi:[1,0]
    v_pk_add_f32 v[42:43], v[42:43], 1.0 op_sel_hi:[1,0]
    v_pk_add_f32 v[44:45], v[44:45], 1.0 op_sel_hi:[1,0]
    v_pk_add_f32 v[46:47], v[46:47], 1.0 op_sel_hi:[1,0]
    v_pk_add_f32 v[48:49], v[48:49], 1.0 op_sel_hi:[1,0]
    v_pk_add_f32 v[50:51], v[50:51], 1.0 op_sel_hi:[1,0]
    v_pk_add_f32 v[52:53], v[52:53], 1.0 op_sel_hi:[1,0]
    v_pk_add_f32 v[54:55], v[54:55], 1.0 op_sel_hi:[1,0]
    v_pk_add_f32 v[56:57], v[56:57], 1.0 op_sel_hi:[1,0]
    v_pk_add_f32 v[58:59], v[58:59], 1.0 op_sel_hi:[1,0]
    v_pk_add_f32 v[60:61], v[60:61], 1.0 op_sel_hi:[1,0]
    v_pk_add_f32 v[62:63], v[62:63], 1.0 op_sel_hi:[1,0]
    v_pk_add_f32 v[64:65], v[64:65], 1.0 op_sel_hi:[1,0]
    v_pk_add_f32 v[66:67], v[66:67], 1.0 op_sel_hi:[1,0]
    v_rcp_f32 v40, v40
    v_rcp_f32 v41, v41
    v_rcp_f32 v42, v42
    v_rcp_f32 v43, v43
    v_rcp_f32 v44, v44
    v_rcp_f32 v45, v45
    v_rcp_f32 v46, v46
    v_rcp_f32 v47, v47
    v_rcp_f32 v48, v48
    v_rcp_f32 v49, v49
    v_rcp_f32 v50, v50
    v_rcp_f32 v51, v51
    v_rcp_f32 v52, v52
    v_rcp_f32 v53, v53
    v_rcp_f32 v54, v54
    v_rcp_f32 v55, v55
    v_rcp_f32 v56, v56
    v_rcp_f32 v57, v57
    v_rcp_f32 v58, v58
    v_rcp_f32 v59, v59
    v_rcp_f32 v60, v60
    v_rcp_f32 v61, v61
    v_rcp_f32 v62, v62
    v_rcp_f32 v63, v63
    v_rcp_f32 v64, v64
    v_rcp_f32 v65, v65
    v_rcp_f32 v66, v66
    v_rcp_f32 v67, v67
    v_pk_mul_f32 v[12:13], v[12:13], v[40:41]
    v_pk_mul_f32 v[14:15], v[14:15], v[42:43]
    v_pk_mul_f32 v[16:17], v[16:17], v[44:45]
    v_pk_mul_f32 v[18:19], v[18:19], v[46:47]
    v_pk_mul_f32 v[20:21], v[20:21], v[48:49]
    v_pk_mul_f32 v[22:23], v[22:23], v[50:51]
    v_pk_mul_f32 v[24:25], v[24:25], v[52:53]
    v_pk_mul_f32 v[26:27], v[26:27], v[54:55]
    v_pk_mul_f32 v[28:29], v[28:29], v[56:57]
    v_pk_mul_f32 v[30:31], v[30:31], v[58:59]
    v_pk_mul_f32 v[32:33], v[32:33], v[60:61]
    v_pk_mul_f32 v[34:35], v[34:35], v[62:63]
    v_pk_mul_f32 v[36:37], v[36:37], v[64:65]
    v_pk_mul_f32 v[38:39], v[38:39], v[66:67]
    v_pk_mul_f32 v[12:13], v[12:13], v[76:77] op_sel_hi:[1,0]
    v_pk_mul_f32 v[14:15], v[14:15], v[76:77] op_sel_hi:[1,0]
    v_pk_mul_f32 v[16:17], v[16:17], v[76:77] op_sel_hi:[1,0]
    v_pk_mul_f32 v[18:19], v[18:19], v[76:77] op_sel_hi:[1,0]
    v_pk_mul_f32 v[20:21], v[20:21], v[76:77] op_sel_hi:[1,0]
    v_pk_mul_f32 v[22:23], v[22:23], v[76:77] op_sel_hi:[1,0]
    v_pk_mul_f32 v[24:25], v[24:25], v[76:77] op_sel_hi:[1,0]
    v_pk_mul_f32 v[26:27], v[26:27], v[76:77] op_sel_hi:[1,0]
    v_pk_mul_f32 v[28:29], v[28:29], v[76:77] op_sel_hi:[1,0]
    v_pk_mul_f32 v[30:31], v[30:31], v[76:77] op_sel_hi:[1,0]
    v_pk_mul_f32 v[32:33], v[32:33], v[76:77] op_sel_hi:[1,0]
    v_pk_mul_f32 v[34:35], v[34:35], v[76:77] op_sel_hi:[1,0]
    v_pk_mul_f32 v[36:37], v[36:37], v[76:77] op_sel_hi:[1,0]
    v_pk_mul_f32 v[38:39], v[38:39], v[76:77] op_sel_hi:[1,0]
    v_cvt_pk_bf16_f32 v40, v12, v13
    v_cvt_pk_bf16_f32 v41, v14, v15
    v_cvt_pk_bf16_f32 v42, v16, v17
    v_cvt_pk_bf16_f32 v43, v18, v19
    v_cvt_pk_bf16_f32 v44, v20, v21
    v_cvt_pk_bf16_f32 v45, v22, v23
    v_cvt_pk_bf16_f32 v46, v24, v25
    v_cvt_pk_bf16_f32 v47, v26, v27
    v_cvt_pk_bf16_f32 v48, v28, v29
    v_cvt_pk_bf16_f32 v49, v30, v31
    v_cvt_pk_bf16_f32 v50, v32, v33
    v_cvt_pk_bf16_f32 v51, v34, v35
    v_cvt_pk_bf16_f32 v52, v36, v37
    v_cvt_pk_bf16_f32 v53, v38, v39
    s_mul_i32 s8, s47, 55296
    s_lshl_b32 s17, s45, 9
    s_add_u32 s8, s8, s17
    s_add_u32 s8, s8, 8184832
    s_cmp_ge_u32 s45, 105
    s_cbranch_scc1 k2_kernel_sk114
    v_lshrrev_b32 v4, 1, v2
    v_and_b32 v5, 1, v2
    v_lshlrev_b32 v4, 8, v4
    v_lshl_add_u32 v4, v1, 4, v4
    v_permlane16_swap_b32 v40, v42
    v_permlane16_swap_b32 v41, v43
    v_permlane16_swap_b32 v44, v46
    v_permlane16_swap_b32 v45, v47
    v_permlane16_swap_b32 v48, v50
    v_permlane16_swap_b32 v49, v51
    v_lshl_add_u32 v6, v5, 9, v4
    v_lshl_add_u32 v7, v5, 3, v4
    buffer_store_dwordx4 v[40:43], v6, s[28:31], s8 offen offset:0 sc1
    buffer_store_dwordx4 v[44:47], v6, s[28:31], s8 offen offset:1024 sc1
    buffer_store_dwordx4 v[48:51], v6, s[28:31], s8 offen offset:2048 sc1
    buffer_store_dwordx2 v[52:53], v7, s[28:31], s8 offen offset:3072 sc1
    s_branch k2_kernel_sd115
k2_kernel_sk114:
    v_lshrrev_b32 v4, 1, v2
    v_and_b32 v5, 1, v2
    v_lshlrev_b32 v4, 8, v4
    v_lshl_add_u32 v4, v1, 4, v4
    v_permlane16_swap_b32 v40, v42
    v_permlane16_swap_b32 v41, v43
    v_lshl_add_u32 v6, v5, 9, v4
    v_lshl_add_u32 v7, v5, 3, v4
    buffer_store_dwordx4 v[40:43], v6, s[28:31], s8 offen offset:0 sc1
    buffer_store_dwordx2 v[44:45], v7, s[28:31], s8 offen offset:1024 sc1
k2_kernel_sd115:
k2_kernel_join96:
    s_waitcnt vmcnt(0)
    s_barrier
    s_cmp_lg_u32 s3, 0
    s_cbranch_scc1 k2_kernel_pub116
    s_lshl_b32 s8, s6, 7
    s_lshl_b32 s16, s7, 2
    s_add_u32 s8, s8, s16
    s_add_u32 s8, s8, 29774848
    v_mov_b32 v4, 0
    v_mov_b32 v5, 1
    s_mov_b64 exec, 1
    buffer_store_dword v5, v4, s[28:31], s8 offen sc1
    s_mov_b64 exec, -1
k2_kernel_pub116:
    s_setprio 0
    s_cmp_ge_u32 s3, 4
    s_cbranch_scc1 k2_kernel_ldr117
    s_lshr_b32 s42, s3, 1
    s_and_b32 s43, s3, 1
    s_lshl_b32 s44, s4, 2
    s_lshl_b32 s8, s42, 1
    s_add_u32 s44, s44, s8
    s_mul_i32 s45, s5, 5
    s_mul_i32 s8, s44, 55296
    v_lshlrev_b32 v4, 8, v2
    v_lshl_add_u32 v4, v1, 4, v4
    v_add_u32 v10, s8, v4
    v_add_u32 v11, 55296, v10
    s_cmp_eq_u32 s43, 0
    s_cbranch_scc1 k2_kernel_sw119
    v_swap_b32 v10, v11
k2_kernel_sw119:
    v_lshlrev_b32 v4, 4, v0
    s_mul_i32 s8, s43, 10240
    v_add_u32 v3, s8, v4
    s_add_u32 s47, s44, s43
    s_waitcnt lgkmcnt(0)
    s_add_u32 s24, s10, 8184832
    s_addc_u32 s25, s11, 0
    s_mov_b32 s26, 7077888
    s_mov_b32 s27, 0x20000
    s_mov_b32 s28, s10
    s_mov_b32 s29, s11
    s_mov_b32 s30, 29815808
    s_mov_b32 s31, 0x20000
    v_lshlrev_b32 v4, 8, v2
    v_lshl_add_u32 v4, v1, 4, v4
    s_mul_i32 s8, s44, 20480
    s_add_u32 s8, s8, 17826816
    v_add_u32 v104, s8, v4
    v_add_u32 v105, 20480, v104
    s_cmp_eq_u32 s43, 0
    s_cbranch_scc1 k2_kernel_sw120
    v_swap_b32 v104, v105
k2_kernel_sw120:
    s_cmp_lg_u32 s3, 0
    s_cbranch_scc1 k2_kernel_ps123
    v_mov_b32 v6, 1
    v_lshlrev_b32 v4, 2, v0
    s_lshr_b32 s8, s4, 1
    s_lshl_b32 s8, s8, 7
    s_add_u32 s8, s8, 29774848
    v_add_u32 v4, s8, v4
    s_mov_b32 s18, 0
    s_mov_b64 exec, 65535
k2_kernel_poll121:
    buffer_load_dword v5, v4, s[28:31], 0 offen sc1
    s_waitcnt vmcnt(0)
    v_cmp_ne_u32 vcc, v6, v5
    s_cmp_eq_u64 vcc, 0
    s_cbranch_scc1 k2_kernel_pd122
    s_add_u32 s18, s18, 1
    s_cmp_ge_u32 s18, 0x40000
    s_cbranch_scc1 k2_kernel_pd122
    s_sleep 1
    s_branch k2_kernel_poll121
k2_kernel_pd122:
    s_mov_b64 exec, -1
k2_kernel_ps123:
    s_barrier
    s_mov_b32 s39, 0
    s_mul_i32 s39, s39, 4
    s_lshl_b32 s8, s43, 1
    s_add_u32 s39, s39, s8
    s_mov_b32 s46, 0
    s_mov_b32 s49, 0
    s_lshl_b32 s40, s39, 10
    s_cmp_lt_u32 s39, 76
    s_cselect_b32 s40, s40, 0x40000000
    s_cmp_lt_u32 s46, 38
    s_cselect_b32 s40, s40, 0x40000000
    s_add_u32 s46, s46, 1
    s_cmp_ge_u32 s39, 56
    s_cselect_b32 s8, s49, 1
    s_cmp_eq_u32 s8, 0
    s_cselect_b32 s40, 0x40000000, s40
    s_sub_u32 s8, s39, 54
    s_cmp_lt_u32 s8, 2
    s_cselect_b32 s40, 0x40000000, s40
    s_cmp_ge_u32 s39, 56
    s_cbranch_scc1 k2_kernel_as124
    buffer_load_dwordx4 v[72:75], v10, s[24:27], s40 offen sc1
    buffer_load_dwordx4 v[76:79], v11, s[24:27], s40 offen sc1
    s_branch k2_kernel_as125
k2_kernel_as124:
    buffer_load_dwordx4 v[72:75], v104, s[28:31], s40 offen sc1
    buffer_load_dwordx4 v[76:79], v105, s[28:31], s40 offen sc1
k2_kernel_as125:
    s_add_u32 s39, s39, 1
    s_lshl_b32 s40, s39, 10
    s_cmp_lt_u32 s39, 76
    s_cselect_b32 s40, s40, 0x40000000
    s_cmp_lt_u32 s46, 38
    s_cselect_b32 s40, s40, 0x40000000
    s_add_u32 s46, s46, 1
    s_cmp_ge_u32 s39, 56
    s_cselect_b32 s8, s49, 1
    s_cmp_eq_u32 s8, 0
    s_cselect_b32 s40, 0x40000000, s40
    s_sub_u32 s8, s39, 54
    s_cmp_lt_u32 s8, 2
    s_cselect_b32 s40, 0x40000000, s40
    s_cmp_ge_u32 s39, 56
    s_cbranch_scc1 k2_kernel_as126
    buffer_load_dwordx4 v[80:83], v10, s[24:27], s40 offen sc1
    buffer_load_dwordx4 v[84:87], v11, s[24:27], s40 offen sc1
    s_branch k2_kernel_as127
k2_kernel_as126:
    buffer_load_dwordx4 v[80:83], v104, s[28:31], s40 offen sc1
    buffer_load_dwordx4 v[84:87], v105, s[28:31], s40 offen sc1
k2_kernel_as127:
    s_add_u32 s39, s39, 3
    s_sub_u32 s8, s39, 76
    s_cmp_ge_u32 s39, 76
    s_cselect_b32 s39, s8, s39
    s_lshl_b32 s40, s39, 10
    s_cmp_lt_u32 s39, 76
    s_cselect_b32 s40, s40, 0x40000000
    s_cmp_lt_u32 s46, 38
    s_cselect_b32 s40, s40, 0x40000000
    s_add_u32 s46, s46, 1
    s_cmp_ge_u32 s39, 56
    s_cselect_b32 s8, s49, 1
    s_cmp_eq_u32 s8, 0
    s_cselect_b32 s40, 0x40000000, s40
    s_sub_u32 s8, s39, 54
    s_cmp_lt_u32 s8, 2
    s_cselect_b32 s40, 0x40000000, s40
    s_cmp_ge_u32 s39, 56
    s_cbranch_scc1 k2_kernel_as128
    buffer_load_dwordx4 v[88:91], v10, s[24:27], s40 offen sc1
    buffer_load_dwordx4 v[92:95], v11, s[24:27], s40 offen sc1
    s_branch k2_kernel_as129
k2_kernel_as128:
    buffer_load_dwordx4 v[88:91], v104, s[28:31], s40 offen sc1
    buffer_load_dwordx4 v[92:95], v105, s[28:31], s40 offen sc1
k2_kernel_as129:
    s_add_u32 s39, s39, 1
    s_lshl_b32 s40, s39, 10
    s_cmp_lt_u32 s39, 76
    s_cselect_b32 s40, s40, 0x40000000
    s_cmp_lt_u32 s46, 38
    s_cselect_b32 s40, s40, 0x40000000
    s_add_u32 s46, s46, 1
    s_cmp_ge_u32 s39, 56
    s_cselect_b32 s8, s49, 1
    s_cmp_eq_u32 s8, 0
    s_cselect_b32 s40, 0x40000000, s40
    s_sub_u32 s8, s39, 54
    s_cmp_lt_u32 s8, 2
    s_cselect_b32 s40, 0x40000000, s40
    s_cmp_ge_u32 s39, 56
    s_cbranch_scc1 k2_kernel_as130
    buffer_load_dwordx4 v[96:99], v10, s[24:27], s40 offen sc1
    buffer_load_dwordx4 v[100:103], v11, s[24:27], s40 offen sc1
    s_branch k2_kernel_as131
k2_kernel_as130:
    buffer_load_dwordx4 v[96:99], v104, s[28:31], s40 offen sc1
    buffer_load_dwordx4 v[100:103], v105, s[28:31], s40 offen sc1
k2_kernel_as131:
    s_add_u32 s39, s39, 3
    s_sub_u32 s8, s39, 76
    s_cmp_ge_u32 s39, 76
    s_cselect_b32 s39, s8, s39
    s_barrier
    ds_read_b128 v[52:55], v3 offset:0
    ds_read_b128 v[56:59], v3 offset:1024
    ds_read_b128 v[60:63], v3 offset:2048
    ds_read_b128 v[64:67], v3 offset:3072
    ds_read_b128 v[68:71], v3 offset:4096
    s_mov_b32 s36, 0
    s_mov_b32 s37, 0
    s_waitcnt vmcnt(6) lgkmcnt(4)
    v_mfma_f32_16x16x32_bf16 v[12:15], v[52:55], v[72:75], 0
    v_mfma_f32_16x16x32_bf16 v[32:35], v[52:55], v[76:79], 0
    s_waitcnt lgkmcnt(3)
    v_mfma_f32_16x16x32_bf16 v[16:19], v[56:59], v[72:75], 0
    ds_read_b128 v[52:55], v3 offset:5120
    v_mfma_f32_16x16x32_bf16 v[36:39], v[56:59], v[76:79], 0
    s_waitcnt lgkmcnt(3)
    v_mfma_f32_16x16x32_bf16 v[20:23], v[60:63], v[72:75], 0
    ds_read_b128 v[56:59], v3 offset:6144
    v_mfma_f32_16x16x32_bf16 v[40:43], v[60:63], v[76:79], 0
    s_waitcnt lgkmcnt(3)
    v_mfma_f32_16x16x32_bf16 v[24:27], v[64:67], v[72:75], 0
    ds_read_b128 v[60:63], v3 offset:7168
    v_mfma_f32_16x16x32_bf16 v[44:47], v[64:67], v[76:79], 0
    s_waitcnt lgkmcnt(3)
    v_mfma_f32_16x16x32_bf16 v[28:31], v[68:71], v[72:75], 0
    ds_read_b128 v[64:67], v3 offset:8192
    v_mfma_f32_16x16x32_bf16 v[48:51], v[68:71], v[76:79], 0
    ds_read_b128 v[68:71], v3 offset:9216
    s_lshl_b32 s40, s39, 10
    s_cmp_lt_u32 s39, 76
    s_cselect_b32 s40, s40, 0x40000000
    s_cmp_lt_u32 s46, 38
    s_cselect_b32 s40, s40, 0x40000000
    s_add_u32 s46, s46, 1
    s_cmp_ge_u32 s39, 56
    s_cselect_b32 s8, s49, 1
    s_cmp_eq_u32 s8, 0
    s_cselect_b32 s40, 0x40000000, s40
    s_sub_u32 s8, s39, 54
    s_cmp_lt_u32 s8, 2
    s_cselect_b32 s40, 0x40000000, s40
    s_cmp_ge_u32 s39, 56
    s_cbranch_scc1 k2_kernel_as135
    buffer_load_dwordx4 v[72:75], v10, s[24:27], s40 offen sc1
    buffer_load_dwordx4 v[76:79], v11, s[24:27], s40 offen sc1
    s_branch k2_kernel_as136
k2_kernel_as135:
    buffer_load_dwordx4 v[72:75], v104, s[28:31], s40 offen sc1
    buffer_load_dwordx4 v[76:79], v105, s[28:31], s40 offen sc1
k2_kernel_as136:
    s_add_u32 s39, s39, 1
    s_add_u32 s37, s37, 1
    s_cmp_eq_u32 s37, 4
    s_mov_b32 s16, 20480
    s_cselect_b32 s16, 4294905856, s16
    s_cselect_b32 s37, 0, s37
    v_add_u32 v3, s16, v3
    s_barrier
    s_waitcnt vmcnt(6) lgkmcnt(4)
    v_mfma_f32_16x16x32_bf16 v[12:15], v[52:55], v[80:83], v[12:15]
    v_mfma_f32_16x16x32_bf16 v[32:35], v[52:55], v[84:87], v[32:35]
    s_waitcnt lgkmcnt(3)
    v_mfma_f32_16x16x32_bf16 v[16:19], v[56:59], v[80:83], v[16:19]
    ds_read_b128 v[52:55], v3 offset:0
    v_mfma_f32_16x16x32_bf16 v[36:39], v[56:59], v[84:87], v[36:39]
    s_waitcnt lgkmcnt(3)
    v_mfma_f32_16x16x32_bf16 v[20:23], v[60:63], v[80:83], v[20:23]
    ds_read_b128 v[56:59], v3 offset:1024
    v_mfma_f32_16x16x32_bf16 v[40:43], v[60:63], v[84:87], v[40:43]
    s_waitcnt lgkmcnt(3)
    v_mfma_f32_16x16x32_bf16 v[24:27], v[64:67], v[80:83], v[24:27]
    ds_read_b128 v[60:63], v3 offset:2048
    v_mfma_f32_16x16x32_bf16 v[44:47], v[64:67], v[84:87], v[44:47]
    s_waitcnt lgkmcnt(3)
    v_mfma_f32_16x16x32_bf16 v[28:31], v[68:71], v[80:83], v[28:31]
    ds_read_b128 v[64:67], v3 offset:3072
    v_mfma_f32_16x16x32_bf16 v[48:51], v[68:71], v[84:87], v[48:51]
    ds_read_b128 v[68:71], v3 offset:4096
    s_lshl_b32 s40, s39, 10
    s_cmp_lt_u32 s39, 76
    s_cselect_b32 s40, s40, 0x40000000
    s_cmp_lt_u32 s46, 38
    s_cselect_b32 s40, s40, 0x40000000
    s_add_u32 s46, s46, 1
    s_cmp_ge_u32 s39, 56
    s_cselect_b32 s8, s49, 1
    s_cmp_eq_u32 s8, 0
    s_cselect_b32 s40, 0x40000000, s40
    s_sub_u32 s8, s39, 54
    s_cmp_lt_u32 s8, 2
    s_cselect_b32 s40, 0x40000000, s40
    s_cmp_ge_u32 s39, 56
    s_cbranch_scc1 k2_kernel_as137
    buffer_load_dwordx4 v[80:83], v10, s[24:27], s40 offen sc1
    buffer_load_dwordx4 v[84:87], v11, s[24:27], s40 offen sc1
    s_branch k2_kernel_as138
k2_kernel_as137:
    buffer_load_dwordx4 v[80:83], v104, s[28:31], s40 offen sc1
    buffer_load_dwordx4 v[84:87], v105, s[28:31], s40 offen sc1
k2_kernel_as138:
    s_add_u32 s39, s39, 3
    s_sub_u32 s8, s39, 76
    s_cmp_ge_u32 s39, 76
    s_cselect_b32 s39, s8, s39
    s_mul_i32 s8, s47, 20480
    s_lshl_b32 s17, s45, 9
    s_add_u32 s8, s8, s17
    s_add_u32 s8, s8, 5432320
    v_lshrrev_b32 v4, 1, v2
    v_and_b32 v5, 1, v2
    v_lshlrev_b32 v4, 8, v4
    v_lshl_add_u32 v4, v1, 4, v4
    v_lshl_add_u32 v4, v5, 3, v4
    buffer_load_dwordx2 v[106:107], v4, s[28:31], s8 offen offset:0 sc1
    buffer_load_dwordx2 v[108:109], v4, s[28:31], s8 offen offset:512 sc1
    buffer_load_dwordx2 v[110:111], v4, s[28:31], s8 offen offset:1024 sc1
    buffer_load_dwordx2 v[112:113], v4, s[28:31], s8 offen offset:1536 sc1
    buffer_load_dwordx2 v[114:115], v4, s[28:31], s8 offen offset:2048 sc1
    s_lshl_b32 s8, s47, 6
    s_add_u32 s8, s8, 2802688
    v_lshlrev_b32 v4, 2, v1
    buffer_load_dword v116, v4, s[28:31], s8 offen
    s_add_u32 s36, s36, 1
.p2align 6
k2_kernel_gloop132:
    s_waitcnt vmcnt(6) lgkmcnt(4)
    v_mfma_f32_16x16x32_bf16 v[12:15], v[52:55], v[88:91], v[12:15]
    v_mfma_f32_16x16x32_bf16 v[32:35], v[52:55], v[92:95], v[32:35]
    s_waitcnt lgkmcnt(3)
    v_mfma_f32_16x16x32_bf16 v[16:19], v[56:59], v[88:91], v[16:19]
    ds_read_b128 v[52:55], v3 offset:5120
    v_mfma_f32_16x16x32_bf16 v[36:39], v[56:59], v[92:95], v[36:39]
    s_waitcnt lgkmcnt(3)
    v_mfma_f32_16x16x32_bf16 v[20:23], v[60:63], v[88:91], v[20:23]
    ds_read_b128 v[56:59], v3 offset:6144
    v_mfma_f32_16x16x32_bf16 v[40:43], v[60:63], v[92:95], v[40:43]
    s_waitcnt lgkmcnt(3)
    v_mfma_f32_16x16x32_bf16 v[24:27], v[64:67], v[88:91], v[24:27]
    ds_read_b128 v[60:63], v3 offset:7168
    v_mfma_f32_16x16x32_bf16 v[44:47], v[64:67], v[92:95], v[44:47]
    s_waitcnt lgkmcnt(3)
    v_mfma_f32_16x16x32_bf16 v[28:31], v[68:71], v[88:91], v[28:31]
    ds_read_b128 v[64:67], v3 offset:8192
    v_mfma_f32_16x16x32_bf16 v[48:51], v[68:71], v[92:95], v[48:51]
    ds_read_b128 v[68:71], v3 offset:9216
    s_lshl_b32 s40, s39, 10
    s_cmp_lt_u32 s39, 76
    s_cselect_b32 s40, s40, 0x40000000
    s_cmp_lt_u32 s46, 38
    s_cselect_b32 s40, s40, 0x40000000
    s_add_u32 s46, s46, 1
    s_cmp_ge_u32 s39, 56
    s_cselect_b32 s8, s49, 1
    s_cmp_eq_u32 s8, 0
    s_cselect_b32 s40, 0x40000000, s40
    s_sub_u32 s8, s39, 54
    s_cmp_lt_u32 s8, 2
    s_cselect_b32 s40, 0x40000000, s40
    s_cmp_ge_u32 s39, 56
    s_cbranch_scc1 k2_kernel_as139
    buffer_load_dwordx4 v[88:91], v10, s[24:27], s40 offen sc1
    buffer_load_dwordx4 v[92:95], v11, s[24:27], s40 offen sc1
    s_branch k2_kernel_as140
k2_kernel_as139:
    buffer_load_dwordx4 v[88:91], v104, s[28:31], s40 offen sc1
    buffer_load_dwordx4 v[92:95], v105, s[28:31], s40 offen sc1
k2_kernel_as140:
    s_add_u32 s39, s39, 1
    s_add_u32 s37, s37, 1
    s_cmp_eq_u32 s37, 4
    s_mov_b32 s16, 20480
    s_cselect_b32 s16, 4294905856, s16
    s_cselect_b32 s37, 0, s37
    v_add_u32 v3, s16, v3
    s_cmp_lg_u32 s36, 13
    s_cbranch_scc1 k2_kernel_mp141
    s_cmp_lg_u32 s3, 0
    s_cbranch_scc1 k2_kernel_ps144
    v_mov_b32 v6, 1
    v_lshlrev_b32 v4, 2, v0
    s_lshl_b32 s8, s4, 7
    s_add_u32 s8, s8, 29778944
    v_add_u32 v4, s8, v4
    s_mov_b32 s18, 0
    s_mov_b64 exec, 255
k2_kernel_poll142:
    buffer_load_dword v5, v4, s[28:31], 0 offen sc1
    s_waitcnt vmcnt(0)
    v_cmp_ne_u32 vcc, v6, v5
    s_cmp_eq_u64 vcc, 0
    s_cbranch_scc1 k2_kernel_pd143
    s_add_u32 s18, s18, 1
    s_cmp_ge_u32 s18, 0x40000
    s_cbranch_scc1 k2_kernel_pd143
    s_sleep 1
    s_branch k2_kernel_poll142
k2_kernel_pd143:
    s_mov_b64 exec, -1
k2_kernel_ps144:
k2_kernel_mp141:
    s_barrier
    s_waitcnt vmcnt(6) lgkmcnt(4)
    v_mfma_f32_16x16x32_bf16 v[12:15], v[52:55], v[96:99], v[12:15]
    v_mfma_f32_16x16x32_bf16 v[32:35], v[52:55], v[100:103], v[32:35]
    s_waitcnt lgkmcnt(3)
    v_mfma_f32_16x16x32_bf16 v[16:19], v[56:59], v[96:99], v[16:19]
    ds_read_b128 v[52:55], v3 offset:0
    v_mfma_f32_16x16x32_bf16 v[36:39], v[56:59], v[100:103], v[36:39]
    s_waitcnt lgkmcnt(3)
    v_mfma_f32_16x16x32_bf16 v[20:23], v[60:63], v[96:99], v[20:23]
    ds_read_b128 v[56:59], v3 offset:1024
    v_mfma_f32_16x16x32_bf16 v[40:43], v[60:63], v[100:103], v[40:43]
    s_waitcnt lgkmcnt(3)
    v_mfma_f32_16x16x32_bf16 v[24:27], v[64:67], v[96:99], v[24:27]
    ds_read_b128 v[60:63], v3 offset:2048
    v_mfma_f32_16x16x32_bf16 v[44:47], v[64:67], v[100:103], v[44:47]
    s_waitcnt lgkmcnt(3)
    v_mfma_f32_16x16x32_bf16 v[28:31], v[68:71], v[96:99], v[28:31]
    ds_read_b128 v[64:67], v3 offset:3072
    v_mfma_f32_16x16x32_bf16 v[48:51], v[68:71], v[100:103], v[48:51]
    ds_read_b128 v[68:71], v3 offset:4096
    s_lshl_b32 s40, s39, 10
    s_cmp_lt_u32 s39, 76
    s_cselect_b32 s40, s40, 0x40000000
    s_cmp_lt_u32 s46, 38
    s_cselect_b32 s40, s40, 0x40000000
    s_add_u32 s46, s46, 1
    s_cmp_ge_u32 s39, 56
    s_cselect_b32 s8, s49, 1
    s_cmp_eq_u32 s8, 0
    s_cselect_b32 s40, 0x40000000, s40
    s_sub_u32 s8, s39, 54
    s_cmp_lt_u32 s8, 2
    s_cselect_b32 s40, 0x40000000, s40
    s_cmp_ge_u32 s39, 56
    s_cbranch_scc1 k2_kernel_as145
    buffer_load_dwordx4 v[96:99], v10, s[24:27], s40 offen sc1
    buffer_load_dwordx4 v[100:103], v11, s[24:27], s40 offen sc1
    s_branch k2_kernel_as146
k2_kernel_as145:
    buffer_load_dwordx4 v[96:99], v104, s[28:31], s40 offen sc1
    buffer_load_dwordx4 v[100:103], v105, s[28:31], s40 offen sc1
k2_kernel_as146:
    s_add_u32 s39, s39, 3
    s_sub_u32 s8, s39, 76
    s_cmp_ge_u32 s39, 76
    s_cselect_b32 s39, s8, s39
    s_cmp_lg_u32 s36, 13
    s_cbranch_scc1 k2_kernel_mq147
    s_mov_b32 s49, 1
    s_waitcnt vmcnt(0)
    s_lshl_b32 s39, s43, 1
    s_add_u32 s39, s39, 56
    s_sub_u32 s46, s46, 4
    s_lshl_b32 s40, s39, 10
    s_cmp_lt_u32 s39, 76
    s_cselect_b32 s40, s40, 0x40000000
    s_cmp_lt_u32 s46, 38
    s_cselect_b32 s40, s40, 0x40000000
    s_add_u32 s46, s46, 1
    s_cmp_ge_u32 s39, 56
    s_cselect_b32 s8, s49, 1
    s_cmp_eq_u32 s8, 0
    s_cselect_b32 s40, 0x40000000, s40
    s_sub_u32 s8, s39, 54
    s_cmp_lt_u32 s8, 2
    s_cselect_b32 s40, 0x40000000, s40
    s_cmp_ge_u32 s39, 56
    s_cbranch_scc1 k2_kernel_as148
    buffer_load_dwordx4 v[72:75], v10, s[24:27], s40 offen sc1
    buffer_load_dwordx4 v[76:79], v11, s[24:27], s40 offen sc1
    s_branch k2_kernel_as149
k2_kernel_as148:
    buffer_load_dwordx4 v[72:75], v104, s[28:31], s40 offen sc1
    buffer_load_dwordx4 v[76:79], v105, s[28:31], s40 offen sc1
k2_kernel_as149:
    s_add_u32 s39, s39, 1
    s_lshl_b32 s40, s39, 10
    s_cmp_lt_u32 s39, 76
    s_cselect_b32 s40, s40, 0x40000000
    s_cmp_lt_u32 s46, 38
    s_cselect_b32 s40, s40, 0x40000000
    s_add_u32 s46, s46, 1
    s_cmp_ge_u32 s39, 56
    s_cselect_b32 s8, s49, 1
    s_cmp_eq_u32 s8, 0
    s_cselect_b32 s40, 0x40000000, s40
    s_sub_u32 s8, s39, 54
    s_cmp_lt_u32 s8, 2
    s_cselect_b32 s40, 0x40000000, s40
    s_cmp_ge_u32 s39, 56
    s_cbranch_scc1 k2_kernel_as150
    buffer_load_dwordx4 v[80:83], v10, s[24:27], s40 offen sc1
    buffer_load_dwordx4 v[84:87], v11, s[24:27], s40 offen sc1
    s_branch k2_kernel_as151
k2_kernel_as150:
    buffer_load_dwordx4 v[80:83], v104, s[28:31], s40 offen sc1
    buffer_load_dwordx4 v[84:87], v105, s[28:31], s40 offen sc1
k2_kernel_as151:
    s_add_u32 s39, s39, 3
    s_sub_u32 s8, s39, 76
    s_cmp_ge_u32 s39, 76
    s_cselect_b32 s39, s8, s39
    s_lshl_b32 s40, s39, 10
    s_cmp_lt_u32 s39, 76
    s_cselect_b32 s40, s40, 0x40000000
    s_cmp_lt_u32 s46, 38
    s_cselect_b32 s40, s40, 0x40000000
    s_add_u32 s46, s46, 1
    s_cmp_ge_u32 s39, 56
    s_cselect_b32 s8, s49, 1
    s_cmp_eq_u32 s8, 0
    s_cselect_b32 s40, 0x40000000, s40
    s_sub_u32 s8, s39, 54
    s_cmp_lt_u32 s8, 2
    s_cselect_b32 s40, 0x40000000, s40
    s_cmp_ge_u32 s39, 56
    s_cbranch_scc1 k2_kernel_as152
    buffer_load_dwordx4 v[88:91], v10, s[24:27], s40 offen sc1
    buffer_load_dwordx4 v[92:95], v11, s[24:27], s40 offen sc1
    s_branch k2_kernel_as153
k2_kernel_as152:
    buffer_load_dwordx4 v[88:91], v104, s[28:31], s40 offen sc1
    buffer_load_dwordx4 v[92:95], v105, s[28:31], s40 offen sc1
k2_kernel_as153:
    s_add_u32 s39, s39, 1
    s_lshl_b32 s40, s39, 10
    s_cmp_lt_u32 s39, 76
    s_cselect_b32 s40, s40, 0x40000000
    s_cmp_lt_u32 s46, 38
    s_cselect_b32 s40, s40, 0x40000000
    s_add_u32 s46, s46, 1
    s_cmp_ge_u32 s39, 56
    s_cselect_b32 s8, s49, 1
    s_cmp_eq_u32 s8, 0
    s_cselect_b32 s40, 0x40000000, s40
    s_sub_u32 s8, s39, 54
    s_cmp_lt_u32 s8, 2
    s_cselect_b32 s40, 0x40000000, s40
    s_cmp_ge_u32 s39, 56
    s_cbranch_scc1 k2_kernel_as154
    buffer_load_dwordx4 v[96:99], v10, s[24:27], s40 offen sc1
    buffer_load_dwordx4 v[100:103], v11, s[24:27], s40 offen sc1
    s_branch k2_kernel_as155
k2_kernel_as154:
    buffer_load_dwordx4 v[96:99], v104, s[28:31], s40 offen sc1
    buffer_load_dwordx4 v[100:103], v105, s[28:31], s40 offen sc1
k2_kernel_as155:
    s_add_u32 s39, s39, 3
    s_sub_u32 s8, s39, 76
    s_cmp_ge_u32 s39, 76
    s_cselect_b32 s39, s8, s39
k2_kernel_mq147:
    s_add_u32 s36, s36, 1
    s_cmp_lt_u32 s36, 18
    s_cbranch_scc0 k2_kernel_gexit133
    s_waitcnt vmcnt(6) lgkmcnt(4)
    v_mfma_f32_16x16x32_bf16 v[12:15], v[52:55], v[72:75], v[12:15]
    v_mfma_f32_16x16x32_bf16 v[32:35], v[52:55], v[76:79], v[32:35]
    s_waitcnt lgkmcnt(3)
    v_mfma_f32_16x16x32_bf16 v[16:19], v[56:59], v[72:75], v[16:19]
    ds_read_b128 v[52:55], v3 offset:5120
    v_mfma_f32_16x16x32_bf16 v[36:39], v[56:59], v[76:79], v[36:39]
    s_waitcnt lgkmcnt(3)
    v_mfma_f32_16x16x32_bf16 v[20:23], v[60:63], v[72:75], v[20:23]
    ds_read_b128 v[56:59], v3 offset:6144
    v_mfma_f32_16x16x32_bf16 v[40:43], v[60:63], v[76:79], v[40:43]
    s_waitcnt lgkmcnt(3)
    v_mfma_f32_16x16x32_bf16 v[24:27], v[64:67], v[72:75], v[24:27]
    ds_read_b128 v[60:63], v3 offset:7168
    v_mfma_f32_16x16x32_bf16 v[44:47], v[64:67], v[76:79], v[44:47]
    s_waitcnt lgkmcnt(3)
    v_mfma_f32_16x16x32_bf16 v[28:31], v[68:71], v[72:75], v[28:31]
    ds_read_b128 v[64:67], v3 offset:8192
    v_mfma_f32_16x16x32_bf16 v[48:51], v[68:71], v[76:79], v[48:51]
    ds_read_b128 v[68:71], v3 offset:9216
    s_lshl_b32 s40, s39, 10
    s_cmp_lt_u32 s39, 76
    s_cselect_b32 s40, s40, 0x40000000
    s_cmp_lt_u32 s46, 38
    s_cselect_b32 s40, s40, 0x40000000
    s_add_u32 s46, s46, 1
    s_cmp_ge_u32 s39, 56
    s_cselect_b32 s8, s49, 1
    s_cmp_eq_u32 s8, 0
    s_cselect_b32 s40, 0x40000000, s40
    s_sub_u32 s8, s39, 54
    s_cmp_lt_u32 s8, 2
    s_cselect_b32 s40, 0x40000000, s40
    s_cmp_ge_u32 s39, 56
    s_cbranch_scc1 k2_kernel_as156
    buffer_load_dwordx4 v[72:75], v10, s[24:27], s40 offen sc1
    buffer_load_dwordx4 v[76:79], v11, s[24:27], s40 offen sc1
    s_branch k2_kernel_as157
k2_kernel_as156:
    buffer_load_dwordx4 v[72:75], v104, s[28:31], s40 offen sc1
    buffer_load_dwordx4 v[76:79], v105, s[28:31], s40 offen sc1
k2_kernel_as157:
    s_add_u32 s39, s39, 1
    s_add_u32 s37, s37, 1
    s_cmp_eq_u32 s37, 4
    s_mov_b32 s16, 20480
    s_cselect_b32 s16, 4294905856, s16
    s_cselect_b32 s37, 0, s37
    v_add_u32 v3, s16, v3
    s_barrier
    s_waitcnt vmcnt(6) lgkmcnt(4)
    v_mfma_f32_16x16x32_bf16 v[12:15], v[52:55], v[80:83], v[12:15]
    v_mfma_f32_16x16x32_bf16 v[32:35], v[52:55], v[84:87], v[32:35]
    s_waitcnt lgkmcnt(3)
    v_mfma_f32_16x16x32_bf16 v[16:19], v[56:59], v[80:83], v[16:19]
    ds_read_b128 v[52:55], v3 offset:0
    v_mfma_f32_16x16x32_bf16 v[36:39], v[56:59], v[84:87], v[36:39]
    s_waitcnt lgkmcnt(3)
    v_mfma_f32_16x16x32_bf16 v[20:23], v[60:63], v[80:83], v[20:23]
    ds_read_b128 v[56:59], v3 offset:1024
    v_mfma_f32_16x16x32_bf16 v[40:43], v[60:63], v[84:87], v[40:43]
    s_waitcnt lgkmcnt(3)
    v_mfma_f32_16x16x32_bf16 v[24:27], v[64:67], v[80:83], v[24:27]
    ds_read_b128 v[60:63], v3 offset:2048
    v_mfma_f32_16x16x32_bf16 v[44:47], v[64:67], v[84:87], v[44:47]
    s_waitcnt lgkmcnt(3)
    v_mfma_f32_16x16x32_bf16 v[28:31], v[68:71], v[80:83], v[28:31]
    ds_read_b128 v[64:67], v3 offset:3072
    v_mfma_f32_16x16x32_bf16 v[48:51], v[68:71], v[84:87], v[48:51]
    ds_read_b128 v[68:71], v3 offset:4096
    s_lshl_b32 s40, s39, 10
    s_cmp_lt_u32 s39, 76
    s_cselect_b32 s40, s40, 0x40000000
    s_cmp_lt_u32 s46, 38
    s_cselect_b32 s40, s40, 0x40000000
    s_add_u32 s46, s46, 1
    s_cmp_ge_u32 s39, 56
    s_cselect_b32 s8, s49, 1
    s_cmp_eq_u32 s8, 0
    s_cselect_b32 s40, 0x40000000, s40
    s_sub_u32 s8, s39, 54
    s_cmp_lt_u32 s8, 2
    s_cselect_b32 s40, 0x40000000, s40
    s_cmp_ge_u32 s39, 56
    s_cbranch_scc1 k2_kernel_as158
    buffer_load_dwordx4 v[80:83], v10, s[24:27], s40 offen sc1
    buffer_load_dwordx4 v[84:87], v11, s[24:27], s40 offen sc1
    s_branch k2_kernel_as159
k2_kernel_as158:
    buffer_load_dwordx4 v[80:83], v104, s[28:31], s40 offen sc1
    buffer_load_dwordx4 v[84:87], v105, s[28:31], s40 offen sc1
k2_kernel_as159:
    s_add_u32 s39, s39, 3
    s_sub_u32 s8, s39, 76
    s_cmp_ge_u32 s39, 76
    s_cselect_b32 s39, s8, s39
    s_add_u32 s36, s36, 1
    s_cmp_lt_u32 s36, 18
    s_cbranch_scc1 k2_kernel_gloop132
k2_kernel_gexit133:
    s_waitcnt vmcnt(6) lgkmcnt(4)
    v_mfma_f32_16x16x32_bf16 v[12:15], v[52:55], v[72:75], v[12:15]
    v_mfma_f32_16x16x32_bf16 v[32:35], v[52:55], v[76:79], v[32:35]
    s_waitcnt lgkmcnt(3)
    v_mfma_f32_16x16x32_bf16 v[16:19], v[56:59], v[72:75], v[16:19]
    ds_read_b128 v[52:55], v3 offset:5120
    v_mfma_f32_16x16x32_bf16 v[36:39], v[56:59], v[76:79], v[36:39]
    s_waitcnt lgkmcnt(3)
    v_mfma_f32_16x16x32_bf16 v[20:23], v[60:63], v[72:75], v[20:23]
    ds_read_b128 v[56:59], v3 offset:6144
    v_mfma_f32_16x16x32_bf16 v[40:43], v[60:63], v[76:79], v[40:43]
    s_waitcnt lgkmcnt(3)
    v_mfma_f32_16x16x32_bf16 v[24:27], v[64:67], v[72:75], v[24:27]
    ds_read_b128 v[60:63], v3 offset:7168
    v_mfma_f32_16x16x32_bf16 v[44:47], v[64:67], v[76:79], v[44:47]
    s_waitcnt lgkmcnt(3)
    v_mfma_f32_16x16x32_bf16 v[28:31], v[68:71], v[72:75], v[28:31]
    ds_read_b128 v[64:67], v3 offset:8192
    v_mfma_f32_16x16x32_bf16 v[48:51], v[68:71], v[76:79], v[48:51]
    ds_read_b128 v[68:71], v3 offset:9216
    s_lshl_b32 s40, s39, 10
    s_cmp_lt_u32 s39, 76
    s_cselect_b32 s40, s40, 0x40000000
    s_cmp_lt_u32 s46, 38
    s_cselect_b32 s40, s40, 0x40000000
    s_add_u32 s46, s46, 1
    s_cmp_ge_u32 s39, 56
    s_cselect_b32 s8, s49, 1
    s_cmp_eq_u32 s8, 0
    s_cselect_b32 s40, 0x40000000, s40
    s_sub_u32 s8, s39, 54
    s_cmp_lt_u32 s8, 2
    s_cselect_b32 s40, 0x40000000, s40
    s_cmp_ge_u32 s39, 56
    s_cbranch_scc1 k2_kernel_as160
    buffer_load_dwordx4 v[72:75], v10, s[24:27], s40 offen sc1
    buffer_load_dwordx4 v[76:79], v11, s[24:27], s40 offen sc1
    s_branch k2_kernel_as161
k2_kernel_as160:
    buffer_load_dwordx4 v[72:75], v104, s[28:31], s40 offen sc1
    buffer_load_dwordx4 v[76:79], v105, s[28:31], s40 offen sc1
k2_kernel_as161:
    s_add_u32 s39, s39, 1
    s_waitcnt vmcnt(6) lgkmcnt(4)
    v_mfma_f32_16x16x32_bf16 v[12:15], v[52:55], v[80:83], v[12:15]
    v_mfma_f32_16x16x32_bf16 v[32:35], v[52:55], v[84:87], v[32:35]
    s_waitcnt lgkmcnt(3)
    v_mfma_f32_16x16x32_bf16 v[16:19], v[56:59], v[80:83], v[16:19]
    v_mfma_f32_16x16x32_bf16 v[36:39], v[56:59], v[84:87], v[36:39]
    s_waitcnt lgkmcnt(2)
    v_mfma_f32_16x16x32_bf16 v[20:23], v[60:63], v[80:83], v[20:23]
    v_mfma_f32_16x16x32_bf16 v[40:43], v[60:63], v[84:87], v[40:43]
    s_waitcnt lgkmcnt(1)
    v_mfma_f32_16x16x32_bf16 v[24:27], v[64:67], v[80:83], v[24:27]
    v_mfma_f32_16x16x32_bf16 v[44:47], v[64:67], v[84:87], v[44:47]
    s_waitcnt lgkmcnt(0)
    v_mfma_f32_16x16x32_bf16 v[28:31], v[68:71], v[80:83], v[28:31]
    v_mfma_f32_16x16x32_bf16 v[48:51], v[68:71], v[84:87], v[48:51]
    s_nop 7
    s_xor_b32 s8, s3, 1
    s_mul_i32 s8, s8, 5120
    s_add_u32 s8, s8, 0
    v_lshlrev_b32 v8, 4, v0
    v_add_u32 v9, s8, v8
    ds_write_b128 v9, v[32:35] offset:0
    ds_write_b128 v9, v[36:39] offset:1024
    ds_write_b128 v9, v[40:43] offset:2048
    ds_write_b128 v9, v[44:47] offset:3072
    ds_write_b128 v9, v[48:51] offset:4096
    s_mul_i32 s8, s3, 5120
    s_add_u32 s8, s8, 0
    s_waitcnt lgkmcnt(0)
    s_barrier
    v_add_u32 v9, s8, v8
    ds_read_b128 v[32:35], v9 offset:0
    ds_read_b128 v[36:39], v9 offset:1024
    ds_read_b128 v[40:43], v9 offset:2048
    ds_read_b128 v[44:47], v9 offset:3072
    ds_read_b128 v[48:51], v9 offset:4096
    s_waitcnt vmcnt(0) lgkmcnt(0)
    v_pk_add_f32 v[12:13], v[12:13], v[32:33]
    v_pk_add_f32 v[14:15], v[14:15], v[34:35]
    v_pk_add_f32 v[16:17], v[16:17], v[36:37]
    v_pk_add_f32 v[18:19], v[18:19], v[38:39]
    v_pk_add_f32 v[20:21], v[20:21], v[40:41]
    v_pk_add_f32 v[22:23], v[22:23], v[42:43]
    v_pk_add_f32 v[24:25], v[24:25], v[44:45]
    v_pk_add_f32 v[26:27], v[26:27], v[46:47]
    v_pk_add_f32 v[28:29], v[28:29], v[48:49]
    v_pk_add_f32 v[30:31], v[30:31], v[50:51]
    s_mov_b32 s32, s14
    s_mov_b32 s33, s15
    s_mov_b32 s34, 2621440
    s_mov_b32 s35, 0x20000
    v_sub_f32 v68, 1.0, v116
    v_lshlrev_b32 v64, 16, v106
    v_and_b32 v65, 0xffff0000, v106
    v_lshlrev_b32 v66, 16, v107
    v_and_b32 v67, 0xffff0000, v107
    v_pk_fma_f32 v[12:13], v[64:65], v[68:69], v[12:13] op_sel_hi:[1,0,1]
    v_pk_fma_f32 v[14:15], v[66:67], v[68:69], v[14:15] op_sel_hi:[1,0,1]
    v_cvt_pk_bf16_f32 v52, v12, v13
    v_cvt_pk_bf16_f32 v53, v14, v15
    v_lshlrev_b32 v64, 16, v108
    v_and_b32 v65, 0xffff0000, v108
    v_lshlrev_b32 v66, 16, v109
    v_and_b32 v67, 0xffff0000, v109
    v_pk_fma_f32 v[16:17], v[64:65], v[68:69], v[16:17] op_sel_hi:[1,0,1]
    v_pk_fma_f32 v[18:19], v[66:67], v[68:69], v[18:19] op_sel_hi:[1,0,1]
    v_cvt_pk_bf16_f32 v54, v16, v17
    v_cvt_pk_bf16_f32 v55, v18, v19
    v_lshlrev_b32 v64, 16, v110
    v_and_b32 v65, 0xffff0000, v110
    v_lshlrev_b32 v66, 16, v111
    v_and_b32 v67, 0xffff0000, v111
    v_pk_fma_f32 v[20:21], v[64:65], v[68:69], v[20:21] op_sel_hi:[1,0,1]
    v_pk_fma_f32 v[22:23], v[66:67], v[68:69], v[22:23] op_sel_hi:[1,0,1]
    v_cvt_pk_bf16_f32 v56, v20, v21
    v_cvt_pk_bf16_f32 v57, v22, v23
    v_lshlrev_b32 v64, 16, v112
    v_and_b32 v65, 0xffff0000, v112
    v_lshlrev_b32 v66, 16, v113
    v_and_b32 v67, 0xffff0000, v113
    v_pk_fma_f32 v[24:25], v[64:65], v[68:69], v[24:25] op_sel_hi:[1,0,1]
    v_pk_fma_f32 v[26:27], v[66:67], v[68:69], v[26:27] op_sel_hi:[1,0,1]
    v_cvt_pk_bf16_f32 v58, v24, v25
    v_cvt_pk_bf16_f32 v59, v26, v27
    v_lshlrev_b32 v64, 16, v114
    v_and_b32 v65, 0xffff0000, v114
    v_lshlrev_b32 v66, 16, v115
    v_and_b32 v67, 0xffff0000, v115
    v_pk_fma_f32 v[28:29], v[64:65], v[68:69], v[28:29] op_sel_hi:[1,0,1]
    v_pk_fma_f32 v[30:31], v[66:67], v[68:69], v[30:31] op_sel_hi:[1,0,1]
    v_cvt_pk_bf16_f32 v60, v28, v29
    v_cvt_pk_bf16_f32 v61, v30, v31
    s_lshl_b32 s8, s47, 4
    v_add_u32 v4, s8, v1
    v_mul_u32_u24 v4, 1280, v4
    v_lshl_add_u32 v4, v2, 3, v4
    s_lshl_b32 s8, s45, 5
    buffer_store_dwordx2 v[52:53], v4, s[32:35], s8 offen offset:0
    buffer_store_dwordx2 v[54:55], v4, s[32:35], s8 offen offset:32
    buffer_store_dwordx2 v[56:57], v4, s[32:35], s8 offen offset:64
    buffer_store_dwordx2 v[58:59], v4, s[32:35], s8 offen offset:96
    buffer_store_dwordx2 v[60:61], v4, s[32:35], s8 offen offset:128
    s_branch k2_kernel_join118
k2_kernel_ldr117:
    s_cmp_eq_u32 s3, 5
    s_cbranch_scc1 k2_kernel_l163
    s_cmp_eq_u32 s3, 6
    s_cbranch_scc1 k2_kernel_l164
    s_cmp_eq_u32 s3, 7
    s_cbranch_scc1 k2_kernel_l165
k2_kernel_l162:
    v_lshlrev_b32 v10, 4, v0
    s_waitcnt lgkmcnt(0)
    s_mov_b32 s39, 0
    s_mul_i32 s40, s5, 389120
    s_add_u32 s40, s40, 0
    s_mul_i32 s38, s39, 20480
    s_add_u32 s38, s38, s40
    s_add_u32 s20, s10, 26657792
    s_addc_u32 s21, s11, 0
    s_mov_b32 s22, 3112960
    s_mov_b32 s23, 0x20000
    v_lshlrev_b32 v11, 7, v0
    s_mov_b32 s28, s10
    s_mov_b32 s29, s11
    s_mov_b32 s30, 29815808
    s_mov_b32 s31, 0x20000
    s_mov_b32 m0, 0
    s_nop 0
    buffer_load_dwordx4 v10, s[20:23], s38 offen offset:0 lds
    buffer_load_dwordx4 v10, s[20:23], s38 offen offset:1024 lds
    buffer_load_dwordx4 v10, s[20:23], s38 offen offset:2048 lds
    buffer_load_dwordx4 v10, s[20:23], s38 offen offset:3072 lds
    s_mov_b32 m0, 4096
    s_add_u32 s8, s38, 4096
    buffer_load_dwordx4 v10, s[20:23], s8 offen offset:0 lds
    s_add_u32 s38, s38, 20480
    s_add_u32 s39, s39, 1
    s_cmp_eq_u32 s39, 19
    s_cselect_b32 s38, s40, s38
    s_cselect_b32 s39, 0, s39
    s_mov_b32 m0, 20480
    s_nop 0
    buffer_load_dwordx4 v10, s[20:23], s38 offen offset:0 lds
    buffer_load_dwordx4 v10, s[20:23], s38 offen offset:1024 lds
    buffer_load_dwordx4 v10, s[20:23], s38 offen offset:2048 lds
    buffer_load_dwordx4 v10, s[20:23], s38 offen offset:3072 lds
    s_mov_b32 m0, 24576
    s_add_u32 s8, s38, 4096
    buffer_load_dwordx4 v10, s[20:23], s8 offen offset:0 lds
    s_add_u32 s38, s38, 20480
    s_add_u32 s39, s39, 1
    s_cmp_eq_u32 s39, 19
    s_cselect_b32 s38, s40, s38
    s_cselect_b32 s39, 0, s39
    s_mov_b32 m0, 40960
    s_nop 0
    buffer_load_dwordx4 v10, s[20:23], s38 offen offset:0 lds
    buffer_load_dwordx4 v10, s[20:23], s38 offen offset:1024 lds
    buffer_load_dwordx4 v10, s[20:23], s38 offen offset:2048 lds
    buffer_load_dwordx4 v10, s[20:23], s38 offen offset:3072 lds
    s_mov_b32 m0, 45056
    s_add_u32 s8, s38, 4096
    buffer_load_dwordx4 v10, s[20:23], s8 offen offset:0 lds
    s_add_u32 s38, s38, 20480
    s_add_u32 s39, s39, 1
    s_cmp_eq_u32 s39, 19
    s_cselect_b32 s38, s40, s38
    s_cselect_b32 s39, 0, s39
    s_mov_b32 m0, 61440
    s_nop 0
    buffer_load_dwordx4 v10, s[20:23], s38 offen offset:0 lds
    buffer_load_dwordx4 v10, s[20:23], s38 offen offset:1024 lds
    buffer_load_dwordx4 v10, s[20:23], s38 offen offset:2048 lds
    buffer_load_dwordx4 v10, s[20:23], s38 offen offset:3072 lds
    s_mov_b32 m0, 65536
    s_add_u32 s8, s38, 4096
    buffer_load_dwordx4 v10, s[20:23], s8 offen offset:0 lds
    s_add_u32 s38, s38, 20480
    s_add_u32 s39, s39, 1
    s_cmp_eq_u32 s39, 19
    s_cselect_b32 s38, s40, s38
    s_cselect_b32 s39, 0, s39
    s_barrier
    s_waitcnt vmcnt(15)
    s_barrier
    s_waitcnt vmcnt(10)
    s_barrier
    s_mov_b32 s37, 0
    s_mov_b32 s46, 40960
    s_mov_b32 s36, 2
k2_kernel_ll167:
    s_waitcnt vmcnt(5)
    s_barrier
    s_add_u32 m0, s37, 0
    s_nop 0
    buffer_load_dwordx4 v10, s[20:23], s38 offen offset:0 lds
    buffer_load_dwordx4 v10, s[20:23], s38 offen offset:1024 lds
    buffer_load_dwordx4 v10, s[20:23], s38 offen offset:2048 lds
    buffer_load_dwordx4 v10, s[20:23], s38 offen offset:3072 lds
    s_add_u32 m0, s37, 4096
    s_add_u32 s8, s38, 4096
    buffer_load_dwordx4 v10, s[20:23], s8 offen offset:0 lds
    s_add_u32 s38, s38, 20480
    s_add_u32 s39, s39, 1
    s_cmp_eq_u32 s39, 19
    s_cselect_b32 s38, s40, s38
    s_cselect_b32 s39, 0, s39
    s_add_u32 s37, s37, 20480
    s_cmp_eq_u32 s37, 81920
    s_cselect_b32 s37, 0, s37
    s_add_u32 s36, s36, 1
    s_cmp_le_u32 s36, 16
    s_cbranch_scc1 k2_kernel_ll167
    s_waitcnt vmcnt(5)
    s_barrier
    s_waitcnt vmcnt(0)
    s_barrier
    s_branch k2_kernel_lfin166
k2_kernel_l163:
    v_lshlrev_b32 v10, 4, v0
    s_waitcnt lgkmcnt(0)
    s_mov_b32 s39, 0
    s_mul_i32 s40, s5, 389120
    s_add_u32 s40, s40, 5120
    s_mul_i32 s38, s39, 20480
    s_add_u32 s38, s38, s40
    s_add_u32 s20, s10, 26657792
    s_addc_u32 s21, s11, 0
    s_mov_b32 s22, 3112960
    s_mov_b32 s23, 0x20000
    v_lshlrev_b32 v11, 7, v0
    s_mov_b32 s28, s10
    s_mov_b32 s29, s11
    s_mov_b32 s30, 29815808
    s_mov_b32 s31, 0x20000
    s_mov_b32 m0, 5120
    s_nop 0
    buffer_load_dwordx4 v10, s[20:23], s38 offen offset:0 lds
    buffer_load_dwordx4 v10, s[20:23], s38 offen offset:1024 lds
    buffer_load_dwordx4 v10, s[20:23], s38 offen offset:2048 lds
    buffer_load_dwordx4 v10, s[20:23], s38 offen offset:3072 lds
    s_mov_b32 m0, 9216
    s_add_u32 s8, s38, 4096
    buffer_load_dwordx4 v10, s[20:23], s8 offen offset:0 lds
    s_add_u32 s38, s38, 20480
    s_add_u32 s39, s39, 1
    s_cmp_eq_u32 s39, 19
    s_cselect_b32 s38, s40, s38
    s_cselect_b32 s39, 0, s39
    s_mov_b32 m0, 25600
    s_nop 0
    buffer_load_dwordx4 v10, s[20:23], s38 offen offset:0 lds
    buffer_load_dwordx4 v10, s[20:23], s38 offen offset:1024 lds
    buffer_load_dwordx4 v10, s[20:23], s38 offen offset:2048 lds
    buffer_load_dwordx4 v10, s[20:23], s38 offen offset:3072 lds
    s_mov_b32 m0, 29696
    s_add_u32 s8, s38, 4096
    buffer_load_dwordx4 v10, s[20:23], s8 offen offset:0 lds
    s_add_u32 s38, s38, 20480
    s_add_u32 s39, s39, 1
    s_cmp_eq_u32 s39, 19
    s_cselect_b32 s38, s40, s38
    s_cselect_b32 s39, 0, s39
    s_mov_b32 m0, 46080
    s_nop 0
    buffer_load_dwordx4 v10, s[20:23], s38 offen offset:0 lds
    buffer_load_dwordx4 v10, s[20:23], s38 offen offset:1024 lds
    buffer_load_dwordx4 v10, s[20:23], s38 offen offset:2048 lds
    buffer_load_dwordx4 v10, s[20:23], s38 offen offset:3072 lds
    s_mov_b32 m0, 50176
    s_add_u32 s8, s38, 4096
    buffer_load_dwordx4 v10, s[20:23], s8 offen offset:0 lds
    s_add_u32 s38, s38, 20480
    s_add_u32 s39, s39, 1
    s_cmp_eq_u32 s39, 19
    s_cselect_b32 s38, s40, s38
    s_cselect_b32 s39, 0, s39
    s_mov_b32 m0, 66560
    s_nop 0
    buffer_load_dwordx4 v10, s[20:23], s38 offen offset:0 lds
    buffer_load_dwordx4 v10, s[20:23], s38 offen offset:1024 lds
    buffer_load_dwordx4 v10, s[20:23], s38 offen offset:2048 lds
    buffer_load_dwordx4 v10, s[20:23], s38 offen offset:3072 lds
    s_mov_b32 m0, 70656
    s_add_u32 s8, s38, 4096
    buffer_load_dwordx4 v10, s[20:23], s8 offen offset:0 lds
    s_add_u32 s38, s38, 20480
    s_add_u32 s39, s39, 1
    s_cmp_eq_u32 s39, 19
    s_cselect_b32 s38, s40, s38
    s_cselect_b32 s39, 0, s39
    s_barrier
    s_waitcnt vmcnt(15)
    s_barrier
    s_waitcnt vmcnt(10)
    s_barrier
    s_mov_b32 s37, 0
    s_mov_b32 s46, 40960
    s_mov_b32 s36, 2
k2_kernel_ll168:
    s_waitcnt vmcnt(5)
    s_barrier
    s_add_u32 m0, s37, 5120
    s_nop 0
    buffer_load_dwordx4 v10, s[20:23], s38 offen offset:0 lds
    buffer_load_dwordx4 v10, s[20:23], s38 offen offset:1024 lds
    buffer_load_dwordx4 v10, s[20:23], s38 offen offset:2048 lds
    buffer_load_dwordx4 v10, s[20:23], s38 offen offset:3072 lds
    s_add_u32 m0, s37, 9216
    s_add_u32 s8, s38, 4096
    buffer_load_dwordx4 v10, s[20:23], s8 offen offset:0 lds
    s_add_u32 s38, s38, 20480
    s_add_u32 s39, s39, 1
    s_cmp_eq_u32 s39, 19
    s_cselect_b32 s38, s40, s38
    s_cselect_b32 s39, 0, s39
    s_add_u32 s37, s37, 20480
    s_cmp_eq_u32 s37, 81920
    s_cselect_b32 s37, 0, s37
    s_add_u32 s36, s36, 1
    s_cmp_le_u32 s36, 16
    s_cbranch_scc1 k2_kernel_ll168
    s_waitcnt vmcnt(5)
    s_barrier
    s_waitcnt vmcnt(0)
    s_barrier
    s_branch k2_kernel_lfin166
k2_kernel_l164:
    v_lshlrev_b32 v10, 4, v0
    s_waitcnt lgkmcnt(0)
    s_mov_b32 s39, 0
    s_mul_i32 s40, s5, 389120
    s_add_u32 s40, s40, 10240
    s_mul_i32 s38, s39, 20480
    s_add_u32 s38, s38, s40
    s_add_u32 s20, s10, 26657792
    s_addc_u32 s21, s11, 0
    s_mov_b32 s22, 3112960
    s_mov_b32 s23, 0x20000
    v_lshlrev_b32 v11, 7, v0
    s_mov_b32 s28, s10
    s_mov_b32 s29, s11
    s_mov_b32 s30, 29815808
    s_mov_b32 s31, 0x20000
    s_cmp_eq_u32 s39, 13
    s_cselect_b32 s18, 0x40000000, 0
    s_add_u32 s38, s38, s18
    s_mov_b32 m0, 10240
    s_nop 0
    buffer_load_dwordx4 v10, s[20:23], s38 offen offset:0 lds
    buffer_load_dwordx4 v10, s[20:23], s38 offen offset:1024 lds
    buffer_load_dwordx4 v10, s[20:23], s38 offen offset:2048 lds
    buffer_load_dwordx4 v10, s[20:23], s38 offen offset:3072 lds
    s_mov_b32 m0, 14336
    s_add_u32 s8, s38, 4096
    buffer_load_dwordx4 v10, s[20:23], s8 offen offset:0 lds
    s_sub_u32 s38, s38, s18
    s_add_u32 s38, s38, 20480
    s_add_u32 s39, s39, 1
    s_cmp_eq_u32 s39, 19
    s_cselect_b32 s38, s40, s38
    s_cselect_b32 s39, 0, s39
    s_cmp_eq_u32 s39, 13
    s_cselect_b32 s18, 0x40000000, 0
    s_add_u32 s38, s38, s18
    s_mov_b32 m0, 30720
    s_nop 0
    buffer_load_dwordx4 v10, s[20:23], s38 offen offset:0 lds
    buffer_load_dwordx4 v10, s[20:23], s38 offen offset:1024 lds
    buffer_load_dwordx4 v10, s[20:23], s38 offen offset:2048 lds
    buffer_load_dwordx4 v10, s[20:23], s38 offen offset:3072 lds
    s_mov_b32 m0, 34816
    s_add_u32 s8, s38, 4096
    buffer_load_dwordx4 v10, s[20:23], s8 offen offset:0 lds
    s_sub_u32 s38, s38, s18
    s_add_u32 s38, s38, 20480
    s_add_u32 s39, s39, 1
    s_cmp_eq_u32 s39, 19
    s_cselect_b32 s38, s40, s38
    s_cselect_b32 s39, 0, s39
    s_cmp_eq_u32 s39, 13
    s_cselect_b32 s18, 0x40000000, 0
    s_add_u32 s38, s38, s18
    s_mov_b32 m0, 51200
    s_nop 0
    buffer_load_dwordx4 v10, s[20:23], s38 offen offset:0 lds
    buffer_load_dwordx4 v10, s[20:23], s38 offen offset:1024 lds
    buffer_load_dwordx4 v10, s[20:23], s38 offen offset:2048 lds
    buffer_load_dwordx4 v10, s[20:23], s38 offen offset:3072 lds
    s_mov_b32 m0, 55296
    s_add_u32 s8, s38, 4096
    buffer_load_dwordx4 v10, s[20:23], s8 offen offset:0 lds
    s_sub_u32 s38, s38, s18
    s_add_u32 s38, s38, 20480
    s_add_u32 s39, s39, 1
    s_cmp_eq_u32 s39, 19
    s_cselect_b32 s38, s40, s38
    s_cselect_b32 s39, 0, s39
    s_cmp_eq_u32 s39, 13
    s_cselect_b32 s18, 0x40000000, 0
    s_add_u32 s38, s38, s18
    s_mov_b32 m0, 71680
    s_nop 0
    buffer_load_dwordx4 v10, s[20:23], s38 offen offset:0 lds
    buffer_load_dwordx4 v10, s[20:23], s38 offen offset:1024 lds
    buffer_load_dwordx4 v10, s[20:23], s38 offen offset:2048 lds
    buffer_load_dwordx4 v10, s[20:23], s38 offen offset:3072 lds
    s_mov_b32 m0, 75776
    s_add_u32 s8, s38, 4096
    buffer_load_dwordx4 v10, s[20:23], s8 offen offset:0 lds
    s_sub_u32 s38, s38, s18
    s_add_u32 s38, s38, 20480
    s_add_u32 s39, s39, 1
    s_cmp_eq_u32 s39, 19
    s_cselect_b32 s38, s40, s38
    s_cselect_b32 s39, 0, s39
    s_barrier
    s_waitcnt vmcnt(15)
    s_barrier
    s_waitcnt vmcnt(10)
    s_barrier
    s_mov_b32 s37, 0
    s_mov_b32 s46, 40960
    s_mov_b32 s36, 2
k2_kernel_ll169:
    s_waitcnt vmcnt(5)
    s_barrier
    s_cmp_eq_u32 s39, 13
    s_cselect_b32 s18, 0x40000000, 0
    s_add_u32 s38, s38, s18
    s_add_u32 m0, s37, 10240
    s_nop 0
    buffer_load_dwordx4 v10, s[20:23], s38 offen offset:0 lds
    buffer_load_dwordx4 v10, s[20:23], s38 offen offset:1024 lds
    buffer_load_dwordx4 v10, s[20:23], s38 offen offset:2048 lds
    buffer_load_dwordx4 v10, s[20:23], s38 offen offset:3072 lds
    s_add_u32 m0, s37, 14336
    s_add_u32 s8, s38, 4096
    buffer_load_dwordx4 v10, s[20:23], s8 offen offset:0 lds
    s_sub_u32 s38, s38, s18
    s_add_u32 s38, s38, 20480
    s_add_u32 s39, s39, 1
    s_cmp_eq_u32 s39, 19
    s_cselect_b32 s38, s40, s38
    s_cselect_b32 s39, 0, s39
    s_add_u32 s37, s37, 20480
    s_cmp_eq_u32 s37, 81920
    s_cselect_b32 s37, 0, s37
    s_add_u32 s36, s36, 1
    s_cmp_le_u32 s36, 16
    s_cbranch_scc1 k2_kernel_ll169
    s_waitcnt vmcnt(5)
    s_barrier
    s_waitcnt vmcnt(0)
    s_barrier
    s_branch k2_kernel_lfin166
k2_kernel_l165:
    v_lshlrev_b32 v10, 4, v0
    s_waitcnt lgkmcnt(0)
    s_mov_b32 s39, 0
    s_mul_i32 s40, s5, 389120
    s_add_u32 s40, s40, 15360
    s_mul_i32 s38, s39, 20480
    s_add_u32 s38, s38, s40
    s_add_u32 s20, s10, 26657792
    s_addc_u32 s21, s11, 0
    s_mov_b32 s22, 3112960
    s_mov_b32 s23, 0x20000
    v_lshlrev_b32 v11, 7, v0
    s_mov_b32 s28, s10
    s_mov_b32 s29, s11
    s_mov_b32 s30, 29815808
    s_mov_b32 s31, 0x20000
    s_cmp_eq_u32 s39, 13
    s_cselect_b32 s18, 0x40000000, 0
    s_add_u32 s38, s38, s18
    s_mov_b32 m0, 15360
    s_nop 0
    buffer_load_dwordx4 v10, s[20:23], s38 offen offset:0 lds
    buffer_load_dwordx4 v10, s[20:23], s38 offen offset:1024 lds
    buffer_load_dwordx4 v10, s[20:23], s38 offen offset:2048 lds
    buffer_load_dwordx4 v10, s[20:23], s38 offen offset:3072 lds
    s_mov_b32 m0, 19456
    s_add_u32 s8, s38, 4096
    buffer_load_dwordx4 v10, s[20:23], s8 offen offset:0 lds
    s_sub_u32 s38, s38, s18
    s_add_u32 s38, s38, 20480
    s_add_u32 s39, s39, 1
    s_cmp_eq_u32 s39, 19
    s_cselect_b32 s38, s40, s38
    s_cselect_b32 s39, 0, s39
    s_cmp_eq_u32 s39, 13
    s_cselect_b32 s18, 0x40000000, 0
    s_add_u32 s38, s38, s18
    s_mov_b32 m0, 35840
    s_nop 0
    buffer_load_dwordx4 v10, s[20:23], s38 offen offset:0 lds
    buffer_load_dwordx4 v10, s[20:23], s38 offen offset:1024 lds
    buffer_load_dwordx4 v10, s[20:23], s38 offen offset:2048 lds
    buffer_load_dwordx4 v10, s[20:23], s38 offen offset:3072 lds
    s_mov_b32 m0, 39936
    s_add_u32 s8, s38, 4096
    buffer_load_dwordx4 v10, s[20:23], s8 offen offset:0 lds
    s_sub_u32 s38, s38, s18
    s_add_u32 s38, s38, 20480
    s_add_u32 s39, s39, 1
    s_cmp_eq_u32 s39, 19
    s_cselect_b32 s38, s40, s38
    s_cselect_b32 s39, 0, s39
    s_cmp_eq_u32 s39, 13
    s_cselect_b32 s18, 0x40000000, 0
    s_add_u32 s38, s38, s18
    s_mov_b32 m0, 56320
    s_nop 0
    buffer_load_dwordx4 v10, s[20:23], s38 offen offset:0 lds
    buffer_load_dwordx4 v10, s[20:23], s38 offen offset:1024 lds
    buffer_load_dwordx4 v10, s[20:23], s38 offen offset:2048 lds
    buffer_load_dwordx4 v10, s[20:23], s38 offen offset:3072 lds
    s_mov_b32 m0, 60416
    s_add_u32 s8, s38, 4096
    buffer_load_dwordx4 v10, s[20:23], s8 offen offset:0 lds
    s_sub_u32 s38, s38, s18
    s_add_u32 s38, s38, 20480
    s_add_u32 s39, s39, 1
    s_cmp_eq_u32 s39, 19
    s_cselect_b32 s38, s40, s38
    s_cselect_b32 s39, 0, s39
    s_cmp_eq_u32 s39, 13
    s_cselect_b32 s18, 0x40000000, 0
    s_add_u32 s38, s38, s18
    s_mov_b32 m0, 76800
    s_nop 0
    buffer_load_dwordx4 v10, s[20:23], s38 offen offset:0 lds
    buffer_load_dwordx4 v10, s[20:23], s38 offen offset:1024 lds
    buffer_load_dwordx4 v10, s[20:23], s38 offen offset:2048 lds
    buffer_load_dwordx4 v10, s[20:23], s38 offen offset:3072 lds
    s_mov_b32 m0, 80896
    s_add_u32 s8, s38, 4096
    buffer_load_dwordx4 v10, s[20:23], s8 offen offset:0 lds
    s_sub_u32 s38, s38, s18
    s_add_u32 s38, s38, 20480
    s_add_u32 s39, s39, 1
    s_cmp_eq_u32 s39, 19
    s_cselect_b32 s38, s40, s38
    s_cselect_b32 s39, 0, s39
    s_barrier
    s_waitcnt vmcnt(15)
    s_barrier
    s_waitcnt vmcnt(10)
    s_barrier
    s_mov_b32 s37, 0
    s_mov_b32 s46, 40960
    s_mov_b32 s36, 2
k2_kernel_ll170:
    s_waitcnt vmcnt(5)
    s_barrier
    s_cmp_eq_u32 s39, 13
    s_cselect_b32 s18, 0x40000000, 0
    s_add_u32 s38, s38, s18
    s_add_u32 m0, s37, 15360
    s_nop 0
    buffer_load_dwordx4 v10, s[20:23], s38 offen offset:0 lds
    buffer_load_dwordx4 v10, s[20:23], s38 offen offset:1024 lds
    buffer_load_dwordx4 v10, s[20:23], s38 offen offset:2048 lds
    buffer_load_dwordx4 v10, s[20:23], s38 offen offset:3072 lds
    s_add_u32 m0, s37, 19456
    s_add_u32 s8, s38, 4096
    buffer_load_dwordx4 v10, s[20:23], s8 offen offset:0 lds
    s_sub_u32 s38, s38, s18
    s_add_u32 s38, s38, 20480
    s_add_u32 s39, s39, 1
    s_cmp_eq_u32 s39, 19
    s_cselect_b32 s38, s40, s38
    s_cselect_b32 s39, 0, s39
    s_add_u32 s37, s37, 20480
    s_cmp_eq_u32 s37, 81920
    s_cselect_b32 s37, 0, s37
    s_add_u32 s36, s36, 1
    s_cmp_le_u32 s36, 16
    s_cbranch_scc1 k2_kernel_ll170
    s_waitcnt vmcnt(5)
    s_barrier
    s_waitcnt vmcnt(0)
    s_barrier
k2_kernel_lfin166:
    s_barrier
k2_kernel_join118:
k2_kernel_x:
    s_endpgm
k2_code_end:

.section .rodata,"a"
.p2align 6
.amdhsa_kernel k2_kernel
  .amdhsa_next_free_vgpr 128
  .amdhsa_next_free_sgpr 52
  .amdhsa_accum_offset 128
  .amdhsa_group_segment_fixed_size 0
  .amdhsa_kernarg_size 112
  .amdhsa_user_sgpr_count 2
  .amdhsa_user_sgpr_kernarg_segment_ptr 1
  .amdhsa_system_sgpr_workgroup_id_x 1
  .amdhsa_float_denorm_mode_32 3
  .amdhsa_float_denorm_mode_16_64 3
.end_amdhsa_kernel
.text

.set K2_CODE_BYTES, k2_code_end-k2_kernel
```
